```python
import torch

def _softmax(x, axis=-1):
    return torch.softmax(x, dim=axis)
def _gelu(x):
    return torch.nn.functional.gelu(x, approximate="tanh")
def _silu(x):
    return torch.nn.functional.silu(x)
def _sigmoid(x):
    return torch.sigmoid(x)
def _layernorm(x, axis=-1, eps=1e-5):
    m = x.mean(dim=axis, keepdim=True)
    v = x.var(dim=axis, keepdim=True, unbiased=False)
    return (x - m) / torch.sqrt(v + eps)
def _scatter_add(tgt, idx, src, axis=0):
    return tgt.clone().index_add_(axis, idx, src)
def _segment_sum(src, seg, n):
    out = torch.zeros((n,) + src.shape[1:], dtype=src.dtype)
    return out.index_add_(0, seg, src)
def _pad(x, pw):
    flat = tuple(v for pair in reversed(pw) for v in pair)
    return torch.nn.functional.pad(x, flat)

kernel_name = 'concat_heads__mha_block_cached__mha_block_cached__near_ridge'

def setup_inputs():

    _w = (lambda a: (lambda t: t.to(torch.bfloat16) if t.is_floating_point() else t)(torch.as_tensor(a)))
    def _A_setup():
        B, Sq, D = 8, 192, 512
        H, Sk, Dh = 32, 1024, 128
        return {
            "x": _w((lambda *s: torch.randn(*s, dtype=torch.bfloat16) * 0.8)(B, Sq, D)),
            "k_cache": _w((lambda *s: torch.randn(*s, dtype=torch.bfloat16) * 0.8)(B, H, Sk, Dh)),
            "v_cache": _w((lambda *s: torch.randn(*s, dtype=torch.bfloat16) * 0.05)(B, H, Sk, Dh)),
            "wq": _w((lambda *s: torch.randn(*s, dtype=torch.bfloat16) * 0.8)(D, H * Dh) * (D ** -0.5)),
            "wo": _w((lambda *s: torch.randn(*s, dtype=torch.bfloat16) * 0.05)(H * Dh, D) * ((H * Dh) ** -0.5)),
        }
    _A_in = _A_setup()

    def _B_setup():
        B, Sq, D = 8, 192, 512
        H, Sk, Dh = 32, 1024, 128
        return {
            "x": _w((lambda *s: torch.randn(*s, dtype=torch.bfloat16) * 0.8)(B, Sq, D)),
            "k_cache": _w((lambda *s: torch.randn(*s, dtype=torch.bfloat16) * 0.8)(B, H, Sk, Dh)),
            "v_cache": _w((lambda *s: torch.randn(*s, dtype=torch.bfloat16) * 0.05)(B, H, Sk, Dh)),
            "wq": _w((lambda *s: torch.randn(*s, dtype=torch.bfloat16) * 0.8)(D, H * Dh) * (D ** -0.5)),
            "wo": _w((lambda *s: torch.randn(*s, dtype=torch.bfloat16) * 0.05)(H * Dh, D) * ((H * Dh) ** -0.5)),
        }
    _B_in = _B_setup()

    return {
        "A_x": _A_in["x"],
        "A_k_cache": _A_in["k_cache"],
        "A_v_cache": _A_in["v_cache"],
        "A_wq": _A_in["wq"],
        "A_wo": _A_in["wo"],
        "B_x": _B_in["x"],
        "B_k_cache": _B_in["k_cache"],
        "B_v_cache": _B_in["v_cache"],
        "B_wq": _B_in["wq"],
        "B_wo": _B_in["wo"],
    }

def reference(A_x, A_k_cache, A_v_cache, A_wq, A_wo, B_x, B_k_cache, B_v_cache, B_wq, B_wo):
    def _A_ref(x, k_cache, v_cache, wq, wo):
        B, Sq, D = x.shape
        H, Dh = 32, 128
        q = (lambda x, *d: x.permute(*d))((x @ wq).reshape(B, Sq, H, Dh), 0, 2, 1, 3)
        scores = torch.einsum("bhqd,bhkd->bhqk", q, k_cache) * (Dh ** -0.5)
        p = _softmax(scores, axis=-1)
        o = torch.einsum("bhqk,bhkd->bhqd", p, v_cache)
        return (lambda x, *d: x.permute(*d))(o, 0, 2, 1, 3).reshape(B, Sq, H * Dh) @ wo

    def _B_ref(x, k_cache, v_cache, wq, wo):
        B, Sq, D = x.shape
        H, Dh = 32, 128
        q = (lambda x, *d: x.permute(*d))((x @ wq).reshape(B, Sq, H, Dh), 0, 2, 1, 3)
        scores = torch.einsum("bhqd,bhkd->bhqk", q, k_cache) * (Dh ** -0.5)
        p = _softmax(scores, axis=-1)
        o = torch.einsum("bhqk,bhkd->bhqd", p, v_cache)
        return (lambda x, *d: x.permute(*d))(o, 0, 2, 1, 3).reshape(B, Sq, H * Dh) @ wo

    a = _A_ref(A_x, A_k_cache, A_v_cache, A_wq, A_wo)
    b = _B_ref(B_x, B_k_cache, B_v_cache, B_wq, B_wo)
    return torch.concatenate([a, b], axis=-1)
```

```asm
; @launch kernel=attn_fused_kernel grid=(256,1,1) block=(512,1,1) lds=159792
; @launch kernel=oproj_kernel grid=(256,1,1) block=(512,1,1) lds=124416
; @launch kernel=oreduce_kernel grid=(512,1,1) block=(192,1,1) lds=0
.amdgcn_target "amdgcn-amd-amdhsa--gfx950"
.text
.globl attn_fused_kernel
.p2align 8
.type attn_fused_kernel,@function
attn_fused_kernel:
    s_cmp_ge_u32 s2, 256
    s_cbranch_scc1 K1_done
    v_lshrrev_b32 v17, 6, v0
    s_nop 1
    v_readfirstlane_b32 s90, v17
    s_and_b32 s4, s2, 7
    s_lshr_b32 s5, s2, 3
    s_lshr_b32 s6, s4, 2
    s_and_b32 s4, s4, 3
    s_lshl_b32 s4, s4, 2
    s_and_b32 s7, s5, 3
    s_add_u32 s4, s4, s7
    s_lshl_b32 s4, s4, 1
    s_lshr_b32 s7, s90, 2
    s_add_u32 s4, s4, s7
    s_mul_i32 s91, s7, 67584
    s_and_b32 s3, s90, 3
    s_lshr_b32 s5, s5, 2
    s_mul_i32 s7, s6, 40
    s_load_dwordx8 s[44:51], s[0:1], s7
    s_load_dwordx2 s[52:53], s[0:1], 96
    s_lshr_b32 s41, s2, 7
    s_mul_i32 s41, s41, 40
    s_add_u32 s41, s41, 32
    s_load_dwordx2 s[100:101], s[0:1], s41
    v_and_b32 v8, 3, v17
    v_and_b32 v9, 63, v0
    v_and_b32 v10, 15, v9
    v_lshrrev_b32 v11, 4, v9
    v_and_b32 v12, 3, v9
    v_bfe_u32 v13, v9, 2, 2
    s_mov_b32 s40, 1056
    v_and_b32 v14, 7, v10
    v_mul_lo_u32 v1, v14, s40
    v_lshrrev_b32 v14, 3, v10
    v_lshl_add_u32 v1, v14, 8, v1
    v_lshl_add_u32 v1, v11, 4, v1
    v_and_b32 v14, 1, v11
    v_lshl_add_u32 v14, v14, 2, v13
    v_mul_lo_u32 v14, v14, s40
    v_lshrrev_b32 v15, 1, v11
    v_lshl_add_u32 v2, v15, 8, v14
    v_lshl_add_u32 v2, v12, 3, v2
    v_lshl_add_u32 v3, v15, 9, v14
    v_lshl_add_u32 v3, v12, 4, v3
    v_add_u32 v1, s91, v1
    v_add_u32 v2, s91, v2
    v_add_u32 v3, s91, v3
    v_lshlrev_b32 v4, 11, v11
    v_lshl_add_u32 v4, v10, 4, v4
    v_lshl_add_u32 v4, v8, 9, v4
    v_lshlrev_b32 v14, 4, v15
    v_lshrrev_b32 v16, 1, v8
    v_lshl_add_u32 v14, v16, 3, v14
    v_and_b32 v16, 1, v11
    v_lshl_add_u32 v14, v16, 2, v14
    v_and_b32 v16, 1, v8
    v_lshl_add_u32 v14, v16, 1, v14
    v_lshlrev_b32 v5, 13, v14
    v_lshl_add_u32 v5, v10, 4, v5
    v_lshlrev_b32 v7, 4, v9
    v_lshrrev_b32 v14, 3, v9
    v_mul_u32_u24 v15, 24, v17
    v_add_u32 v15, v15, v14
    v_lshrrev_b32 v14, 1, v14
    v_and_b32 v16, 7, v9
    v_xor_b32 v14, v14, v16
    v_and_b32 v16, 1, v17
    v_lshlrev_b32 v16, 2, v16
    v_xor_b32 v14, v14, v16
    v_lshlrev_b32 v14, 4, v14
    v_lshl_add_u32 v50, v15, 10, v14
    v_xor_b32 v51, 64, v50
    v_lshrrev_b32 v14, 1, v10
    v_xor_b32 v14, v14, v11
    v_lshlrev_b32 v14, 4, v14
    v_lshl_add_u32 v14, v10, 7, v14
    v_mul_u32_u24 v15, 6144, v8
    v_add_u32 v15, v14, v15
    v_add_u32 v52, 135168, v15
    v_xor_b32 v53, 64, v52
    v_and_b32 v15, 1, v8
    v_mul_u32_u24 v15, 6144, v15
    v_add_u32 v15, v14, v15
    v_lshrrev_b32 v16, 1, v8
    v_mul_u32_u24 v16, 67584, v16
    v_add_u32 v15, v15, v16
    v_add_u32 v54, 50688, v15
    v_xor_b32 v55, 64, v54
    v_xor_b32 v14, 16, v9
    v_lshlrev_b32 v252, 2, v14
    v_xor_b32 v14, 32, v9
    v_lshlrev_b32 v253, 2, v14
    v_mov_b32 v24, 0
    v_lshlrev_b32 v25, 2, v17
    v_add_u32 v25, 159744, v25
    v_and_b32 v26, 4, v17
    v_add_u32 v26, v26, v12
    v_lshlrev_b32 v26, 2, v26
    v_add_u32 v26, 159744, v26
    ds_write_b32 v25, v24
    s_mul_i32 s32, s3, 3072
    s_add_u32 s32, s32, s91
    s_add_u32 s32, s32, 50688
    s_mul_i32 s33, s90, 3072
    s_add_u32 s33, s33, 135168
    s_mul_i32 s34, s3, 2112
    s_add_u32 s88, s34, 67584
    s_add_u32 s34, s34, s91
    s_mov_b32 s36, 0
    s_lshl_b32 s54, s5, 2
    s_add_u32 s54, s54, s4
    s_mov_b32 s38, 0x3e0293ee
    s_mov_b32 s39, 0x3e0293ee
    s_lshr_b32 s57, s4, 1
    s_add_u32 s57, s57, s5
    s_and_b32 s57, s57, 7
    s_mul_i32 s41, s6, 96
    s_mul_i32 s42, s5, 12
    s_add_u32 s41, s41, s42
    s_mul_i32 s42, s3, 3
    s_add_u32 s41, s41, s42
    s_lshl_b32 s41, s41, 7
    s_lshl_b32 s42, s4, 2
    s_add_u32 s41, s41, s42
    s_lshl_b32 s37, s41, 10
    s_waitcnt lgkmcnt(0)
    s_lshl_b32 s41, s5, 5
    s_add_u32 s41, s41, s4
    s_lshl_b32 s41, s41, 18
    s_add_u32 s46, s46, s41
    s_addc_u32 s47, s47, 0
    s_add_u32 s48, s48, s41
    s_addc_u32 s49, s49, 0
    s_lshl_b32 s42, s4, 8
    s_add_u32 s50, s50, s42
    s_addc_u32 s51, s51, 0
    s_sub_u32 s43, 0x400000, s42
    s_mul_i32 s42, s5, 196608
    s_add_u32 s44, s44, s42
    s_addc_u32 s45, s45, 0
    s_mov_b32 s8, s46
    s_and_b32 s9, s47, 0xffff
    s_mov_b32 s10, 262144
    s_mov_b32 s11, 0x00020000
    s_mov_b32 s12, s48
    s_and_b32 s13, s49, 0xffff
    s_mov_b32 s14, 262144
    s_mov_b32 s15, 0x00020000
    s_mov_b32 s16, s50
    s_and_b32 s17, s51, 0xffff
    s_mov_b32 s18, s43
    s_mov_b32 s19, 0x00020000
    s_mov_b32 s20, s44
    s_and_b32 s21, s45, 0xffff
    s_mov_b32 s22, 196608
    s_mov_b32 s23, 0x00020000
    s_mov_b32 s24, s52
    s_and_b32 s25, s53, 0xffff
    s_mov_b32 s26, 25165824
    s_mov_b32 s27, 0x00020000
    s_add_u32 s58, s57, 0
    s_and_b32 s58, s58, 7
    s_lshl_b32 s58, s58, 19
    s_add_u32 m0, s34, 0
    s_add_u32 s30, s58, 0
    buffer_load_dwordx4 v5, s[16:19], s30 offen lds
    s_add_u32 m0, s34, 1056
    s_add_u32 s30, s58, 8192
    buffer_load_dwordx4 v5, s[16:19], s30 offen lds
    s_add_u32 m0, s34, 8448
    s_add_u32 s30, s58, 262144
    buffer_load_dwordx4 v5, s[16:19], s30 offen lds
    s_add_u32 m0, s34, 9504
    s_add_u32 s30, s58, 270336
    buffer_load_dwordx4 v5, s[16:19], s30 offen lds
    s_add_u32 s59, s57, 0
    s_and_b32 s59, s59, 7
    s_lshl_b32 s59, s59, 7
    s_add_u32 m0, s32, 0
    s_add_u32 s42, s59, 0
    buffer_load_dwordx4 v50, s[20:23], s42 offen lds
    s_add_u32 m0, s32, 1024
    s_add_u32 s42, s59, 8192
    buffer_load_dwordx4 v51, s[20:23], s42 offen lds
    s_add_u32 m0, s32, 2048
    s_add_u32 s42, s59, 16384
    buffer_load_dwordx4 v50, s[20:23], s42 offen lds
    s_add_u32 s58, s57, 1
    s_and_b32 s58, s58, 7
    s_lshl_b32 s58, s58, 19
    s_add_u32 m0, s34, 16896
    s_add_u32 s30, s58, 0
    buffer_load_dwordx4 v5, s[16:19], s30 offen lds
    s_add_u32 m0, s34, 17952
    s_add_u32 s30, s58, 8192
    buffer_load_dwordx4 v5, s[16:19], s30 offen lds
    s_add_u32 m0, s34, 25344
    s_add_u32 s30, s58, 262144
    buffer_load_dwordx4 v5, s[16:19], s30 offen lds
    s_add_u32 m0, s34, 26400
    s_add_u32 s30, s58, 270336
    buffer_load_dwordx4 v5, s[16:19], s30 offen lds
    s_add_u32 s59, s57, 1
    s_and_b32 s59, s59, 7
    s_lshl_b32 s59, s59, 7
    s_add_u32 m0, s33, 0
    s_add_u32 s42, s59, 0
    buffer_load_dwordx4 v50, s[20:23], s42 offen lds
    s_add_u32 m0, s33, 1024
    s_add_u32 s42, s59, 8192
    buffer_load_dwordx4 v51, s[20:23], s42 offen lds
    s_add_u32 m0, s33, 2048
    s_add_u32 s42, s59, 16384
    buffer_load_dwordx4 v50, s[20:23], s42 offen lds
    s_add_u32 s58, s57, 2
    s_and_b32 s58, s58, 7
    s_lshl_b32 s58, s58, 19
    s_add_u32 m0, s34, 33792
    s_add_u32 s30, s58, 0
    buffer_load_dwordx4 v5, s[16:19], s30 offen lds
    s_add_u32 m0, s34, 34848
    s_add_u32 s30, s58, 8192
    buffer_load_dwordx4 v5, s[16:19], s30 offen lds
    s_add_u32 m0, s34, 42240
    s_add_u32 s30, s58, 262144
    buffer_load_dwordx4 v5, s[16:19], s30 offen lds
    s_add_u32 m0, s34, 43296
    s_add_u32 s30, s58, 270336
    buffer_load_dwordx4 v5, s[16:19], s30 offen lds
    s_waitcnt vmcnt(11) lgkmcnt(0)
    s_barrier
    ds_read_b64_tr_b16 v[8:9], v3 offset:0
    ds_read_b64_tr_b16 v[10:11], v3 offset:256
    ds_read_b128 v[56:59], v54 offset:0
    ds_read_b128 v[64:67], v54 offset:2048
    ds_read_b128 v[72:75], v54 offset:4096
    ds_read_b64_tr_b16 v[12:13], v3 offset:8
    ds_read_b64_tr_b16 v[14:15], v3 offset:264
    ds_read_b64_tr_b16 v[16:17], v3 offset:64
    ds_read_b64_tr_b16 v[18:19], v3 offset:320
    ds_read_b128 v[60:63], v55 offset:0
    ds_read_b128 v[68:71], v55 offset:2048
    ds_read_b128 v[76:79], v55 offset:4096
    ds_read_b64_tr_b16 v[20:21], v3 offset:72
    ds_read_b64_tr_b16 v[22:23], v3 offset:328
    s_waitcnt lgkmcnt(9)
    v_mfma_f32_16x16x32_bf16 v[152:155], v[8:11], v[56:59], 0
    v_mfma_f32_16x16x32_bf16 v[184:187], v[8:11], v[64:67], 0
    v_mfma_f32_16x16x32_bf16 v[216:219], v[8:11], v[72:75], 0
    ds_read_b64_tr_b16 v[8:9], v3 offset:128
    ds_read_b64_tr_b16 v[10:11], v3 offset:384
    s_waitcnt lgkmcnt(9)
    v_mfma_f32_16x16x32_bf16 v[156:159], v[12:15], v[56:59], 0
    v_mfma_f32_16x16x32_bf16 v[188:191], v[12:15], v[64:67], 0
    v_mfma_f32_16x16x32_bf16 v[220:223], v[12:15], v[72:75], 0
    ds_read_b64_tr_b16 v[12:13], v3 offset:136
    ds_read_b64_tr_b16 v[14:15], v3 offset:392
    s_waitcnt lgkmcnt(9)
    v_mfma_f32_16x16x32_bf16 v[160:163], v[16:19], v[56:59], 0
    v_mfma_f32_16x16x32_bf16 v[192:195], v[16:19], v[64:67], 0
    v_mfma_f32_16x16x32_bf16 v[224:227], v[16:19], v[72:75], 0
    ds_read_b64_tr_b16 v[16:17], v3 offset:192
    ds_read_b64_tr_b16 v[18:19], v3 offset:448
    s_waitcnt lgkmcnt(6)
    v_mfma_f32_16x16x32_bf16 v[164:167], v[20:23], v[56:59], 0
    v_mfma_f32_16x16x32_bf16 v[196:199], v[20:23], v[64:67], 0
    v_mfma_f32_16x16x32_bf16 v[228:231], v[20:23], v[72:75], 0
    ds_read_b64_tr_b16 v[20:21], v3 offset:200
    ds_read_b64_tr_b16 v[22:23], v3 offset:456
    s_waitcnt lgkmcnt(6)
    v_mfma_f32_16x16x32_bf16 v[168:171], v[8:11], v[56:59], 0
    v_mfma_f32_16x16x32_bf16 v[200:203], v[8:11], v[64:67], 0
    v_mfma_f32_16x16x32_bf16 v[232:235], v[8:11], v[72:75], 0
    ds_read_b64_tr_b16 v[8:9], v3 offset:8448
    ds_read_b64_tr_b16 v[10:11], v3 offset:8704
    s_waitcnt lgkmcnt(6)
    v_mfma_f32_16x16x32_bf16 v[172:175], v[12:15], v[56:59], 0
    v_mfma_f32_16x16x32_bf16 v[204:207], v[12:15], v[64:67], 0
    v_mfma_f32_16x16x32_bf16 v[236:239], v[12:15], v[72:75], 0
    ds_read_b64_tr_b16 v[12:13], v3 offset:8456
    ds_read_b64_tr_b16 v[14:15], v3 offset:8712
    s_waitcnt lgkmcnt(6)
    v_mfma_f32_16x16x32_bf16 v[176:179], v[16:19], v[56:59], 0
    v_mfma_f32_16x16x32_bf16 v[208:211], v[16:19], v[64:67], 0
    v_mfma_f32_16x16x32_bf16 v[240:243], v[16:19], v[72:75], 0
    ds_read_b64_tr_b16 v[16:17], v3 offset:8512
    ds_read_b64_tr_b16 v[18:19], v3 offset:8768
    s_waitcnt lgkmcnt(6)
    v_mfma_f32_16x16x32_bf16 v[180:183], v[20:23], v[56:59], 0
    v_mfma_f32_16x16x32_bf16 v[212:215], v[20:23], v[64:67], 0
    v_mfma_f32_16x16x32_bf16 v[244:247], v[20:23], v[72:75], 0
    ds_read_b64_tr_b16 v[20:21], v3 offset:8520
    ds_read_b64_tr_b16 v[22:23], v3 offset:8776
    s_waitcnt lgkmcnt(6)
    v_mfma_f32_16x16x32_bf16 v[152:155], v[8:11], v[60:63], v[152:155]
    v_mfma_f32_16x16x32_bf16 v[184:187], v[8:11], v[68:71], v[184:187]
    v_mfma_f32_16x16x32_bf16 v[216:219], v[8:11], v[76:79], v[216:219]
    ds_read_b64_tr_b16 v[8:9], v3 offset:8576
    ds_read_b64_tr_b16 v[10:11], v3 offset:8832
    s_waitcnt lgkmcnt(6)
    v_mfma_f32_16x16x32_bf16 v[156:159], v[12:15], v[60:63], v[156:159]
    v_mfma_f32_16x16x32_bf16 v[188:191], v[12:15], v[68:71], v[188:191]
    v_mfma_f32_16x16x32_bf16 v[220:223], v[12:15], v[76:79], v[220:223]
    ds_read_b64_tr_b16 v[12:13], v3 offset:8584
    ds_read_b64_tr_b16 v[14:15], v3 offset:8840
    s_waitcnt lgkmcnt(6)
    v_mfma_f32_16x16x32_bf16 v[160:163], v[16:19], v[60:63], v[160:163]
    v_mfma_f32_16x16x32_bf16 v[192:195], v[16:19], v[68:71], v[192:195]
    v_mfma_f32_16x16x32_bf16 v[224:227], v[16:19], v[76:79], v[224:227]
    ds_read_b64_tr_b16 v[16:17], v3 offset:8640
    ds_read_b64_tr_b16 v[18:19], v3 offset:8896
    s_waitcnt lgkmcnt(6)
    v_mfma_f32_16x16x32_bf16 v[164:167], v[20:23], v[60:63], v[164:167]
    v_mfma_f32_16x16x32_bf16 v[196:199], v[20:23], v[68:71], v[196:199]
    v_mfma_f32_16x16x32_bf16 v[228:231], v[20:23], v[76:79], v[228:231]
    ds_read_b64_tr_b16 v[20:21], v3 offset:8648
    ds_read_b64_tr_b16 v[22:23], v3 offset:8904
    s_waitcnt lgkmcnt(6)
    v_mfma_f32_16x16x32_bf16 v[168:171], v[8:11], v[60:63], v[168:171]
    v_mfma_f32_16x16x32_bf16 v[200:203], v[8:11], v[68:71], v[200:203]
    v_mfma_f32_16x16x32_bf16 v[232:235], v[8:11], v[76:79], v[232:235]
    s_waitcnt lgkmcnt(4)
    v_mfma_f32_16x16x32_bf16 v[172:175], v[12:15], v[60:63], v[172:175]
    v_mfma_f32_16x16x32_bf16 v[204:207], v[12:15], v[68:71], v[204:207]
    v_mfma_f32_16x16x32_bf16 v[236:239], v[12:15], v[76:79], v[236:239]
    s_waitcnt vmcnt(4) lgkmcnt(0)
    s_barrier
    ds_read_b64_tr_b16 v[8:9], v3 offset:16896
    ds_read_b64_tr_b16 v[10:11], v3 offset:17152
    ds_read_b128 v[80:83], v52 offset:0
    ds_read_b128 v[88:91], v52 offset:2048
    ds_read_b128 v[96:99], v52 offset:4096
    ds_read_b64_tr_b16 v[12:13], v3 offset:16904
    ds_read_b64_tr_b16 v[14:15], v3 offset:17160
    v_mfma_f32_16x16x32_bf16 v[176:179], v[16:19], v[60:63], v[176:179]
    v_mfma_f32_16x16x32_bf16 v[208:211], v[16:19], v[68:71], v[208:211]
    s_add_u32 s59, s57, 2
    s_and_b32 s59, s59, 7
    s_lshl_b32 s59, s59, 7
    s_add_u32 m0, s32, 0
    s_add_u32 s42, s59, 0
    buffer_load_dwordx4 v50, s[20:23], s42 offen lds
    v_mfma_f32_16x16x32_bf16 v[240:243], v[16:19], v[76:79], v[240:243]
    ds_read_b64_tr_b16 v[16:17], v3 offset:16960
    ds_read_b64_tr_b16 v[18:19], v3 offset:17216
    ds_read_b128 v[84:87], v53 offset:0
    ds_read_b128 v[92:95], v53 offset:2048
    ds_read_b128 v[100:103], v53 offset:4096
    v_mfma_f32_16x16x32_bf16 v[180:183], v[20:23], v[60:63], v[180:183]
    v_mfma_f32_16x16x32_bf16 v[212:215], v[20:23], v[68:71], v[212:215]
    s_add_u32 m0, s32, 1024
    s_add_u32 s42, s59, 8192
    buffer_load_dwordx4 v51, s[20:23], s42 offen lds
    v_mfma_f32_16x16x32_bf16 v[244:247], v[20:23], v[76:79], v[244:247]
    ds_read_b64_tr_b16 v[20:21], v3 offset:16968
    ds_read_b64_tr_b16 v[22:23], v3 offset:17224
    s_waitcnt lgkmcnt(9)
    v_mfma_f32_16x16x32_bf16 v[152:155], v[8:11], v[80:83], v[152:155]
    v_mfma_f32_16x16x32_bf16 v[184:187], v[8:11], v[88:91], v[184:187]
    s_add_u32 m0, s32, 2048
    s_add_u32 s42, s59, 16384
    buffer_load_dwordx4 v50, s[20:23], s42 offen lds
    v_mfma_f32_16x16x32_bf16 v[216:219], v[8:11], v[96:99], v[216:219]
    ds_read_b64_tr_b16 v[8:9], v3 offset:17024
    ds_read_b64_tr_b16 v[10:11], v3 offset:17280
    s_waitcnt lgkmcnt(9)
    v_mfma_f32_16x16x32_bf16 v[156:159], v[12:15], v[80:83], v[156:159]
    v_mfma_f32_16x16x32_bf16 v[188:191], v[12:15], v[88:91], v[188:191]
    s_add_u32 s58, s57, 3
    s_and_b32 s58, s58, 7
    s_lshl_b32 s58, s58, 19
    s_add_u32 m0, s34, 0
    s_add_u32 s30, s58, 0
    buffer_load_dwordx4 v5, s[16:19], s30 offen lds
    v_mfma_f32_16x16x32_bf16 v[220:223], v[12:15], v[96:99], v[220:223]
    ds_read_b64_tr_b16 v[12:13], v3 offset:17032
    ds_read_b64_tr_b16 v[14:15], v3 offset:17288
    s_waitcnt lgkmcnt(9)
    v_mfma_f32_16x16x32_bf16 v[160:163], v[16:19], v[80:83], v[160:163]
    v_mfma_f32_16x16x32_bf16 v[192:195], v[16:19], v[88:91], v[192:195]
    s_add_u32 m0, s34, 1056
    s_add_u32 s30, s58, 8192
    buffer_load_dwordx4 v5, s[16:19], s30 offen lds
    v_mfma_f32_16x16x32_bf16 v[224:227], v[16:19], v[96:99], v[224:227]
    ds_read_b64_tr_b16 v[16:17], v3 offset:17088
    ds_read_b64_tr_b16 v[18:19], v3 offset:17344
    s_waitcnt lgkmcnt(6)
    v_mfma_f32_16x16x32_bf16 v[164:167], v[20:23], v[80:83], v[164:167]
    v_mfma_f32_16x16x32_bf16 v[196:199], v[20:23], v[88:91], v[196:199]
    s_add_u32 m0, s34, 8448
    s_add_u32 s30, s58, 262144
    buffer_load_dwordx4 v5, s[16:19], s30 offen lds
    v_mfma_f32_16x16x32_bf16 v[228:231], v[20:23], v[96:99], v[228:231]
    ds_read_b64_tr_b16 v[20:21], v3 offset:17096
    ds_read_b64_tr_b16 v[22:23], v3 offset:17352
    s_waitcnt lgkmcnt(6)
    v_mfma_f32_16x16x32_bf16 v[168:171], v[8:11], v[80:83], v[168:171]
    v_mfma_f32_16x16x32_bf16 v[200:203], v[8:11], v[88:91], v[200:203]
    s_add_u32 m0, s34, 9504
    s_add_u32 s30, s58, 270336
    buffer_load_dwordx4 v5, s[16:19], s30 offen lds
    v_mfma_f32_16x16x32_bf16 v[232:235], v[8:11], v[96:99], v[232:235]
    ds_read_b64_tr_b16 v[8:9], v3 offset:25344
    ds_read_b64_tr_b16 v[10:11], v3 offset:25600
    s_waitcnt lgkmcnt(6)
    v_mfma_f32_16x16x32_bf16 v[172:175], v[12:15], v[80:83], v[172:175]
    v_mfma_f32_16x16x32_bf16 v[204:207], v[12:15], v[88:91], v[204:207]
    v_mfma_f32_16x16x32_bf16 v[236:239], v[12:15], v[96:99], v[236:239]
    ds_read_b64_tr_b16 v[12:13], v3 offset:25352
    ds_read_b64_tr_b16 v[14:15], v3 offset:25608
    s_waitcnt lgkmcnt(6)
    v_mfma_f32_16x16x32_bf16 v[176:179], v[16:19], v[80:83], v[176:179]
    v_mfma_f32_16x16x32_bf16 v[208:211], v[16:19], v[88:91], v[208:211]
    v_mfma_f32_16x16x32_bf16 v[240:243], v[16:19], v[96:99], v[240:243]
    ds_read_b64_tr_b16 v[16:17], v3 offset:25408
    ds_read_b64_tr_b16 v[18:19], v3 offset:25664
    s_waitcnt lgkmcnt(6)
    v_mfma_f32_16x16x32_bf16 v[180:183], v[20:23], v[80:83], v[180:183]
    v_mfma_f32_16x16x32_bf16 v[212:215], v[20:23], v[88:91], v[212:215]
    v_mfma_f32_16x16x32_bf16 v[244:247], v[20:23], v[96:99], v[244:247]
    ds_read_b64_tr_b16 v[20:21], v3 offset:25416
    ds_read_b64_tr_b16 v[22:23], v3 offset:25672
    s_waitcnt lgkmcnt(6)
    v_mfma_f32_16x16x32_bf16 v[152:155], v[8:11], v[84:87], v[152:155]
    v_mfma_f32_16x16x32_bf16 v[184:187], v[8:11], v[92:95], v[184:187]
    v_mfma_f32_16x16x32_bf16 v[216:219], v[8:11], v[100:103], v[216:219]
    ds_read_b64_tr_b16 v[8:9], v3 offset:25472
    ds_read_b64_tr_b16 v[10:11], v3 offset:25728
    s_waitcnt lgkmcnt(6)
    v_mfma_f32_16x16x32_bf16 v[156:159], v[12:15], v[84:87], v[156:159]
    v_mfma_f32_16x16x32_bf16 v[188:191], v[12:15], v[92:95], v[188:191]
    v_mfma_f32_16x16x32_bf16 v[220:223], v[12:15], v[100:103], v[220:223]
    ds_read_b64_tr_b16 v[12:13], v3 offset:25480
    ds_read_b64_tr_b16 v[14:15], v3 offset:25736
    s_waitcnt lgkmcnt(6)
    v_mfma_f32_16x16x32_bf16 v[160:163], v[16:19], v[84:87], v[160:163]
    v_mfma_f32_16x16x32_bf16 v[192:195], v[16:19], v[92:95], v[192:195]
    v_mfma_f32_16x16x32_bf16 v[224:227], v[16:19], v[100:103], v[224:227]
    ds_read_b64_tr_b16 v[16:17], v3 offset:25536
    ds_read_b64_tr_b16 v[18:19], v3 offset:25792
    s_waitcnt lgkmcnt(6)
    v_mfma_f32_16x16x32_bf16 v[164:167], v[20:23], v[84:87], v[164:167]
    v_mfma_f32_16x16x32_bf16 v[196:199], v[20:23], v[92:95], v[196:199]
    v_mfma_f32_16x16x32_bf16 v[228:231], v[20:23], v[100:103], v[228:231]
    ds_read_b64_tr_b16 v[20:21], v3 offset:25544
    ds_read_b64_tr_b16 v[22:23], v3 offset:25800
    s_waitcnt lgkmcnt(6)
    v_mfma_f32_16x16x32_bf16 v[168:171], v[8:11], v[84:87], v[168:171]
    v_mfma_f32_16x16x32_bf16 v[200:203], v[8:11], v[92:95], v[200:203]
    v_mfma_f32_16x16x32_bf16 v[232:235], v[8:11], v[100:103], v[232:235]
    s_waitcnt lgkmcnt(4)
    v_mfma_f32_16x16x32_bf16 v[172:175], v[12:15], v[84:87], v[172:175]
    v_mfma_f32_16x16x32_bf16 v[204:207], v[12:15], v[92:95], v[204:207]
    v_mfma_f32_16x16x32_bf16 v[236:239], v[12:15], v[100:103], v[236:239]
    s_waitcnt vmcnt(4) lgkmcnt(0)
    s_barrier
    ds_read_b64_tr_b16 v[8:9], v3 offset:33792
    ds_read_b64_tr_b16 v[10:11], v3 offset:34048
    ds_read_b128 v[56:59], v54 offset:0
    ds_read_b128 v[64:67], v54 offset:2048
    ds_read_b128 v[72:75], v54 offset:4096
    ds_read_b64_tr_b16 v[12:13], v3 offset:33800
    ds_read_b64_tr_b16 v[14:15], v3 offset:34056
    v_mfma_f32_16x16x32_bf16 v[176:179], v[16:19], v[84:87], v[176:179]
    v_mfma_f32_16x16x32_bf16 v[208:211], v[16:19], v[92:95], v[208:211]
    s_add_u32 s59, s57, 3
    s_and_b32 s59, s59, 7
    s_lshl_b32 s59, s59, 7
    s_add_u32 m0, s33, 0
    s_add_u32 s42, s59, 0
    buffer_load_dwordx4 v50, s[20:23], s42 offen lds
    v_mfma_f32_16x16x32_bf16 v[240:243], v[16:19], v[100:103], v[240:243]
    ds_read_b64_tr_b16 v[16:17], v3 offset:33856
    ds_read_b64_tr_b16 v[18:19], v3 offset:34112
    ds_read_b128 v[60:63], v55 offset:0
    ds_read_b128 v[68:71], v55 offset:2048
    ds_read_b128 v[76:79], v55 offset:4096
    v_mfma_f32_16x16x32_bf16 v[180:183], v[20:23], v[84:87], v[180:183]
    v_mfma_f32_16x16x32_bf16 v[212:215], v[20:23], v[92:95], v[212:215]
    s_add_u32 m0, s33, 1024
    s_add_u32 s42, s59, 8192
    buffer_load_dwordx4 v51, s[20:23], s42 offen lds
    v_mfma_f32_16x16x32_bf16 v[244:247], v[20:23], v[100:103], v[244:247]
    ds_read_b64_tr_b16 v[20:21], v3 offset:33864
    ds_read_b64_tr_b16 v[22:23], v3 offset:34120
    s_waitcnt lgkmcnt(9)
    v_mfma_f32_16x16x32_bf16 v[152:155], v[8:11], v[56:59], v[152:155]
    v_mfma_f32_16x16x32_bf16 v[184:187], v[8:11], v[64:67], v[184:187]
    s_add_u32 m0, s33, 2048
    s_add_u32 s42, s59, 16384
    buffer_load_dwordx4 v50, s[20:23], s42 offen lds
    v_mfma_f32_16x16x32_bf16 v[216:219], v[8:11], v[72:75], v[216:219]
    ds_read_b64_tr_b16 v[8:9], v3 offset:33920
    ds_read_b64_tr_b16 v[10:11], v3 offset:34176
    s_waitcnt lgkmcnt(9)
    v_mfma_f32_16x16x32_bf16 v[156:159], v[12:15], v[56:59], v[156:159]
    v_mfma_f32_16x16x32_bf16 v[188:191], v[12:15], v[64:67], v[188:191]
    s_add_u32 s58, s57, 4
    s_and_b32 s58, s58, 7
    s_lshl_b32 s58, s58, 19
    s_add_u32 m0, s34, 16896
    s_add_u32 s30, s58, 0
    buffer_load_dwordx4 v5, s[16:19], s30 offen lds
    v_mfma_f32_16x16x32_bf16 v[220:223], v[12:15], v[72:75], v[220:223]
    ds_read_b64_tr_b16 v[12:13], v3 offset:33928
    ds_read_b64_tr_b16 v[14:15], v3 offset:34184
    s_waitcnt lgkmcnt(9)
    v_mfma_f32_16x16x32_bf16 v[160:163], v[16:19], v[56:59], v[160:163]
    v_mfma_f32_16x16x32_bf16 v[192:195], v[16:19], v[64:67], v[192:195]
    s_add_u32 m0, s34, 17952
    s_add_u32 s30, s58, 8192
    buffer_load_dwordx4 v5, s[16:19], s30 offen lds
    v_mfma_f32_16x16x32_bf16 v[224:227], v[16:19], v[72:75], v[224:227]
    ds_read_b64_tr_b16 v[16:17], v3 offset:33984
    ds_read_b64_tr_b16 v[18:19], v3 offset:34240
    s_waitcnt lgkmcnt(6)
    v_mfma_f32_16x16x32_bf16 v[164:167], v[20:23], v[56:59], v[164:167]
    v_mfma_f32_16x16x32_bf16 v[196:199], v[20:23], v[64:67], v[196:199]
    s_add_u32 m0, s34, 25344
    s_add_u32 s30, s58, 262144
    buffer_load_dwordx4 v5, s[16:19], s30 offen lds
    v_mfma_f32_16x16x32_bf16 v[228:231], v[20:23], v[72:75], v[228:231]
    ds_read_b64_tr_b16 v[20:21], v3 offset:33992
    ds_read_b64_tr_b16 v[22:23], v3 offset:34248
    s_waitcnt lgkmcnt(6)
    v_mfma_f32_16x16x32_bf16 v[168:171], v[8:11], v[56:59], v[168:171]
    v_mfma_f32_16x16x32_bf16 v[200:203], v[8:11], v[64:67], v[200:203]
    s_add_u32 m0, s34, 26400
    s_add_u32 s30, s58, 270336
    buffer_load_dwordx4 v5, s[16:19], s30 offen lds
    v_mfma_f32_16x16x32_bf16 v[232:235], v[8:11], v[72:75], v[232:235]
    ds_read_b64_tr_b16 v[8:9], v3 offset:42240
    ds_read_b64_tr_b16 v[10:11], v3 offset:42496
    s_waitcnt lgkmcnt(6)
    v_mfma_f32_16x16x32_bf16 v[172:175], v[12:15], v[56:59], v[172:175]
    v_mfma_f32_16x16x32_bf16 v[204:207], v[12:15], v[64:67], v[204:207]
    v_mfma_f32_16x16x32_bf16 v[236:239], v[12:15], v[72:75], v[236:239]
    ds_read_b64_tr_b16 v[12:13], v3 offset:42248
    ds_read_b64_tr_b16 v[14:15], v3 offset:42504
    s_waitcnt lgkmcnt(6)
    v_mfma_f32_16x16x32_bf16 v[176:179], v[16:19], v[56:59], v[176:179]
    v_mfma_f32_16x16x32_bf16 v[208:211], v[16:19], v[64:67], v[208:211]
    v_mfma_f32_16x16x32_bf16 v[240:243], v[16:19], v[72:75], v[240:243]
    ds_read_b64_tr_b16 v[16:17], v3 offset:42304
    ds_read_b64_tr_b16 v[18:19], v3 offset:42560
    s_waitcnt lgkmcnt(6)
    v_mfma_f32_16x16x32_bf16 v[180:183], v[20:23], v[56:59], v[180:183]
    v_mfma_f32_16x16x32_bf16 v[212:215], v[20:23], v[64:67], v[212:215]
    v_mfma_f32_16x16x32_bf16 v[244:247], v[20:23], v[72:75], v[244:247]
    ds_read_b64_tr_b16 v[20:21], v3 offset:42312
    ds_read_b64_tr_b16 v[22:23], v3 offset:42568
    s_waitcnt lgkmcnt(6)
    v_mfma_f32_16x16x32_bf16 v[152:155], v[8:11], v[60:63], v[152:155]
    v_mfma_f32_16x16x32_bf16 v[184:187], v[8:11], v[68:71], v[184:187]
    v_mfma_f32_16x16x32_bf16 v[216:219], v[8:11], v[76:79], v[216:219]
    ds_read_b64_tr_b16 v[8:9], v3 offset:42368
    ds_read_b64_tr_b16 v[10:11], v3 offset:42624
    s_waitcnt lgkmcnt(6)
    v_mfma_f32_16x16x32_bf16 v[156:159], v[12:15], v[60:63], v[156:159]
    v_mfma_f32_16x16x32_bf16 v[188:191], v[12:15], v[68:71], v[188:191]
    v_mfma_f32_16x16x32_bf16 v[220:223], v[12:15], v[76:79], v[220:223]
    ds_read_b64_tr_b16 v[12:13], v3 offset:42376
    ds_read_b64_tr_b16 v[14:15], v3 offset:42632
    s_waitcnt lgkmcnt(6)
    v_mfma_f32_16x16x32_bf16 v[160:163], v[16:19], v[60:63], v[160:163]
    v_mfma_f32_16x16x32_bf16 v[192:195], v[16:19], v[68:71], v[192:195]
    v_mfma_f32_16x16x32_bf16 v[224:227], v[16:19], v[76:79], v[224:227]
    ds_read_b64_tr_b16 v[16:17], v3 offset:42432
    ds_read_b64_tr_b16 v[18:19], v3 offset:42688
    s_waitcnt lgkmcnt(6)
    v_mfma_f32_16x16x32_bf16 v[164:167], v[20:23], v[60:63], v[164:167]
    v_mfma_f32_16x16x32_bf16 v[196:199], v[20:23], v[68:71], v[196:199]
    v_mfma_f32_16x16x32_bf16 v[228:231], v[20:23], v[76:79], v[228:231]
    ds_read_b64_tr_b16 v[20:21], v3 offset:42440
    ds_read_b64_tr_b16 v[22:23], v3 offset:42696
    s_waitcnt lgkmcnt(6)
    v_mfma_f32_16x16x32_bf16 v[168:171], v[8:11], v[60:63], v[168:171]
    v_mfma_f32_16x16x32_bf16 v[200:203], v[8:11], v[68:71], v[200:203]
    v_mfma_f32_16x16x32_bf16 v[232:235], v[8:11], v[76:79], v[232:235]
    s_waitcnt lgkmcnt(4)
    v_mfma_f32_16x16x32_bf16 v[172:175], v[12:15], v[60:63], v[172:175]
    v_mfma_f32_16x16x32_bf16 v[204:207], v[12:15], v[68:71], v[204:207]
    v_mfma_f32_16x16x32_bf16 v[236:239], v[12:15], v[76:79], v[236:239]
    s_waitcnt vmcnt(4) lgkmcnt(0)
    s_barrier
    ds_read_b64_tr_b16 v[8:9], v3 offset:0
    ds_read_b64_tr_b16 v[10:11], v3 offset:256
    ds_read_b128 v[80:83], v52 offset:0
    ds_read_b128 v[88:91], v52 offset:2048
    ds_read_b128 v[96:99], v52 offset:4096
    ds_read_b64_tr_b16 v[12:13], v3 offset:8
    ds_read_b64_tr_b16 v[14:15], v3 offset:264
    v_mfma_f32_16x16x32_bf16 v[176:179], v[16:19], v[60:63], v[176:179]
    v_mfma_f32_16x16x32_bf16 v[208:211], v[16:19], v[68:71], v[208:211]
    s_add_u32 s59, s57, 4
    s_and_b32 s59, s59, 7
    s_lshl_b32 s59, s59, 7
    s_add_u32 m0, s32, 0
    s_add_u32 s42, s59, 0
    buffer_load_dwordx4 v50, s[20:23], s42 offen lds
    v_mfma_f32_16x16x32_bf16 v[240:243], v[16:19], v[76:79], v[240:243]
    ds_read_b64_tr_b16 v[16:17], v3 offset:64
    ds_read_b64_tr_b16 v[18:19], v3 offset:320
    ds_read_b128 v[84:87], v53 offset:0
    ds_read_b128 v[92:95], v53 offset:2048
    ds_read_b128 v[100:103], v53 offset:4096
    v_mfma_f32_16x16x32_bf16 v[180:183], v[20:23], v[60:63], v[180:183]
    v_mfma_f32_16x16x32_bf16 v[212:215], v[20:23], v[68:71], v[212:215]
    s_add_u32 m0, s32, 1024
    s_add_u32 s42, s59, 8192
    buffer_load_dwordx4 v51, s[20:23], s42 offen lds
    v_mfma_f32_16x16x32_bf16 v[244:247], v[20:23], v[76:79], v[244:247]
    ds_read_b64_tr_b16 v[20:21], v3 offset:72
    ds_read_b64_tr_b16 v[22:23], v3 offset:328
    s_waitcnt lgkmcnt(9)
    v_mfma_f32_16x16x32_bf16 v[152:155], v[8:11], v[80:83], v[152:155]
    v_mfma_f32_16x16x32_bf16 v[184:187], v[8:11], v[88:91], v[184:187]
    s_add_u32 m0, s32, 2048
    s_add_u32 s42, s59, 16384
    buffer_load_dwordx4 v50, s[20:23], s42 offen lds
    v_mfma_f32_16x16x32_bf16 v[216:219], v[8:11], v[96:99], v[216:219]
    ds_read_b64_tr_b16 v[8:9], v3 offset:128
    ds_read_b64_tr_b16 v[10:11], v3 offset:384
    s_waitcnt lgkmcnt(9)
    v_mfma_f32_16x16x32_bf16 v[156:159], v[12:15], v[80:83], v[156:159]
    v_mfma_f32_16x16x32_bf16 v[188:191], v[12:15], v[88:91], v[188:191]
    s_add_u32 s28, s54, 0
    s_and_b32 s28, s28, 31
    s_lshl_b32 s28, s28, 13
    s_add_u32 m0, s34, 33792
    s_nop 0
    buffer_load_dwordx4 v4, s[8:11], s28 offen offset:0 nt lds
    v_mfma_f32_16x16x32_bf16 v[220:223], v[12:15], v[96:99], v[220:223]
    ds_read_b64_tr_b16 v[12:13], v3 offset:136
    ds_read_b64_tr_b16 v[14:15], v3 offset:392
    s_waitcnt lgkmcnt(9)
    v_mfma_f32_16x16x32_bf16 v[160:163], v[16:19], v[80:83], v[160:163]
    v_mfma_f32_16x16x32_bf16 v[192:195], v[16:19], v[88:91], v[192:195]
    s_add_u32 m0, s34, 34592
    s_nop 0
    buffer_load_dwordx4 v4, s[8:11], s28 offen offset:256 nt lds
    v_mfma_f32_16x16x32_bf16 v[224:227], v[16:19], v[96:99], v[224:227]
    ds_read_b64_tr_b16 v[16:17], v3 offset:192
    ds_read_b64_tr_b16 v[18:19], v3 offset:448
    s_waitcnt lgkmcnt(6)
    v_mfma_f32_16x16x32_bf16 v[164:167], v[20:23], v[80:83], v[164:167]
    v_mfma_f32_16x16x32_bf16 v[196:199], v[20:23], v[88:91], v[196:199]
    s_add_u32 s28, s54, 1
    s_and_b32 s28, s28, 31
    s_lshl_b32 s28, s28, 13
    s_add_u32 m0, s34, 42240
    s_nop 0
    buffer_load_dwordx4 v4, s[8:11], s28 offen offset:0 nt lds
    v_mfma_f32_16x16x32_bf16 v[228:231], v[20:23], v[96:99], v[228:231]
    ds_read_b64_tr_b16 v[20:21], v3 offset:200
    ds_read_b64_tr_b16 v[22:23], v3 offset:456
    s_waitcnt lgkmcnt(6)
    v_mfma_f32_16x16x32_bf16 v[168:171], v[8:11], v[80:83], v[168:171]
    v_mfma_f32_16x16x32_bf16 v[200:203], v[8:11], v[88:91], v[200:203]
    s_add_u32 m0, s34, 43040
    s_nop 0
    buffer_load_dwordx4 v4, s[8:11], s28 offen offset:256 nt lds
    v_mfma_f32_16x16x32_bf16 v[232:235], v[8:11], v[96:99], v[232:235]
    ds_read_b64_tr_b16 v[8:9], v3 offset:8448
    ds_read_b64_tr_b16 v[10:11], v3 offset:8704
    s_waitcnt lgkmcnt(6)
    v_mfma_f32_16x16x32_bf16 v[172:175], v[12:15], v[80:83], v[172:175]
    v_mfma_f32_16x16x32_bf16 v[204:207], v[12:15], v[88:91], v[204:207]
    s_lshl_b32 s87, s54, 13
    s_and_b32 s87, s87, 0x3e000
    buffer_load_dword v254, v7, s[12:15], s87 offen nt
    v_mfma_f32_16x16x32_bf16 v[236:239], v[12:15], v[96:99], v[236:239]
    ds_read_b64_tr_b16 v[12:13], v3 offset:8456
    ds_read_b64_tr_b16 v[14:15], v3 offset:8712
    s_waitcnt lgkmcnt(6)
    v_mfma_f32_16x16x32_bf16 v[176:179], v[16:19], v[80:83], v[176:179]
    v_mfma_f32_16x16x32_bf16 v[208:211], v[16:19], v[88:91], v[208:211]
    v_mfma_f32_16x16x32_bf16 v[240:243], v[16:19], v[96:99], v[240:243]
    ds_read_b64_tr_b16 v[16:17], v3 offset:8512
    ds_read_b64_tr_b16 v[18:19], v3 offset:8768
    s_waitcnt lgkmcnt(6)
    v_mfma_f32_16x16x32_bf16 v[180:183], v[20:23], v[80:83], v[180:183]
    v_mfma_f32_16x16x32_bf16 v[212:215], v[20:23], v[88:91], v[212:215]
    v_mfma_f32_16x16x32_bf16 v[244:247], v[20:23], v[96:99], v[244:247]
    ds_read_b64_tr_b16 v[20:21], v3 offset:8520
    ds_read_b64_tr_b16 v[22:23], v3 offset:8776
    s_waitcnt lgkmcnt(6)
    v_mfma_f32_16x16x32_bf16 v[152:155], v[8:11], v[84:87], v[152:155]
    v_mfma_f32_16x16x32_bf16 v[184:187], v[8:11], v[92:95], v[184:187]
    v_mfma_f32_16x16x32_bf16 v[216:219], v[8:11], v[100:103], v[216:219]
    ds_read_b64_tr_b16 v[8:9], v3 offset:8576
    ds_read_b64_tr_b16 v[10:11], v3 offset:8832
    s_waitcnt lgkmcnt(6)
    v_mfma_f32_16x16x32_bf16 v[156:159], v[12:15], v[84:87], v[156:159]
    v_mfma_f32_16x16x32_bf16 v[188:191], v[12:15], v[92:95], v[188:191]
    v_mfma_f32_16x16x32_bf16 v[220:223], v[12:15], v[100:103], v[220:223]
    ds_read_b64_tr_b16 v[12:13], v3 offset:8584
    ds_read_b64_tr_b16 v[14:15], v3 offset:8840
    s_waitcnt lgkmcnt(6)
    v_mfma_f32_16x16x32_bf16 v[160:163], v[16:19], v[84:87], v[160:163]
    v_mfma_f32_16x16x32_bf16 v[192:195], v[16:19], v[92:95], v[192:195]
    v_mfma_f32_16x16x32_bf16 v[224:227], v[16:19], v[100:103], v[224:227]
    ds_read_b64_tr_b16 v[16:17], v3 offset:8640
    ds_read_b64_tr_b16 v[18:19], v3 offset:8896
    s_waitcnt lgkmcnt(6)
    v_mfma_f32_16x16x32_bf16 v[164:167], v[20:23], v[84:87], v[164:167]
    v_mfma_f32_16x16x32_bf16 v[196:199], v[20:23], v[92:95], v[196:199]
    v_mfma_f32_16x16x32_bf16 v[228:231], v[20:23], v[100:103], v[228:231]
    ds_read_b64_tr_b16 v[20:21], v3 offset:8648
    ds_read_b64_tr_b16 v[22:23], v3 offset:8904
    s_waitcnt lgkmcnt(6)
    v_mfma_f32_16x16x32_bf16 v[168:171], v[8:11], v[84:87], v[168:171]
    v_mfma_f32_16x16x32_bf16 v[200:203], v[8:11], v[92:95], v[200:203]
    v_mfma_f32_16x16x32_bf16 v[232:235], v[8:11], v[100:103], v[232:235]
    s_waitcnt lgkmcnt(4)
    v_mfma_f32_16x16x32_bf16 v[172:175], v[12:15], v[84:87], v[172:175]
    v_mfma_f32_16x16x32_bf16 v[204:207], v[12:15], v[92:95], v[204:207]
    v_mfma_f32_16x16x32_bf16 v[236:239], v[12:15], v[100:103], v[236:239]
    s_waitcnt vmcnt(5) lgkmcnt(0)
    s_barrier
    ds_read_b64_tr_b16 v[8:9], v3 offset:16896
    ds_read_b64_tr_b16 v[10:11], v3 offset:17152
    ds_read_b128 v[56:59], v54 offset:0
    ds_read_b128 v[64:67], v54 offset:2048
    ds_read_b128 v[72:75], v54 offset:4096
    ds_read_b64_tr_b16 v[12:13], v3 offset:16904
    ds_read_b64_tr_b16 v[14:15], v3 offset:17160
    v_mfma_f32_16x16x32_bf16 v[176:179], v[16:19], v[84:87], v[176:179]
    v_mfma_f32_16x16x32_bf16 v[208:211], v[16:19], v[92:95], v[208:211]
    s_add_u32 s59, s57, 5
    s_and_b32 s59, s59, 7
    s_lshl_b32 s59, s59, 7
    s_add_u32 m0, s33, 0
    s_add_u32 s42, s59, 0
    buffer_load_dwordx4 v50, s[20:23], s42 offen lds
    v_mfma_f32_16x16x32_bf16 v[240:243], v[16:19], v[100:103], v[240:243]
    ds_read_b64_tr_b16 v[16:17], v3 offset:16960
    ds_read_b64_tr_b16 v[18:19], v3 offset:17216
    ds_read_b128 v[60:63], v55 offset:0
    ds_read_b128 v[68:71], v55 offset:2048
    ds_read_b128 v[76:79], v55 offset:4096
    v_mfma_f32_16x16x32_bf16 v[180:183], v[20:23], v[84:87], v[180:183]
    v_mfma_f32_16x16x32_bf16 v[212:215], v[20:23], v[92:95], v[212:215]
    s_add_u32 m0, s33, 1024
    s_add_u32 s42, s59, 8192
    buffer_load_dwordx4 v51, s[20:23], s42 offen lds
    v_mfma_f32_16x16x32_bf16 v[244:247], v[20:23], v[100:103], v[244:247]
    ds_read_b64_tr_b16 v[20:21], v3 offset:16968
    ds_read_b64_tr_b16 v[22:23], v3 offset:17224
    s_waitcnt lgkmcnt(9)
    v_mfma_f32_16x16x32_bf16 v[152:155], v[8:11], v[56:59], v[152:155]
    v_mfma_f32_16x16x32_bf16 v[184:187], v[8:11], v[64:67], v[184:187]
    s_add_u32 m0, s33, 2048
    s_add_u32 s42, s59, 16384
    buffer_load_dwordx4 v50, s[20:23], s42 offen lds
    v_mfma_f32_16x16x32_bf16 v[216:219], v[8:11], v[72:75], v[216:219]
    ds_read_b64_tr_b16 v[8:9], v3 offset:17024
    ds_read_b64_tr_b16 v[10:11], v3 offset:17280
    s_waitcnt lgkmcnt(9)
    v_mfma_f32_16x16x32_bf16 v[156:159], v[12:15], v[56:59], v[156:159]
    v_mfma_f32_16x16x32_bf16 v[188:191], v[12:15], v[64:67], v[188:191]
    s_add_u32 s58, s57, 5
    s_and_b32 s58, s58, 7
    s_lshl_b32 s58, s58, 19
    s_add_u32 m0, s34, 0
    s_add_u32 s30, s58, 0
    buffer_load_dwordx4 v5, s[16:19], s30 offen lds
    v_mfma_f32_16x16x32_bf16 v[220:223], v[12:15], v[72:75], v[220:223]
    ds_read_b64_tr_b16 v[12:13], v3 offset:17032
    ds_read_b64_tr_b16 v[14:15], v3 offset:17288
    s_waitcnt lgkmcnt(9)
    v_mfma_f32_16x16x32_bf16 v[160:163], v[16:19], v[56:59], v[160:163]
    v_mfma_f32_16x16x32_bf16 v[192:195], v[16:19], v[64:67], v[192:195]
    s_add_u32 m0, s34, 1056
    s_add_u32 s30, s58, 8192
    buffer_load_dwordx4 v5, s[16:19], s30 offen lds
    v_mfma_f32_16x16x32_bf16 v[224:227], v[16:19], v[72:75], v[224:227]
    ds_read_b64_tr_b16 v[16:17], v3 offset:17088
    ds_read_b64_tr_b16 v[18:19], v3 offset:17344
    s_waitcnt lgkmcnt(6)
    v_mfma_f32_16x16x32_bf16 v[164:167], v[20:23], v[56:59], v[164:167]
    v_mfma_f32_16x16x32_bf16 v[196:199], v[20:23], v[64:67], v[196:199]
    s_add_u32 m0, s34, 8448
    s_add_u32 s30, s58, 262144
    buffer_load_dwordx4 v5, s[16:19], s30 offen lds
    v_mfma_f32_16x16x32_bf16 v[228:231], v[20:23], v[72:75], v[228:231]
    ds_read_b64_tr_b16 v[20:21], v3 offset:17096
    ds_read_b64_tr_b16 v[22:23], v3 offset:17352
    s_waitcnt lgkmcnt(6)
    v_mfma_f32_16x16x32_bf16 v[168:171], v[8:11], v[56:59], v[168:171]
    v_mfma_f32_16x16x32_bf16 v[200:203], v[8:11], v[64:67], v[200:203]
    s_add_u32 m0, s34, 9504
    s_add_u32 s30, s58, 270336
    buffer_load_dwordx4 v5, s[16:19], s30 offen lds
    v_mfma_f32_16x16x32_bf16 v[232:235], v[8:11], v[72:75], v[232:235]
    ds_read_b64_tr_b16 v[8:9], v3 offset:25344
    ds_read_b64_tr_b16 v[10:11], v3 offset:25600
    s_waitcnt lgkmcnt(6)
    v_mfma_f32_16x16x32_bf16 v[172:175], v[12:15], v[56:59], v[172:175]
    v_mfma_f32_16x16x32_bf16 v[204:207], v[12:15], v[64:67], v[204:207]
    v_mfma_f32_16x16x32_bf16 v[236:239], v[12:15], v[72:75], v[236:239]
    ds_read_b64_tr_b16 v[12:13], v3 offset:25352
    ds_read_b64_tr_b16 v[14:15], v3 offset:25608
    s_waitcnt lgkmcnt(6)
    v_mfma_f32_16x16x32_bf16 v[176:179], v[16:19], v[56:59], v[176:179]
    v_mfma_f32_16x16x32_bf16 v[208:211], v[16:19], v[64:67], v[208:211]
    v_mfma_f32_16x16x32_bf16 v[240:243], v[16:19], v[72:75], v[240:243]
    ds_read_b64_tr_b16 v[16:17], v3 offset:25408
    ds_read_b64_tr_b16 v[18:19], v3 offset:25664
    s_waitcnt lgkmcnt(6)
    v_mfma_f32_16x16x32_bf16 v[180:183], v[20:23], v[56:59], v[180:183]
    v_mfma_f32_16x16x32_bf16 v[212:215], v[20:23], v[64:67], v[212:215]
    v_mfma_f32_16x16x32_bf16 v[244:247], v[20:23], v[72:75], v[244:247]
    ds_read_b64_tr_b16 v[20:21], v3 offset:25416
    ds_read_b64_tr_b16 v[22:23], v3 offset:25672
    s_waitcnt lgkmcnt(6)
    v_mfma_f32_16x16x32_bf16 v[152:155], v[8:11], v[60:63], v[152:155]
    v_mfma_f32_16x16x32_bf16 v[184:187], v[8:11], v[68:71], v[184:187]
    v_mfma_f32_16x16x32_bf16 v[216:219], v[8:11], v[76:79], v[216:219]
    ds_read_b64_tr_b16 v[8:9], v3 offset:25472
    ds_read_b64_tr_b16 v[10:11], v3 offset:25728
    s_waitcnt lgkmcnt(6)
    v_mfma_f32_16x16x32_bf16 v[156:159], v[12:15], v[60:63], v[156:159]
    v_mfma_f32_16x16x32_bf16 v[188:191], v[12:15], v[68:71], v[188:191]
    v_mfma_f32_16x16x32_bf16 v[220:223], v[12:15], v[76:79], v[220:223]
    ds_read_b64_tr_b16 v[12:13], v3 offset:25480
    ds_read_b64_tr_b16 v[14:15], v3 offset:25736
    s_waitcnt lgkmcnt(6)
    v_mfma_f32_16x16x32_bf16 v[160:163], v[16:19], v[60:63], v[160:163]
    v_mfma_f32_16x16x32_bf16 v[192:195], v[16:19], v[68:71], v[192:195]
    v_mfma_f32_16x16x32_bf16 v[224:227], v[16:19], v[76:79], v[224:227]
    ds_read_b64_tr_b16 v[16:17], v3 offset:25536
    ds_read_b64_tr_b16 v[18:19], v3 offset:25792
    s_waitcnt lgkmcnt(6)
    v_mfma_f32_16x16x32_bf16 v[164:167], v[20:23], v[60:63], v[164:167]
    v_mfma_f32_16x16x32_bf16 v[196:199], v[20:23], v[68:71], v[196:199]
    v_mfma_f32_16x16x32_bf16 v[228:231], v[20:23], v[76:79], v[228:231]
    ds_read_b64_tr_b16 v[20:21], v3 offset:25544
    ds_read_b64_tr_b16 v[22:23], v3 offset:25800
    s_waitcnt lgkmcnt(6)
    v_mfma_f32_16x16x32_bf16 v[168:171], v[8:11], v[60:63], v[168:171]
    v_mfma_f32_16x16x32_bf16 v[200:203], v[8:11], v[68:71], v[200:203]
    v_mfma_f32_16x16x32_bf16 v[232:235], v[8:11], v[76:79], v[232:235]
    s_waitcnt lgkmcnt(4)
    v_mfma_f32_16x16x32_bf16 v[172:175], v[12:15], v[60:63], v[172:175]
    v_mfma_f32_16x16x32_bf16 v[204:207], v[12:15], v[68:71], v[204:207]
    v_mfma_f32_16x16x32_bf16 v[236:239], v[12:15], v[76:79], v[236:239]
    s_waitcnt vmcnt(0) lgkmcnt(0)
    s_barrier
    ds_read_b64_tr_b16 v[8:9], v3 offset:0
    ds_read_b64_tr_b16 v[10:11], v3 offset:256
    ds_read_b128 v[80:83], v52 offset:0
    ds_read_b128 v[88:91], v52 offset:2048
    ds_read_b128 v[96:99], v52 offset:4096
    ds_read_b64_tr_b16 v[12:13], v3 offset:8
    ds_read_b64_tr_b16 v[14:15], v3 offset:264
    v_mfma_f32_16x16x32_bf16 v[176:179], v[16:19], v[60:63], v[176:179]
    v_mfma_f32_16x16x32_bf16 v[208:211], v[16:19], v[68:71], v[208:211]
    s_add_u32 s59, s57, 6
    s_and_b32 s59, s59, 7
    s_lshl_b32 s59, s59, 7
    s_add_u32 m0, s32, 0
    s_add_u32 s42, s59, 0
    buffer_load_dwordx4 v50, s[20:23], s42 offen lds
    v_mfma_f32_16x16x32_bf16 v[240:243], v[16:19], v[76:79], v[240:243]
    ds_read_b64_tr_b16 v[16:17], v3 offset:64
    ds_read_b64_tr_b16 v[18:19], v3 offset:320
    ds_read_b128 v[84:87], v53 offset:0
    ds_read_b128 v[92:95], v53 offset:2048
    ds_read_b128 v[100:103], v53 offset:4096
    v_mfma_f32_16x16x32_bf16 v[180:183], v[20:23], v[60:63], v[180:183]
    v_mfma_f32_16x16x32_bf16 v[212:215], v[20:23], v[68:71], v[212:215]
    s_add_u32 m0, s32, 1024
    s_add_u32 s42, s59, 8192
    buffer_load_dwordx4 v51, s[20:23], s42 offen lds
    v_mfma_f32_16x16x32_bf16 v[244:247], v[20:23], v[76:79], v[244:247]
    ds_read_b64_tr_b16 v[20:21], v3 offset:72
    ds_read_b64_tr_b16 v[22:23], v3 offset:328
    s_waitcnt lgkmcnt(9)
    v_mfma_f32_16x16x32_bf16 v[152:155], v[8:11], v[80:83], v[152:155]
    v_mfma_f32_16x16x32_bf16 v[184:187], v[8:11], v[88:91], v[184:187]
    s_add_u32 m0, s32, 2048
    s_add_u32 s42, s59, 16384
    buffer_load_dwordx4 v50, s[20:23], s42 offen lds
    v_mfma_f32_16x16x32_bf16 v[216:219], v[8:11], v[96:99], v[216:219]
    ds_read_b64_tr_b16 v[8:9], v3 offset:128
    ds_read_b64_tr_b16 v[10:11], v3 offset:384
    s_waitcnt lgkmcnt(9)
    v_mfma_f32_16x16x32_bf16 v[156:159], v[12:15], v[80:83], v[156:159]
    v_mfma_f32_16x16x32_bf16 v[188:191], v[12:15], v[88:91], v[188:191]
    s_add_u32 s58, s57, 6
    s_and_b32 s58, s58, 7
    s_lshl_b32 s58, s58, 19
    s_add_u32 m0, s34, 16896
    s_add_u32 s30, s58, 0
    buffer_load_dwordx4 v5, s[16:19], s30 offen lds
    v_mfma_f32_16x16x32_bf16 v[220:223], v[12:15], v[96:99], v[220:223]
    ds_read_b64_tr_b16 v[12:13], v3 offset:136
    ds_read_b64_tr_b16 v[14:15], v3 offset:392
    s_waitcnt lgkmcnt(9)
    v_mfma_f32_16x16x32_bf16 v[160:163], v[16:19], v[80:83], v[160:163]
    v_mfma_f32_16x16x32_bf16 v[192:195], v[16:19], v[88:91], v[192:195]
    s_add_u32 m0, s34, 17952
    s_add_u32 s30, s58, 8192
    buffer_load_dwordx4 v5, s[16:19], s30 offen lds
    v_mfma_f32_16x16x32_bf16 v[224:227], v[16:19], v[96:99], v[224:227]
    ds_read_b64_tr_b16 v[16:17], v3 offset:192
    ds_read_b64_tr_b16 v[18:19], v3 offset:448
    s_waitcnt lgkmcnt(6)
    v_mfma_f32_16x16x32_bf16 v[164:167], v[20:23], v[80:83], v[164:167]
    v_mfma_f32_16x16x32_bf16 v[196:199], v[20:23], v[88:91], v[196:199]
    s_add_u32 m0, s34, 25344
    s_add_u32 s30, s58, 262144
    buffer_load_dwordx4 v5, s[16:19], s30 offen lds
    v_mfma_f32_16x16x32_bf16 v[228:231], v[20:23], v[96:99], v[228:231]
    ds_read_b64_tr_b16 v[20:21], v3 offset:200
    ds_read_b64_tr_b16 v[22:23], v3 offset:456
    s_waitcnt lgkmcnt(6)
    v_mfma_f32_16x16x32_bf16 v[168:171], v[8:11], v[80:83], v[168:171]
    v_mfma_f32_16x16x32_bf16 v[200:203], v[8:11], v[88:91], v[200:203]
    s_add_u32 m0, s34, 26400
    s_add_u32 s30, s58, 270336
    buffer_load_dwordx4 v5, s[16:19], s30 offen lds
    v_mfma_f32_16x16x32_bf16 v[232:235], v[8:11], v[96:99], v[232:235]
    ds_read_b64_tr_b16 v[8:9], v3 offset:8448
    ds_read_b64_tr_b16 v[10:11], v3 offset:8704
    s_waitcnt lgkmcnt(6)
    v_mfma_f32_16x16x32_bf16 v[172:175], v[12:15], v[80:83], v[172:175]
    v_mfma_f32_16x16x32_bf16 v[204:207], v[12:15], v[88:91], v[204:207]
    v_mfma_f32_16x16x32_bf16 v[236:239], v[12:15], v[96:99], v[236:239]
    ds_read_b64_tr_b16 v[12:13], v3 offset:8456
    ds_read_b64_tr_b16 v[14:15], v3 offset:8712
    s_waitcnt lgkmcnt(6)
    v_mfma_f32_16x16x32_bf16 v[176:179], v[16:19], v[80:83], v[176:179]
    v_mfma_f32_16x16x32_bf16 v[208:211], v[16:19], v[88:91], v[208:211]
    v_mfma_f32_16x16x32_bf16 v[240:243], v[16:19], v[96:99], v[240:243]
    ds_read_b64_tr_b16 v[16:17], v3 offset:8512
    ds_read_b64_tr_b16 v[18:19], v3 offset:8768
    s_waitcnt lgkmcnt(6)
    v_mfma_f32_16x16x32_bf16 v[180:183], v[20:23], v[80:83], v[180:183]
    v_mfma_f32_16x16x32_bf16 v[212:215], v[20:23], v[88:91], v[212:215]
    v_mfma_f32_16x16x32_bf16 v[244:247], v[20:23], v[96:99], v[244:247]
    ds_read_b64_tr_b16 v[20:21], v3 offset:8520
    ds_read_b64_tr_b16 v[22:23], v3 offset:8776
    s_waitcnt lgkmcnt(6)
    v_mfma_f32_16x16x32_bf16 v[152:155], v[8:11], v[84:87], v[152:155]
    v_mfma_f32_16x16x32_bf16 v[184:187], v[8:11], v[92:95], v[184:187]
    v_mfma_f32_16x16x32_bf16 v[216:219], v[8:11], v[100:103], v[216:219]
    ds_read_b64_tr_b16 v[8:9], v3 offset:8576
    ds_read_b64_tr_b16 v[10:11], v3 offset:8832
    s_waitcnt lgkmcnt(6)
    v_mfma_f32_16x16x32_bf16 v[156:159], v[12:15], v[84:87], v[156:159]
    v_mfma_f32_16x16x32_bf16 v[188:191], v[12:15], v[92:95], v[188:191]
    v_mfma_f32_16x16x32_bf16 v[220:223], v[12:15], v[100:103], v[220:223]
    ds_read_b64_tr_b16 v[12:13], v3 offset:8584
    ds_read_b64_tr_b16 v[14:15], v3 offset:8840
    s_waitcnt lgkmcnt(6)
    v_mfma_f32_16x16x32_bf16 v[160:163], v[16:19], v[84:87], v[160:163]
    v_mfma_f32_16x16x32_bf16 v[192:195], v[16:19], v[92:95], v[192:195]
    v_mfma_f32_16x16x32_bf16 v[224:227], v[16:19], v[100:103], v[224:227]
    ds_read_b64_tr_b16 v[16:17], v3 offset:8640
    ds_read_b64_tr_b16 v[18:19], v3 offset:8896
    s_waitcnt lgkmcnt(6)
    v_mfma_f32_16x16x32_bf16 v[164:167], v[20:23], v[84:87], v[164:167]
    v_mfma_f32_16x16x32_bf16 v[196:199], v[20:23], v[92:95], v[196:199]
    v_mfma_f32_16x16x32_bf16 v[228:231], v[20:23], v[100:103], v[228:231]
    ds_read_b64_tr_b16 v[20:21], v3 offset:8648
    ds_read_b64_tr_b16 v[22:23], v3 offset:8904
    s_waitcnt lgkmcnt(6)
    v_mfma_f32_16x16x32_bf16 v[168:171], v[8:11], v[84:87], v[168:171]
    v_mfma_f32_16x16x32_bf16 v[200:203], v[8:11], v[92:95], v[200:203]
    v_mfma_f32_16x16x32_bf16 v[232:235], v[8:11], v[100:103], v[232:235]
    s_waitcnt lgkmcnt(4)
    v_mfma_f32_16x16x32_bf16 v[172:175], v[12:15], v[84:87], v[172:175]
    v_mfma_f32_16x16x32_bf16 v[204:207], v[12:15], v[92:95], v[204:207]
    v_mfma_f32_16x16x32_bf16 v[236:239], v[12:15], v[100:103], v[236:239]
    s_waitcnt vmcnt(0) lgkmcnt(0)
    s_barrier
    ds_read_b64_tr_b16 v[8:9], v3 offset:16896
    ds_read_b64_tr_b16 v[10:11], v3 offset:17152
    ds_read_b128 v[56:59], v54 offset:0
    ds_read_b128 v[64:67], v54 offset:2048
    ds_read_b128 v[72:75], v54 offset:4096
    ds_read_b64_tr_b16 v[12:13], v3 offset:16904
    ds_read_b64_tr_b16 v[14:15], v3 offset:17160
    v_mfma_f32_16x16x32_bf16 v[176:179], v[16:19], v[84:87], v[176:179]
    v_mfma_f32_16x16x32_bf16 v[208:211], v[16:19], v[92:95], v[208:211]
    s_add_u32 s59, s57, 7
    s_and_b32 s59, s59, 7
    s_lshl_b32 s59, s59, 7
    s_add_u32 m0, s33, 0
    s_add_u32 s42, s59, 0
    buffer_load_dwordx4 v50, s[20:23], s42 offen lds
    v_mfma_f32_16x16x32_bf16 v[240:243], v[16:19], v[100:103], v[240:243]
    ds_read_b64_tr_b16 v[16:17], v3 offset:16960
    ds_read_b64_tr_b16 v[18:19], v3 offset:17216
    ds_read_b128 v[60:63], v55 offset:0
    ds_read_b128 v[68:71], v55 offset:2048
    ds_read_b128 v[76:79], v55 offset:4096
    v_mfma_f32_16x16x32_bf16 v[180:183], v[20:23], v[84:87], v[180:183]
    v_mfma_f32_16x16x32_bf16 v[212:215], v[20:23], v[92:95], v[212:215]
    s_add_u32 m0, s33, 1024
    s_add_u32 s42, s59, 8192
    buffer_load_dwordx4 v51, s[20:23], s42 offen lds
    v_mfma_f32_16x16x32_bf16 v[244:247], v[20:23], v[100:103], v[244:247]
    ds_read_b64_tr_b16 v[20:21], v3 offset:16968
    ds_read_b64_tr_b16 v[22:23], v3 offset:17224
    s_waitcnt lgkmcnt(9)
    v_mfma_f32_16x16x32_bf16 v[152:155], v[8:11], v[56:59], v[152:155]
    v_mfma_f32_16x16x32_bf16 v[184:187], v[8:11], v[64:67], v[184:187]
    s_add_u32 m0, s33, 2048
    s_add_u32 s42, s59, 16384
    buffer_load_dwordx4 v50, s[20:23], s42 offen lds
    v_mfma_f32_16x16x32_bf16 v[216:219], v[8:11], v[72:75], v[216:219]
    ds_read_b64_tr_b16 v[8:9], v3 offset:17024
    ds_read_b64_tr_b16 v[10:11], v3 offset:17280
    s_waitcnt lgkmcnt(9)
    v_mfma_f32_16x16x32_bf16 v[156:159], v[12:15], v[56:59], v[156:159]
    v_mfma_f32_16x16x32_bf16 v[188:191], v[12:15], v[64:67], v[188:191]
    s_add_u32 s58, s57, 7
    s_and_b32 s58, s58, 7
    s_lshl_b32 s58, s58, 19
    s_add_u32 m0, s34, 0
    s_add_u32 s30, s58, 0
    buffer_load_dwordx4 v5, s[16:19], s30 offen lds
    v_mfma_f32_16x16x32_bf16 v[220:223], v[12:15], v[72:75], v[220:223]
    ds_read_b64_tr_b16 v[12:13], v3 offset:17032
    ds_read_b64_tr_b16 v[14:15], v3 offset:17288
    s_waitcnt lgkmcnt(9)
    v_mfma_f32_16x16x32_bf16 v[160:163], v[16:19], v[56:59], v[160:163]
    v_mfma_f32_16x16x32_bf16 v[192:195], v[16:19], v[64:67], v[192:195]
    s_add_u32 m0, s34, 1056
    s_add_u32 s30, s58, 8192
    buffer_load_dwordx4 v5, s[16:19], s30 offen lds
    v_mfma_f32_16x16x32_bf16 v[224:227], v[16:19], v[72:75], v[224:227]
    ds_read_b64_tr_b16 v[16:17], v3 offset:17088
    ds_read_b64_tr_b16 v[18:19], v3 offset:17344
    s_waitcnt lgkmcnt(6)
    v_mfma_f32_16x16x32_bf16 v[164:167], v[20:23], v[56:59], v[164:167]
    v_mfma_f32_16x16x32_bf16 v[196:199], v[20:23], v[64:67], v[196:199]
    s_add_u32 m0, s34, 8448
    s_add_u32 s30, s58, 262144
    buffer_load_dwordx4 v5, s[16:19], s30 offen lds
    v_mfma_f32_16x16x32_bf16 v[228:231], v[20:23], v[72:75], v[228:231]
    ds_read_b64_tr_b16 v[20:21], v3 offset:17096
    ds_read_b64_tr_b16 v[22:23], v3 offset:17352
    s_waitcnt lgkmcnt(6)
    v_mfma_f32_16x16x32_bf16 v[168:171], v[8:11], v[56:59], v[168:171]
    v_mfma_f32_16x16x32_bf16 v[200:203], v[8:11], v[64:67], v[200:203]
    s_add_u32 m0, s34, 9504
    s_add_u32 s30, s58, 270336
    buffer_load_dwordx4 v5, s[16:19], s30 offen lds
    v_mfma_f32_16x16x32_bf16 v[232:235], v[8:11], v[72:75], v[232:235]
    ds_read_b64_tr_b16 v[8:9], v3 offset:25344
    ds_read_b64_tr_b16 v[10:11], v3 offset:25600
    s_waitcnt lgkmcnt(6)
    v_mfma_f32_16x16x32_bf16 v[172:175], v[12:15], v[56:59], v[172:175]
    v_mfma_f32_16x16x32_bf16 v[204:207], v[12:15], v[64:67], v[204:207]
    v_mfma_f32_16x16x32_bf16 v[236:239], v[12:15], v[72:75], v[236:239]
    ds_read_b64_tr_b16 v[12:13], v3 offset:25352
    ds_read_b64_tr_b16 v[14:15], v3 offset:25608
    s_waitcnt lgkmcnt(6)
    v_mfma_f32_16x16x32_bf16 v[176:179], v[16:19], v[56:59], v[176:179]
    v_mfma_f32_16x16x32_bf16 v[208:211], v[16:19], v[64:67], v[208:211]
    v_mfma_f32_16x16x32_bf16 v[240:243], v[16:19], v[72:75], v[240:243]
    ds_read_b64_tr_b16 v[16:17], v3 offset:25408
    ds_read_b64_tr_b16 v[18:19], v3 offset:25664
    s_waitcnt lgkmcnt(6)
    v_mfma_f32_16x16x32_bf16 v[180:183], v[20:23], v[56:59], v[180:183]
    v_mfma_f32_16x16x32_bf16 v[212:215], v[20:23], v[64:67], v[212:215]
    v_mfma_f32_16x16x32_bf16 v[244:247], v[20:23], v[72:75], v[244:247]
    ds_read_b64_tr_b16 v[20:21], v3 offset:25416
    ds_read_b64_tr_b16 v[22:23], v3 offset:25672
    s_waitcnt lgkmcnt(6)
    v_mfma_f32_16x16x32_bf16 v[152:155], v[8:11], v[60:63], v[152:155]
    v_mfma_f32_16x16x32_bf16 v[184:187], v[8:11], v[68:71], v[184:187]
    v_mfma_f32_16x16x32_bf16 v[216:219], v[8:11], v[76:79], v[216:219]
    ds_read_b64_tr_b16 v[8:9], v3 offset:25472
    ds_read_b64_tr_b16 v[10:11], v3 offset:25728
    s_waitcnt lgkmcnt(6)
    v_mfma_f32_16x16x32_bf16 v[156:159], v[12:15], v[60:63], v[156:159]
    v_mfma_f32_16x16x32_bf16 v[188:191], v[12:15], v[68:71], v[188:191]
    v_mfma_f32_16x16x32_bf16 v[220:223], v[12:15], v[76:79], v[220:223]
    ds_read_b64_tr_b16 v[12:13], v3 offset:25480
    ds_read_b64_tr_b16 v[14:15], v3 offset:25736
    s_waitcnt lgkmcnt(6)
    v_mfma_f32_16x16x32_bf16 v[160:163], v[16:19], v[60:63], v[160:163]
    v_mfma_f32_16x16x32_bf16 v[192:195], v[16:19], v[68:71], v[192:195]
    v_mfma_f32_16x16x32_bf16 v[224:227], v[16:19], v[76:79], v[224:227]
    ds_read_b64_tr_b16 v[16:17], v3 offset:25536
    ds_read_b64_tr_b16 v[18:19], v3 offset:25792
    s_waitcnt lgkmcnt(6)
    v_mfma_f32_16x16x32_bf16 v[164:167], v[20:23], v[60:63], v[164:167]
    v_mfma_f32_16x16x32_bf16 v[196:199], v[20:23], v[68:71], v[196:199]
    v_mfma_f32_16x16x32_bf16 v[228:231], v[20:23], v[76:79], v[228:231]
    ds_read_b64_tr_b16 v[20:21], v3 offset:25544
    ds_read_b64_tr_b16 v[22:23], v3 offset:25800
    s_waitcnt lgkmcnt(6)
    v_mfma_f32_16x16x32_bf16 v[168:171], v[8:11], v[60:63], v[168:171]
    v_mfma_f32_16x16x32_bf16 v[200:203], v[8:11], v[68:71], v[200:203]
    v_mfma_f32_16x16x32_bf16 v[232:235], v[8:11], v[76:79], v[232:235]
    s_waitcnt lgkmcnt(4)
    v_mfma_f32_16x16x32_bf16 v[172:175], v[12:15], v[60:63], v[172:175]
    v_mfma_f32_16x16x32_bf16 v[204:207], v[12:15], v[68:71], v[204:207]
    v_mfma_f32_16x16x32_bf16 v[236:239], v[12:15], v[76:79], v[236:239]
    s_waitcnt vmcnt(0) lgkmcnt(0)
    s_barrier
    ds_read_b64_tr_b16 v[8:9], v3 offset:0
    ds_read_b64_tr_b16 v[10:11], v3 offset:256
    ds_read_b128 v[80:83], v52 offset:0
    ds_read_b128 v[88:91], v52 offset:2048
    ds_read_b128 v[96:99], v52 offset:4096
    ds_read_b64_tr_b16 v[12:13], v3 offset:8
    ds_read_b64_tr_b16 v[14:15], v3 offset:264
    v_mfma_f32_16x16x32_bf16 v[176:179], v[16:19], v[60:63], v[176:179]
    v_mfma_f32_16x16x32_bf16 v[208:211], v[16:19], v[68:71], v[208:211]
    s_add_u32 s29, s54, 0
    s_and_b32 s29, s29, 31
    s_lshl_b32 s29, s29, 13
    s_add_u32 m0, s34, 16896
    s_nop 0
    buffer_load_dwordx4 v4, s[12:15], s29 offen offset:0 nt lds
    v_mfma_f32_16x16x32_bf16 v[240:243], v[16:19], v[76:79], v[240:243]
    ds_read_b64_tr_b16 v[16:17], v3 offset:64
    ds_read_b64_tr_b16 v[18:19], v3 offset:320
    ds_read_b128 v[84:87], v53 offset:0
    ds_read_b128 v[92:95], v53 offset:2048
    ds_read_b128 v[100:103], v53 offset:4096
    v_mfma_f32_16x16x32_bf16 v[180:183], v[20:23], v[60:63], v[180:183]
    v_mfma_f32_16x16x32_bf16 v[212:215], v[20:23], v[68:71], v[212:215]
    s_add_u32 m0, s34, 17696
    s_nop 0
    buffer_load_dwordx4 v4, s[12:15], s29 offen offset:256 nt lds
    v_mfma_f32_16x16x32_bf16 v[244:247], v[20:23], v[76:79], v[244:247]
    ds_read_b64_tr_b16 v[20:21], v3 offset:72
    ds_read_b64_tr_b16 v[22:23], v3 offset:328
    s_waitcnt lgkmcnt(9)
    v_mfma_f32_16x16x32_bf16 v[152:155], v[8:11], v[80:83], v[152:155]
    v_mfma_f32_16x16x32_bf16 v[184:187], v[8:11], v[88:91], v[184:187]
    s_add_u32 s28, s54, 2
    s_and_b32 s28, s28, 31
    s_lshl_b32 s28, s28, 13
    s_add_u32 m0, s34, 25344
    s_nop 0
    buffer_load_dwordx4 v4, s[8:11], s28 offen offset:0 nt lds
    v_mfma_f32_16x16x32_bf16 v[216:219], v[8:11], v[96:99], v[216:219]
    ds_read_b64_tr_b16 v[8:9], v3 offset:128
    ds_read_b64_tr_b16 v[10:11], v3 offset:384
    s_waitcnt lgkmcnt(9)
    v_mfma_f32_16x16x32_bf16 v[156:159], v[12:15], v[80:83], v[156:159]
    v_mfma_f32_16x16x32_bf16 v[188:191], v[12:15], v[88:91], v[188:191]
    s_add_u32 m0, s34, 26144
    s_nop 0
    buffer_load_dwordx4 v4, s[8:11], s28 offen offset:256 nt lds
    v_mfma_f32_16x16x32_bf16 v[220:223], v[12:15], v[96:99], v[220:223]
    ds_read_b64_tr_b16 v[12:13], v3 offset:136
    ds_read_b64_tr_b16 v[14:15], v3 offset:392
    s_waitcnt lgkmcnt(9)
    v_mfma_f32_16x16x32_bf16 v[160:163], v[16:19], v[80:83], v[160:163]
    v_mfma_f32_16x16x32_bf16 v[192:195], v[16:19], v[88:91], v[192:195]
    s_add_u32 s29, s54, 1
    s_and_b32 s29, s29, 31
    s_lshl_b32 s29, s29, 13
    s_add_u32 m0, s34, 50688
    s_nop 0
    buffer_load_dwordx4 v4, s[12:15], s29 offen offset:0 nt lds
    v_mfma_f32_16x16x32_bf16 v[224:227], v[16:19], v[96:99], v[224:227]
    ds_read_b64_tr_b16 v[16:17], v3 offset:192
    ds_read_b64_tr_b16 v[18:19], v3 offset:448
    s_waitcnt lgkmcnt(6)
    v_mfma_f32_16x16x32_bf16 v[164:167], v[20:23], v[80:83], v[164:167]
    v_mfma_f32_16x16x32_bf16 v[196:199], v[20:23], v[88:91], v[196:199]
    s_add_u32 m0, s34, 51488
    s_nop 0
    buffer_load_dwordx4 v4, s[12:15], s29 offen offset:256 nt lds
    v_mfma_f32_16x16x32_bf16 v[228:231], v[20:23], v[96:99], v[228:231]
    ds_read_b64_tr_b16 v[20:21], v3 offset:200
    ds_read_b64_tr_b16 v[22:23], v3 offset:456
    s_waitcnt lgkmcnt(6)
    v_mfma_f32_16x16x32_bf16 v[168:171], v[8:11], v[80:83], v[168:171]
    v_mfma_f32_16x16x32_bf16 v[200:203], v[8:11], v[88:91], v[200:203]
    s_add_u32 s28, s54, 3
    s_and_b32 s28, s28, 31
    s_lshl_b32 s28, s28, 13
    s_add_u32 m0, s34, 59136
    s_nop 0
    buffer_load_dwordx4 v4, s[8:11], s28 offen offset:0 nt lds
    v_mfma_f32_16x16x32_bf16 v[232:235], v[8:11], v[96:99], v[232:235]
    ds_read_b64_tr_b16 v[8:9], v3 offset:8448
    ds_read_b64_tr_b16 v[10:11], v3 offset:8704
    s_waitcnt lgkmcnt(6)
    v_mfma_f32_16x16x32_bf16 v[172:175], v[12:15], v[80:83], v[172:175]
    v_mfma_f32_16x16x32_bf16 v[204:207], v[12:15], v[88:91], v[204:207]
    s_add_u32 m0, s34, 59936
    s_nop 0
    buffer_load_dwordx4 v4, s[8:11], s28 offen offset:256 nt lds
    v_mfma_f32_16x16x32_bf16 v[236:239], v[12:15], v[96:99], v[236:239]
    ds_read_b64_tr_b16 v[12:13], v3 offset:8456
    ds_read_b64_tr_b16 v[14:15], v3 offset:8712
    s_waitcnt lgkmcnt(6)
    v_mfma_f32_16x16x32_bf16 v[176:179], v[16:19], v[80:83], v[176:179]
    v_mfma_f32_16x16x32_bf16 v[208:211], v[16:19], v[88:91], v[208:211]
    v_mfma_f32_16x16x32_bf16 v[240:243], v[16:19], v[96:99], v[240:243]
    ds_read_b64_tr_b16 v[16:17], v3 offset:8512
    ds_read_b64_tr_b16 v[18:19], v3 offset:8768
    s_waitcnt lgkmcnt(6)
    v_mfma_f32_16x16x32_bf16 v[180:183], v[20:23], v[80:83], v[180:183]
    v_mfma_f32_16x16x32_bf16 v[212:215], v[20:23], v[88:91], v[212:215]
    v_mfma_f32_16x16x32_bf16 v[244:247], v[20:23], v[96:99], v[244:247]
    ds_read_b64_tr_b16 v[20:21], v3 offset:8520
    ds_read_b64_tr_b16 v[22:23], v3 offset:8776
    s_waitcnt lgkmcnt(6)
    v_mfma_f32_16x16x32_bf16 v[152:155], v[8:11], v[84:87], v[152:155]
    v_mfma_f32_16x16x32_bf16 v[184:187], v[8:11], v[92:95], v[184:187]
    v_mfma_f32_16x16x32_bf16 v[216:219], v[8:11], v[100:103], v[216:219]
    ds_read_b64_tr_b16 v[8:9], v3 offset:8576
    ds_read_b64_tr_b16 v[10:11], v3 offset:8832
    s_waitcnt lgkmcnt(6)
    v_mfma_f32_16x16x32_bf16 v[156:159], v[12:15], v[84:87], v[156:159]
    v_mfma_f32_16x16x32_bf16 v[188:191], v[12:15], v[92:95], v[188:191]
    v_mfma_f32_16x16x32_bf16 v[220:223], v[12:15], v[100:103], v[220:223]
    ds_read_b64_tr_b16 v[12:13], v3 offset:8584
    ds_read_b64_tr_b16 v[14:15], v3 offset:8840
    s_waitcnt lgkmcnt(6)
    v_mfma_f32_16x16x32_bf16 v[160:163], v[16:19], v[84:87], v[160:163]
    v_mfma_f32_16x16x32_bf16 v[192:195], v[16:19], v[92:95], v[192:195]
    v_mfma_f32_16x16x32_bf16 v[224:227], v[16:19], v[100:103], v[224:227]
    ds_read_b64_tr_b16 v[16:17], v3 offset:8640
    ds_read_b64_tr_b16 v[18:19], v3 offset:8896
    s_waitcnt lgkmcnt(6)
    v_mfma_f32_16x16x32_bf16 v[164:167], v[20:23], v[84:87], v[164:167]
    v_mfma_f32_16x16x32_bf16 v[196:199], v[20:23], v[92:95], v[196:199]
    v_mfma_f32_16x16x32_bf16 v[228:231], v[20:23], v[100:103], v[228:231]
    ds_read_b64_tr_b16 v[20:21], v3 offset:8648
    ds_read_b64_tr_b16 v[22:23], v3 offset:8904
    s_waitcnt lgkmcnt(6)
    v_mfma_f32_16x16x32_bf16 v[168:171], v[8:11], v[84:87], v[168:171]
    v_mfma_f32_16x16x32_bf16 v[200:203], v[8:11], v[92:95], v[200:203]
    v_mfma_f32_16x16x32_bf16 v[232:235], v[8:11], v[100:103], v[232:235]
    s_waitcnt lgkmcnt(4)
    v_mfma_f32_16x16x32_bf16 v[172:175], v[12:15], v[84:87], v[172:175]
    v_mfma_f32_16x16x32_bf16 v[204:207], v[12:15], v[92:95], v[204:207]
    v_mfma_f32_16x16x32_bf16 v[236:239], v[12:15], v[100:103], v[236:239]
    s_waitcnt lgkmcnt(0)
    s_barrier
    ds_read_b128 v[8:11], v1 offset:33792
    ds_read_b128 v[12:15], v1 offset:33856
    v_mfma_f32_16x16x32_bf16 v[176:179], v[16:19], v[84:87], v[176:179]
    v_mfma_f32_16x16x32_bf16 v[208:211], v[16:19], v[92:95], v[208:211]
    v_mfma_f32_16x16x32_bf16 v[240:243], v[16:19], v[100:103], v[240:243]
    ds_read_b128 v[16:19], v1 offset:33920
    v_mfma_f32_16x16x32_bf16 v[180:183], v[20:23], v[84:87], v[180:183]
    v_mfma_f32_16x16x32_bf16 v[212:215], v[20:23], v[92:95], v[212:215]
    v_mfma_f32_16x16x32_bf16 v[244:247], v[20:23], v[100:103], v[244:247]
    v_pk_mul_f32 v[152:153], v[152:153], s[38:39]
    v_pk_mul_f32 v[154:155], v[154:155], s[38:39]
    v_cvt_pk_bf16_f32 v104, v152, v153
    v_cvt_pk_bf16_f32 v105, v154, v155
    v_pk_mul_f32 v[156:157], v[156:157], s[38:39]
    v_pk_mul_f32 v[158:159], v[158:159], s[38:39]
    v_cvt_pk_bf16_f32 v106, v156, v157
    v_cvt_pk_bf16_f32 v107, v158, v159
    v_pk_mul_f32 v[160:161], v[160:161], s[38:39]
    v_pk_mul_f32 v[162:163], v[162:163], s[38:39]
    v_cvt_pk_bf16_f32 v108, v160, v161
    v_cvt_pk_bf16_f32 v109, v162, v163
    v_pk_mul_f32 v[164:165], v[164:165], s[38:39]
    v_pk_mul_f32 v[166:167], v[166:167], s[38:39]
    v_cvt_pk_bf16_f32 v110, v164, v165
    v_cvt_pk_bf16_f32 v111, v166, v167
    v_pk_mul_f32 v[168:169], v[168:169], s[38:39]
    v_pk_mul_f32 v[170:171], v[170:171], s[38:39]
    v_cvt_pk_bf16_f32 v112, v168, v169
    v_cvt_pk_bf16_f32 v113, v170, v171
    v_pk_mul_f32 v[172:173], v[172:173], s[38:39]
    v_pk_mul_f32 v[174:175], v[174:175], s[38:39]
    v_cvt_pk_bf16_f32 v114, v172, v173
    v_cvt_pk_bf16_f32 v115, v174, v175
    v_pk_mul_f32 v[176:177], v[176:177], s[38:39]
    v_pk_mul_f32 v[178:179], v[178:179], s[38:39]
    v_cvt_pk_bf16_f32 v116, v176, v177
    v_cvt_pk_bf16_f32 v117, v178, v179
    v_pk_mul_f32 v[180:181], v[180:181], s[38:39]
    v_pk_mul_f32 v[182:183], v[182:183], s[38:39]
    v_cvt_pk_bf16_f32 v118, v180, v181
    v_cvt_pk_bf16_f32 v119, v182, v183
    v_pk_mul_f32 v[184:185], v[184:185], s[38:39]
    v_pk_mul_f32 v[186:187], v[186:187], s[38:39]
    v_cvt_pk_bf16_f32 v120, v184, v185
    v_cvt_pk_bf16_f32 v121, v186, v187
    v_pk_mul_f32 v[188:189], v[188:189], s[38:39]
    v_pk_mul_f32 v[190:191], v[190:191], s[38:39]
    v_cvt_pk_bf16_f32 v122, v188, v189
    v_cvt_pk_bf16_f32 v123, v190, v191
    v_pk_mul_f32 v[192:193], v[192:193], s[38:39]
    v_pk_mul_f32 v[194:195], v[194:195], s[38:39]
    v_cvt_pk_bf16_f32 v124, v192, v193
    v_cvt_pk_bf16_f32 v125, v194, v195
    v_pk_mul_f32 v[196:197], v[196:197], s[38:39]
    v_pk_mul_f32 v[198:199], v[198:199], s[38:39]
    v_cvt_pk_bf16_f32 v126, v196, v197
    v_cvt_pk_bf16_f32 v127, v198, v199
    v_pk_mul_f32 v[200:201], v[200:201], s[38:39]
    v_pk_mul_f32 v[202:203], v[202:203], s[38:39]
    v_cvt_pk_bf16_f32 v128, v200, v201
    v_cvt_pk_bf16_f32 v129, v202, v203
    v_pk_mul_f32 v[204:205], v[204:205], s[38:39]
    v_pk_mul_f32 v[206:207], v[206:207], s[38:39]
    v_cvt_pk_bf16_f32 v130, v204, v205
    v_cvt_pk_bf16_f32 v131, v206, v207
    v_pk_mul_f32 v[208:209], v[208:209], s[38:39]
    v_pk_mul_f32 v[210:211], v[210:211], s[38:39]
    v_cvt_pk_bf16_f32 v132, v208, v209
    v_cvt_pk_bf16_f32 v133, v210, v211
    v_pk_mul_f32 v[212:213], v[212:213], s[38:39]
    v_pk_mul_f32 v[214:215], v[214:215], s[38:39]
    v_cvt_pk_bf16_f32 v134, v212, v213
    v_cvt_pk_bf16_f32 v135, v214, v215
    v_pk_mul_f32 v[216:217], v[216:217], s[38:39]
    v_pk_mul_f32 v[218:219], v[218:219], s[38:39]
    v_cvt_pk_bf16_f32 v136, v216, v217
    v_cvt_pk_bf16_f32 v137, v218, v219
    v_pk_mul_f32 v[220:221], v[220:221], s[38:39]
    v_pk_mul_f32 v[222:223], v[222:223], s[38:39]
    v_cvt_pk_bf16_f32 v138, v220, v221
    v_cvt_pk_bf16_f32 v139, v222, v223
    v_pk_mul_f32 v[224:225], v[224:225], s[38:39]
    v_pk_mul_f32 v[226:227], v[226:227], s[38:39]
    v_cvt_pk_bf16_f32 v140, v224, v225
    v_cvt_pk_bf16_f32 v141, v226, v227
    v_pk_mul_f32 v[228:229], v[228:229], s[38:39]
    v_pk_mul_f32 v[230:231], v[230:231], s[38:39]
    v_cvt_pk_bf16_f32 v142, v228, v229
    v_cvt_pk_bf16_f32 v143, v230, v231
    v_pk_mul_f32 v[232:233], v[232:233], s[38:39]
    v_pk_mul_f32 v[234:235], v[234:235], s[38:39]
    v_cvt_pk_bf16_f32 v144, v232, v233
    v_cvt_pk_bf16_f32 v145, v234, v235
    v_pk_mul_f32 v[236:237], v[236:237], s[38:39]
    v_pk_mul_f32 v[238:239], v[238:239], s[38:39]
    v_cvt_pk_bf16_f32 v146, v236, v237
    v_cvt_pk_bf16_f32 v147, v238, v239
    v_pk_mul_f32 v[240:241], v[240:241], s[38:39]
    v_pk_mul_f32 v[242:243], v[242:243], s[38:39]
    v_cvt_pk_bf16_f32 v148, v240, v241
    v_cvt_pk_bf16_f32 v149, v242, v243
    v_pk_mul_f32 v[244:245], v[244:245], s[38:39]
    v_pk_mul_f32 v[246:247], v[246:247], s[38:39]
    v_cvt_pk_bf16_f32 v150, v244, v245
    v_cvt_pk_bf16_f32 v151, v246, v247
    v_mov_b32 v40, 0
    v_mov_b32 v41, 0
    v_mov_b32 v42, 0
    v_mov_b32 v43, 0
    v_mov_b32 v44, 0
    v_mov_b32 v45, 0
    s_mov_b32 s55, 2
    s_mov_b32 s56, 4
    ds_read_b128 v[20:23], v1 offset:33984
    s_waitcnt lgkmcnt(3)
    v_mfma_f32_16x16x32_bf16 v[56:59], v[8:11], v[104:107], 0
    v_mfma_f32_16x16x32_bf16 v[64:67], v[8:11], v[120:123], 0
    v_mfma_f32_16x16x32_bf16 v[72:75], v[8:11], v[136:139], 0
    ds_read_b128 v[8:11], v1 offset:34304
    s_waitcnt lgkmcnt(3)
    v_mfma_f32_16x16x32_bf16 v[56:59], v[12:15], v[108:111], v[56:59]
    v_mfma_f32_16x16x32_bf16 v[64:67], v[12:15], v[124:127], v[64:67]
    v_mfma_f32_16x16x32_bf16 v[72:75], v[12:15], v[140:143], v[72:75]
    ds_read_b128 v[12:15], v1 offset:34368
    s_waitcnt lgkmcnt(3)
    v_mfma_f32_16x16x32_bf16 v[56:59], v[16:19], v[112:115], v[56:59]
    v_mfma_f32_16x16x32_bf16 v[64:67], v[16:19], v[128:131], v[64:67]
    v_mfma_f32_16x16x32_bf16 v[72:75], v[16:19], v[144:147], v[72:75]
    ds_read_b128 v[16:19], v1 offset:34432
    s_waitcnt lgkmcnt(3)
    v_mfma_f32_16x16x32_bf16 v[56:59], v[20:23], v[116:119], v[56:59]
    v_mfma_f32_16x16x32_bf16 v[64:67], v[20:23], v[132:135], v[64:67]
    v_mfma_f32_16x16x32_bf16 v[72:75], v[20:23], v[148:151], v[72:75]
    ds_read_b128 v[20:23], v1 offset:34496
    s_waitcnt lgkmcnt(3)
    v_mfma_f32_16x16x32_bf16 v[60:63], v[8:11], v[104:107], 0
    v_mfma_f32_16x16x32_bf16 v[68:71], v[8:11], v[120:123], 0
    v_mfma_f32_16x16x32_bf16 v[76:79], v[8:11], v[136:139], 0
    ds_read_b128 v[8:11], v1 offset:42240
    s_waitcnt lgkmcnt(3)
    v_mfma_f32_16x16x32_bf16 v[60:63], v[12:15], v[108:111], v[60:63]
    v_mfma_f32_16x16x32_bf16 v[68:71], v[12:15], v[124:127], v[68:71]
    v_mfma_f32_16x16x32_bf16 v[76:79], v[12:15], v[140:143], v[76:79]
    ds_read_b128 v[12:15], v1 offset:42304
    s_waitcnt lgkmcnt(3)
    v_mfma_f32_16x16x32_bf16 v[60:63], v[16:19], v[112:115], v[60:63]
    v_mfma_f32_16x16x32_bf16 v[68:71], v[16:19], v[128:131], v[68:71]
    v_mfma_f32_16x16x32_bf16 v[76:79], v[16:19], v[144:147], v[76:79]
    ds_read_b128 v[16:19], v1 offset:42368
    s_waitcnt lgkmcnt(3)
    v_mfma_f32_16x16x32_bf16 v[60:63], v[20:23], v[116:119], v[60:63]
    v_mfma_f32_16x16x32_bf16 v[68:71], v[20:23], v[132:135], v[68:71]
    v_mfma_f32_16x16x32_bf16 v[76:79], v[20:23], v[148:151], v[76:79]
    ds_read_b128 v[20:23], v1 offset:42432
    s_waitcnt lgkmcnt(3)
    s_nop 7
    s_nop 7
    v_max3_f32 v248, v56, v57, v58
    v_max3_f32 v248, v248, v59, v60
    v_max3_f32 v248, v248, v61, v62
    v_max_f32 v248, v248, v63
    ds_bpermute_b32 v249, v252, v248
    s_waitcnt lgkmcnt(0)
    v_max_f32 v248, v248, v249
    ds_bpermute_b32 v249, v253, v248
    s_waitcnt lgkmcnt(0)
    v_max_f32 v248, v248, v249
    v_sub_f32 v56, v56, v248
    v_sub_f32 v57, v57, v248
    v_sub_f32 v58, v58, v248
    v_sub_f32 v59, v59, v248
    v_sub_f32 v60, v60, v248
    v_sub_f32 v61, v61, v248
    v_sub_f32 v62, v62, v248
    v_sub_f32 v63, v63, v248
    v_sub_f32 v28, 0, v248
    v_sub_f32 v29, 0, v248
    v_sub_f32 v30, 0, v248
    v_sub_f32 v31, 0, v248
    v_max3_f32 v248, v64, v65, v66
    v_max3_f32 v248, v248, v67, v68
    v_max3_f32 v248, v248, v69, v70
    v_max_f32 v248, v248, v71
    ds_bpermute_b32 v249, v252, v248
    s_waitcnt lgkmcnt(0)
    v_max_f32 v248, v248, v249
    ds_bpermute_b32 v249, v253, v248
    s_waitcnt lgkmcnt(0)
    v_max_f32 v248, v248, v249
    v_sub_f32 v64, v64, v248
    v_sub_f32 v65, v65, v248
    v_sub_f32 v66, v66, v248
    v_sub_f32 v67, v67, v248
    v_sub_f32 v68, v68, v248
    v_sub_f32 v69, v69, v248
    v_sub_f32 v70, v70, v248
    v_sub_f32 v71, v71, v248
    v_sub_f32 v32, 0, v248
    v_sub_f32 v33, 0, v248
    v_sub_f32 v34, 0, v248
    v_sub_f32 v35, 0, v248
    v_max3_f32 v248, v72, v73, v74
    v_max3_f32 v248, v248, v75, v76
    v_max3_f32 v248, v248, v77, v78
    v_max_f32 v248, v248, v79
    ds_bpermute_b32 v249, v252, v248
    s_waitcnt lgkmcnt(0)
    v_max_f32 v248, v248, v249
    ds_bpermute_b32 v249, v253, v248
    s_waitcnt lgkmcnt(0)
    v_max_f32 v248, v248, v249
    v_sub_f32 v72, v72, v248
    v_sub_f32 v73, v73, v248
    v_sub_f32 v74, v74, v248
    v_sub_f32 v75, v75, v248
    v_sub_f32 v76, v76, v248
    v_sub_f32 v77, v77, v248
    v_sub_f32 v78, v78, v248
    v_sub_f32 v79, v79, v248
    v_sub_f32 v36, 0, v248
    v_sub_f32 v37, 0, v248
    v_sub_f32 v38, 0, v248
    v_sub_f32 v39, 0, v248
    s_nop 3
    v_mfma_f32_16x16x32_bf16 v[80:83], v[8:11], v[104:107], v[28:31]
    v_exp_f32 v56, v56
    v_exp_f32 v57, v57
    v_mfma_f32_16x16x32_bf16 v[88:91], v[8:11], v[120:123], v[32:35]
    v_exp_f32 v58, v58
    v_mfma_f32_16x16x32_bf16 v[96:99], v[8:11], v[136:139], v[36:39]
    v_exp_f32 v59, v59
    v_pk_add_f32 v[40:41], v[40:41], v[56:57]
    ds_read_b128 v[8:11], v1 offset:42752
    v_mfma_f32_16x16x32_bf16 v[80:83], v[12:15], v[108:111], v[80:83]
    v_cvt_pk_bf16_f32 v56, v56, v57
    v_exp_f32 v60, v60
    v_mfma_f32_16x16x32_bf16 v[88:91], v[12:15], v[124:127], v[88:91]
    v_exp_f32 v61, v61
    v_pk_add_f32 v[40:41], v[40:41], v[58:59]
    v_mfma_f32_16x16x32_bf16 v[96:99], v[12:15], v[140:143], v[96:99]
    v_cvt_pk_bf16_f32 v57, v58, v59
    v_exp_f32 v62, v62
    ds_read_b128 v[12:15], v1 offset:42816
    v_mfma_f32_16x16x32_bf16 v[80:83], v[16:19], v[112:115], v[80:83]
    v_exp_f32 v63, v63
    v_pk_add_f32 v[40:41], v[40:41], v[60:61]
    v_mfma_f32_16x16x32_bf16 v[88:91], v[16:19], v[128:131], v[88:91]
    v_cvt_pk_bf16_f32 v58, v60, v61
    v_pk_add_f32 v[40:41], v[40:41], v[62:63]
    v_cvt_pk_bf16_f32 v59, v62, v63
    v_mfma_f32_16x16x32_bf16 v[96:99], v[16:19], v[144:147], v[96:99]
    v_exp_f32 v64, v64
    v_exp_f32 v65, v65
    ds_read_b128 v[16:19], v1 offset:42880
    v_mfma_f32_16x16x32_bf16 v[80:83], v[20:23], v[116:119], v[80:83]
    v_exp_f32 v66, v66
    v_mfma_f32_16x16x32_bf16 v[88:91], v[20:23], v[132:135], v[88:91]
    v_exp_f32 v67, v67
    v_pk_add_f32 v[42:43], v[42:43], v[64:65]
    v_mfma_f32_16x16x32_bf16 v[96:99], v[20:23], v[148:151], v[96:99]
    v_cvt_pk_bf16_f32 v64, v64, v65
    v_exp_f32 v68, v68
    ds_read_b128 v[20:23], v1 offset:42944
    s_waitcnt lgkmcnt(3)
    v_mfma_f32_16x16x32_bf16 v[84:87], v[8:11], v[104:107], v[28:31]
    v_exp_f32 v69, v69
    v_pk_add_f32 v[42:43], v[42:43], v[66:67]
    v_mfma_f32_16x16x32_bf16 v[92:95], v[8:11], v[120:123], v[32:35]
    v_cvt_pk_bf16_f32 v65, v66, v67
    v_exp_f32 v70, v70
    v_mfma_f32_16x16x32_bf16 v[100:103], v[8:11], v[136:139], v[36:39]
    v_exp_f32 v71, v71
    v_pk_add_f32 v[42:43], v[42:43], v[68:69]
    s_waitcnt lgkmcnt(2)
    v_mfma_f32_16x16x32_bf16 v[84:87], v[12:15], v[108:111], v[84:87]
    v_cvt_pk_bf16_f32 v66, v68, v69
    v_pk_add_f32 v[42:43], v[42:43], v[70:71]
    v_cvt_pk_bf16_f32 v67, v70, v71
    v_mfma_f32_16x16x32_bf16 v[92:95], v[12:15], v[124:127], v[92:95]
    v_exp_f32 v72, v72
    v_exp_f32 v73, v73
    v_mfma_f32_16x16x32_bf16 v[100:103], v[12:15], v[140:143], v[100:103]
    v_exp_f32 v74, v74
    s_waitcnt vmcnt(4) lgkmcnt(0)
    s_barrier
    ds_read_b64_tr_b16 v[8:9], v2 offset:16896
    ds_read_b64_tr_b16 v[10:11], v2 offset:17408
    ds_read_b64_tr_b16 v[12:13], v2 offset:16928
    ds_read_b64_tr_b16 v[14:15], v2 offset:17440
    v_mfma_f32_16x16x32_bf16 v[84:87], v[16:19], v[112:115], v[84:87]
    v_exp_f32 v75, v75
    v_pk_add_f32 v[44:45], v[44:45], v[72:73]
    v_mfma_f32_16x16x32_bf16 v[92:95], v[16:19], v[128:131], v[92:95]
    s_add_u32 s29, s55, s54
    s_and_b32 s29, s29, 31
    s_lshl_b32 s29, s29, 13
    s_cmp_ge_u32 s55, 32
    s_cselect_b32 s29, 0x40000000, s29
    s_add_u32 s55, s55, 1
    s_add_u32 s28, s56, s54
    s_and_b32 s28, s28, 31
    s_lshl_b32 s28, s28, 13
    s_cmp_ge_u32 s56, 32
    s_cselect_b32 s28, 0x40000000, s28
    s_add_u32 s56, s56, 1
    s_add_u32 m0, s34, 0
    s_nop 0
    buffer_load_dwordx4 v4, s[12:15], s29 offen offset:0 nt lds
    v_cvt_pk_bf16_f32 v72, v72, v73
    v_exp_f32 v76, v76
    v_mfma_f32_16x16x32_bf16 v[100:103], v[16:19], v[144:147], v[100:103]
    v_exp_f32 v77, v77
    v_pk_add_f32 v[44:45], v[44:45], v[74:75]
    ds_read_b64_tr_b16 v[16:17], v2 offset:16960
    ds_read_b64_tr_b16 v[18:19], v2 offset:17472
    v_mfma_f32_16x16x32_bf16 v[84:87], v[20:23], v[116:119], v[84:87]
    v_cvt_pk_bf16_f32 v73, v74, v75
    v_exp_f32 v78, v78
    v_mfma_f32_16x16x32_bf16 v[92:95], v[20:23], v[132:135], v[92:95]
    v_exp_f32 v79, v79
    v_pk_add_f32 v[44:45], v[44:45], v[76:77]
    v_mfma_f32_16x16x32_bf16 v[100:103], v[20:23], v[148:151], v[100:103]
    v_cvt_pk_bf16_f32 v74, v76, v77
    v_pk_add_f32 v[44:45], v[44:45], v[78:79]
    v_cvt_pk_bf16_f32 v75, v78, v79
    ds_read_b64_tr_b16 v[20:21], v2 offset:16992
    ds_read_b64_tr_b16 v[22:23], v2 offset:17504
    s_waitcnt lgkmcnt(6)
    v_mfma_f32_16x16x32_bf16 v[152:155], v[8:11], v[56:59], 0
    v_max3_f32 v49, v80, v81, v82
    v_max3_f32 v49, v49, v83, v88
    v_mfma_f32_16x16x32_bf16 v[184:187], v[8:11], v[64:67], 0
    v_max3_f32 v49, v49, v89, v90
    v_max3_f32 v49, v49, v91, v96
    v_mfma_f32_16x16x32_bf16 v[216:219], v[8:11], v[72:75], 0
    v_max3_f32 v49, v49, v97, v98
    v_max_f32 v49, v49, v99
    ds_read_b64_tr_b16 v[8:9], v2 offset:17024
    ds_read_b64_tr_b16 v[10:11], v2 offset:17536
    s_waitcnt lgkmcnt(6)
    v_mfma_f32_16x16x32_bf16 v[156:159], v[12:15], v[56:59], 0
    v_max3_f32 v49, v49, v84, v85
    v_max3_f32 v49, v49, v86, v87
    v_mfma_f32_16x16x32_bf16 v[188:191], v[12:15], v[64:67], 0
    v_max3_f32 v49, v49, v92, v93
    v_max3_f32 v49, v49, v94, v95
    v_mfma_f32_16x16x32_bf16 v[220:223], v[12:15], v[72:75], 0
    v_max3_f32 v49, v49, v100, v101
    v_max3_f32 v49, v49, v102, v103
    ds_read_b64_tr_b16 v[12:13], v2 offset:17056
    ds_read_b64_tr_b16 v[14:15], v2 offset:17568
    s_waitcnt lgkmcnt(6)
    v_cmp_lt_f32 vcc, 0x41000000, v49
    s_cbranch_vccnz K1_r1_0
K1_b1_0:
    v_mfma_f32_16x16x32_bf16 v[160:163], v[16:19], v[56:59], 0
    v_exp_f32 v80, v80
    v_mfma_f32_16x16x32_bf16 v[192:195], v[16:19], v[64:67], 0
    s_add_u32 m0, s34, 800
    s_nop 0
    buffer_load_dwordx4 v4, s[12:15], s29 offen offset:256 nt lds
    v_exp_f32 v81, v81
    v_mfma_f32_16x16x32_bf16 v[224:227], v[16:19], v[72:75], 0
    v_exp_f32 v82, v82
    ds_read_b64_tr_b16 v[16:17], v2 offset:17088
    ds_read_b64_tr_b16 v[18:19], v2 offset:17600
    s_waitcnt lgkmcnt(6)
    v_mfma_f32_16x16x32_bf16 v[164:167], v[20:23], v[56:59], 0
    v_exp_f32 v83, v83
    v_mfma_f32_16x16x32_bf16 v[196:199], v[20:23], v[64:67], 0
    v_pk_add_f32 v[40:41], v[40:41], v[80:81]
    v_mfma_f32_16x16x32_bf16 v[228:231], v[20:23], v[72:75], 0
    v_cvt_pk_bf16_f32 v80, v80, v81
    v_exp_f32 v84, v84
    ds_read_b64_tr_b16 v[20:21], v2 offset:17120
    ds_read_b64_tr_b16 v[22:23], v2 offset:17632
    s_waitcnt lgkmcnt(6)
    v_mfma_f32_16x16x32_bf16 v[168:171], v[8:11], v[56:59], 0
    v_mfma_f32_16x16x32_bf16 v[200:203], v[8:11], v[64:67], 0
    v_exp_f32 v85, v85
    v_mfma_f32_16x16x32_bf16 v[232:235], v[8:11], v[72:75], 0
    v_pk_add_f32 v[40:41], v[40:41], v[82:83]
    v_cvt_pk_bf16_f32 v81, v82, v83
    ds_read_b128 v[8:11], v1 offset:25344
    s_waitcnt lgkmcnt(5)
    v_mfma_f32_16x16x32_bf16 v[172:175], v[12:15], v[56:59], 0
    v_exp_f32 v86, v86
    v_mfma_f32_16x16x32_bf16 v[204:207], v[12:15], v[64:67], 0
    v_exp_f32 v87, v87
    v_mfma_f32_16x16x32_bf16 v[236:239], v[12:15], v[72:75], 0
    v_pk_add_f32 v[40:41], v[40:41], v[84:85]
    ds_read_b128 v[12:15], v1 offset:25408
    s_waitcnt lgkmcnt(4)
    v_mfma_f32_16x16x32_bf16 v[176:179], v[16:19], v[56:59], 0
    v_cvt_pk_bf16_f32 v82, v84, v85
    v_pk_add_f32 v[40:41], v[40:41], v[86:87]
    v_mfma_f32_16x16x32_bf16 v[208:211], v[16:19], v[64:67], 0
    s_add_u32 m0, s34, 8448
    s_nop 0
    buffer_load_dwordx4 v4, s[8:11], s28 offen offset:0 nt lds
    v_cvt_pk_bf16_f32 v83, v86, v87
    v_mfma_f32_16x16x32_bf16 v[240:243], v[16:19], v[72:75], 0
    v_exp_f32 v88, v88
    ds_read_b128 v[16:19], v1 offset:25472
    s_waitcnt lgkmcnt(3)
    v_mfma_f32_16x16x32_bf16 v[180:183], v[20:23], v[56:59], 0
    v_exp_f32 v89, v89
    v_mfma_f32_16x16x32_bf16 v[212:215], v[20:23], v[64:67], 0
    v_exp_f32 v90, v90
    v_mfma_f32_16x16x32_bf16 v[244:247], v[20:23], v[72:75], 0
    v_exp_f32 v91, v91
    ds_read_b128 v[20:23], v1 offset:25536
    s_waitcnt lgkmcnt(3)
    v_mfma_f32_16x16x32_bf16 v[56:59], v[8:11], v[104:107], v[28:31]
    v_pk_add_f32 v[42:43], v[42:43], v[88:89]
    v_mfma_f32_16x16x32_bf16 v[64:67], v[8:11], v[120:123], v[32:35]
    v_cvt_pk_bf16_f32 v88, v88, v89
    v_exp_f32 v92, v92
    v_mfma_f32_16x16x32_bf16 v[72:75], v[8:11], v[136:139], v[36:39]
    ds_read_b128 v[8:11], v1 offset:25856
    s_waitcnt lgkmcnt(3)
    v_mfma_f32_16x16x32_bf16 v[56:59], v[12:15], v[108:111], v[56:59]
    v_exp_f32 v93, v93
    v_mfma_f32_16x16x32_bf16 v[64:67], v[12:15], v[124:127], v[64:67]
    v_pk_add_f32 v[42:43], v[42:43], v[90:91]
    v_cvt_pk_bf16_f32 v89, v90, v91
    v_mfma_f32_16x16x32_bf16 v[72:75], v[12:15], v[140:143], v[72:75]
    v_exp_f32 v94, v94
    ds_read_b128 v[12:15], v1 offset:25920
    s_waitcnt lgkmcnt(3)
    s_cmp_lg_u32 s36, 0
    s_cbranch_scc1 K1_r2_1
K1_b2_1:
    v_mfma_f32_16x16x32_bf16 v[56:59], v[16:19], v[112:115], v[56:59]
    v_exp_f32 v95, v95
    v_mfma_f32_16x16x32_bf16 v[64:67], v[16:19], v[128:131], v[64:67]
    s_add_u32 m0, s34, 9248
    s_nop 0
    buffer_load_dwordx4 v4, s[8:11], s28 offen offset:256 nt lds
    v_pk_add_f32 v[42:43], v[42:43], v[92:93]
    v_mfma_f32_16x16x32_bf16 v[72:75], v[16:19], v[144:147], v[72:75]
    v_cvt_pk_bf16_f32 v90, v92, v93
    v_pk_add_f32 v[42:43], v[42:43], v[94:95]
    ds_read_b128 v[16:19], v1 offset:25984
    s_waitcnt lgkmcnt(3)
    v_mfma_f32_16x16x32_bf16 v[56:59], v[20:23], v[116:119], v[56:59]
    v_cvt_pk_bf16_f32 v91, v94, v95
    v_mfma_f32_16x16x32_bf16 v[64:67], v[20:23], v[132:135], v[64:67]
    v_exp_f32 v96, v96
    v_mfma_f32_16x16x32_bf16 v[72:75], v[20:23], v[148:151], v[72:75]
    v_exp_f32 v97, v97
    ds_read_b128 v[20:23], v1 offset:26048
    s_waitcnt lgkmcnt(3)
    v_mfma_f32_16x16x32_bf16 v[60:63], v[8:11], v[104:107], v[28:31]
    v_exp_f32 v98, v98
    v_mfma_f32_16x16x32_bf16 v[68:71], v[8:11], v[120:123], v[32:35]
    v_exp_f32 v99, v99
    v_mfma_f32_16x16x32_bf16 v[76:79], v[8:11], v[136:139], v[36:39]
    v_pk_add_f32 v[44:45], v[44:45], v[96:97]
    s_waitcnt lgkmcnt(2)
    v_mfma_f32_16x16x32_bf16 v[60:63], v[12:15], v[108:111], v[60:63]
    v_cvt_pk_bf16_f32 v96, v96, v97
    v_exp_f32 v100, v100
    v_mfma_f32_16x16x32_bf16 v[68:71], v[12:15], v[124:127], v[68:71]
    v_mfma_f32_16x16x32_bf16 v[76:79], v[12:15], v[140:143], v[76:79]
    v_exp_f32 v101, v101
    s_waitcnt vmcnt(4) lgkmcnt(0)
    s_barrier
    ds_read_b64_tr_b16 v[8:9], v2 offset:50688
    ds_read_b64_tr_b16 v[10:11], v2 offset:51200
    ds_read_b64_tr_b16 v[12:13], v2 offset:50720
    ds_read_b64_tr_b16 v[14:15], v2 offset:51232
    v_mfma_f32_16x16x32_bf16 v[60:63], v[16:19], v[112:115], v[60:63]
    v_pk_add_f32 v[44:45], v[44:45], v[98:99]
    v_cvt_pk_bf16_f32 v97, v98, v99
    v_mfma_f32_16x16x32_bf16 v[68:71], v[16:19], v[128:131], v[68:71]
    s_add_u32 s29, s55, s54
    s_and_b32 s29, s29, 31
    s_lshl_b32 s29, s29, 13
    s_cmp_ge_u32 s55, 32
    s_cselect_b32 s29, 0x40000000, s29
    s_add_u32 s55, s55, 1
    s_add_u32 s28, s56, s54
    s_and_b32 s28, s28, 31
    s_lshl_b32 s28, s28, 13
    s_cmp_ge_u32 s56, 32
    s_cselect_b32 s28, 0x40000000, s28
    s_add_u32 s56, s56, 1
    s_add_u32 m0, s34, 33792
    s_nop 0
    buffer_load_dwordx4 v4, s[12:15], s29 offen offset:0 nt lds
    v_exp_f32 v102, v102
    v_mfma_f32_16x16x32_bf16 v[76:79], v[16:19], v[144:147], v[76:79]
    v_exp_f32 v103, v103
    ds_read_b64_tr_b16 v[16:17], v2 offset:50752
    ds_read_b64_tr_b16 v[18:19], v2 offset:51264
    v_mfma_f32_16x16x32_bf16 v[60:63], v[20:23], v[116:119], v[60:63]
    v_pk_add_f32 v[44:45], v[44:45], v[100:101]
    v_mfma_f32_16x16x32_bf16 v[68:71], v[20:23], v[132:135], v[68:71]
    v_cvt_pk_bf16_f32 v98, v100, v101
    v_pk_add_f32 v[44:45], v[44:45], v[102:103]
    v_mfma_f32_16x16x32_bf16 v[76:79], v[20:23], v[148:151], v[76:79]
    v_cvt_pk_bf16_f32 v99, v102, v103
    ds_read_b64_tr_b16 v[20:21], v2 offset:50784
    ds_read_b64_tr_b16 v[22:23], v2 offset:51296
    s_waitcnt lgkmcnt(6)
    v_mfma_f32_16x16x32_bf16 v[152:155], v[8:11], v[80:83], v[152:155]
    v_max3_f32 v49, v56, v57, v58
    v_max3_f32 v49, v49, v59, v64
    v_mfma_f32_16x16x32_bf16 v[184:187], v[8:11], v[88:91], v[184:187]
    v_max3_f32 v49, v49, v65, v66
    v_max3_f32 v49, v49, v67, v72
    v_mfma_f32_16x16x32_bf16 v[216:219], v[8:11], v[96:99], v[216:219]
    v_max3_f32 v49, v49, v73, v74
    v_max_f32 v49, v49, v75
    ds_read_b64_tr_b16 v[8:9], v2 offset:50816
    ds_read_b64_tr_b16 v[10:11], v2 offset:51328
    s_waitcnt lgkmcnt(6)
    v_mfma_f32_16x16x32_bf16 v[156:159], v[12:15], v[80:83], v[156:159]
    v_max3_f32 v49, v49, v60, v61
    v_max3_f32 v49, v49, v62, v63
    v_mfma_f32_16x16x32_bf16 v[188:191], v[12:15], v[88:91], v[188:191]
    v_max3_f32 v49, v49, v68, v69
    v_max3_f32 v49, v49, v70, v71
    v_mfma_f32_16x16x32_bf16 v[220:223], v[12:15], v[96:99], v[220:223]
    v_max3_f32 v49, v49, v76, v77
    v_max3_f32 v49, v49, v78, v79
    ds_read_b64_tr_b16 v[12:13], v2 offset:50848
    ds_read_b64_tr_b16 v[14:15], v2 offset:51360
    s_waitcnt lgkmcnt(6)
    v_cmp_lt_f32 vcc, 0x41000000, v49
    s_cbranch_vccnz K1_r1_2
K1_b1_2:
    v_mfma_f32_16x16x32_bf16 v[160:163], v[16:19], v[80:83], v[160:163]
    v_exp_f32 v56, v56
    v_mfma_f32_16x16x32_bf16 v[192:195], v[16:19], v[88:91], v[192:195]
    s_add_u32 m0, s34, 34592
    s_nop 0
    buffer_load_dwordx4 v4, s[12:15], s29 offen offset:256 nt lds
    v_exp_f32 v57, v57
    v_mfma_f32_16x16x32_bf16 v[224:227], v[16:19], v[96:99], v[224:227]
    v_exp_f32 v58, v58
    ds_read_b64_tr_b16 v[16:17], v2 offset:50880
    ds_read_b64_tr_b16 v[18:19], v2 offset:51392
    s_waitcnt lgkmcnt(6)
    v_mfma_f32_16x16x32_bf16 v[164:167], v[20:23], v[80:83], v[164:167]
    v_exp_f32 v59, v59
    v_mfma_f32_16x16x32_bf16 v[196:199], v[20:23], v[88:91], v[196:199]
    v_pk_add_f32 v[40:41], v[40:41], v[56:57]
    v_mfma_f32_16x16x32_bf16 v[228:231], v[20:23], v[96:99], v[228:231]
    v_cvt_pk_bf16_f32 v56, v56, v57
    v_exp_f32 v60, v60
    ds_read_b64_tr_b16 v[20:21], v2 offset:50912
    ds_read_b64_tr_b16 v[22:23], v2 offset:51424
    s_waitcnt lgkmcnt(6)
    v_mfma_f32_16x16x32_bf16 v[168:171], v[8:11], v[80:83], v[168:171]
    v_mfma_f32_16x16x32_bf16 v[200:203], v[8:11], v[88:91], v[200:203]
    v_exp_f32 v61, v61
    v_mfma_f32_16x16x32_bf16 v[232:235], v[8:11], v[96:99], v[232:235]
    v_pk_add_f32 v[40:41], v[40:41], v[58:59]
    v_cvt_pk_bf16_f32 v57, v58, v59
    ds_read_b128 v[8:11], v1 offset:59136
    s_waitcnt lgkmcnt(5)
    v_mfma_f32_16x16x32_bf16 v[172:175], v[12:15], v[80:83], v[172:175]
    v_exp_f32 v62, v62
    v_mfma_f32_16x16x32_bf16 v[204:207], v[12:15], v[88:91], v[204:207]
    v_exp_f32 v63, v63
    v_mfma_f32_16x16x32_bf16 v[236:239], v[12:15], v[96:99], v[236:239]
    v_pk_add_f32 v[40:41], v[40:41], v[60:61]
    ds_read_b128 v[12:15], v1 offset:59200
    s_waitcnt lgkmcnt(4)
    v_mfma_f32_16x16x32_bf16 v[176:179], v[16:19], v[80:83], v[176:179]
    v_cvt_pk_bf16_f32 v58, v60, v61
    v_pk_add_f32 v[40:41], v[40:41], v[62:63]
    v_mfma_f32_16x16x32_bf16 v[208:211], v[16:19], v[88:91], v[208:211]
    s_add_u32 m0, s34, 42240
    s_nop 0
    buffer_load_dwordx4 v4, s[8:11], s28 offen offset:0 nt lds
    v_cvt_pk_bf16_f32 v59, v62, v63
    v_mfma_f32_16x16x32_bf16 v[240:243], v[16:19], v[96:99], v[240:243]
    v_exp_f32 v64, v64
    ds_read_b128 v[16:19], v1 offset:59264
    s_waitcnt lgkmcnt(3)
    v_mfma_f32_16x16x32_bf16 v[180:183], v[20:23], v[80:83], v[180:183]
    v_exp_f32 v65, v65
    v_mfma_f32_16x16x32_bf16 v[212:215], v[20:23], v[88:91], v[212:215]
    v_exp_f32 v66, v66
    v_mfma_f32_16x16x32_bf16 v[244:247], v[20:23], v[96:99], v[244:247]
    v_exp_f32 v67, v67
    ds_read_b128 v[20:23], v1 offset:59328
    s_waitcnt lgkmcnt(3)
    v_mfma_f32_16x16x32_bf16 v[80:83], v[8:11], v[104:107], v[28:31]
    v_pk_add_f32 v[42:43], v[42:43], v[64:65]
    v_mfma_f32_16x16x32_bf16 v[88:91], v[8:11], v[120:123], v[32:35]
    v_cvt_pk_bf16_f32 v64, v64, v65
    v_exp_f32 v68, v68
    v_mfma_f32_16x16x32_bf16 v[96:99], v[8:11], v[136:139], v[36:39]
    ds_read_b128 v[8:11], v1 offset:59648
    s_waitcnt lgkmcnt(3)
    v_mfma_f32_16x16x32_bf16 v[80:83], v[12:15], v[108:111], v[80:83]
    v_exp_f32 v69, v69
    v_mfma_f32_16x16x32_bf16 v[88:91], v[12:15], v[124:127], v[88:91]
    v_pk_add_f32 v[42:43], v[42:43], v[66:67]
    v_cvt_pk_bf16_f32 v65, v66, v67
    v_mfma_f32_16x16x32_bf16 v[96:99], v[12:15], v[140:143], v[96:99]
    v_exp_f32 v70, v70
    ds_read_b128 v[12:15], v1 offset:59712
    s_waitcnt lgkmcnt(3)
    s_cmp_lg_u32 s36, 0
    s_cbranch_scc1 K1_r2_3
K1_b2_3:
    v_mfma_f32_16x16x32_bf16 v[80:83], v[16:19], v[112:115], v[80:83]
    v_exp_f32 v71, v71
    v_mfma_f32_16x16x32_bf16 v[88:91], v[16:19], v[128:131], v[88:91]
    s_add_u32 m0, s34, 43040
    s_nop 0
    buffer_load_dwordx4 v4, s[8:11], s28 offen offset:256 nt lds
    v_pk_add_f32 v[42:43], v[42:43], v[68:69]
    v_mfma_f32_16x16x32_bf16 v[96:99], v[16:19], v[144:147], v[96:99]
    v_cvt_pk_bf16_f32 v66, v68, v69
    v_pk_add_f32 v[42:43], v[42:43], v[70:71]
    ds_read_b128 v[16:19], v1 offset:59776
    s_waitcnt lgkmcnt(3)
    v_mfma_f32_16x16x32_bf16 v[80:83], v[20:23], v[116:119], v[80:83]
    v_cvt_pk_bf16_f32 v67, v70, v71
    v_mfma_f32_16x16x32_bf16 v[88:91], v[20:23], v[132:135], v[88:91]
    v_exp_f32 v72, v72
    v_mfma_f32_16x16x32_bf16 v[96:99], v[20:23], v[148:151], v[96:99]
    v_exp_f32 v73, v73
    ds_read_b128 v[20:23], v1 offset:59840
    s_waitcnt lgkmcnt(3)
    v_mfma_f32_16x16x32_bf16 v[84:87], v[8:11], v[104:107], v[28:31]
    v_exp_f32 v74, v74
    v_mfma_f32_16x16x32_bf16 v[92:95], v[8:11], v[120:123], v[32:35]
    v_exp_f32 v75, v75
    v_mfma_f32_16x16x32_bf16 v[100:103], v[8:11], v[136:139], v[36:39]
    v_pk_add_f32 v[44:45], v[44:45], v[72:73]
    s_waitcnt lgkmcnt(2)
    v_mfma_f32_16x16x32_bf16 v[84:87], v[12:15], v[108:111], v[84:87]
    v_cvt_pk_bf16_f32 v72, v72, v73
    v_exp_f32 v76, v76
    v_mfma_f32_16x16x32_bf16 v[92:95], v[12:15], v[124:127], v[92:95]
    v_mfma_f32_16x16x32_bf16 v[100:103], v[12:15], v[140:143], v[100:103]
    v_exp_f32 v77, v77
    s_waitcnt vmcnt(4) lgkmcnt(0)
    s_barrier
    ds_read_b64_tr_b16 v[8:9], v2 offset:0
    ds_read_b64_tr_b16 v[10:11], v2 offset:512
    ds_read_b64_tr_b16 v[12:13], v2 offset:32
    ds_read_b64_tr_b16 v[14:15], v2 offset:544
    v_mfma_f32_16x16x32_bf16 v[84:87], v[16:19], v[112:115], v[84:87]
    v_pk_add_f32 v[44:45], v[44:45], v[74:75]
    v_cvt_pk_bf16_f32 v73, v74, v75
    v_mfma_f32_16x16x32_bf16 v[92:95], v[16:19], v[128:131], v[92:95]
    s_add_u32 s29, s55, s54
    s_and_b32 s29, s29, 31
    s_lshl_b32 s29, s29, 13
    s_cmp_ge_u32 s55, 32
    s_cselect_b32 s29, 0x40000000, s29
    s_add_u32 s55, s55, 1
    s_add_u32 s28, s56, s54
    s_and_b32 s28, s28, 31
    s_lshl_b32 s28, s28, 13
    s_cmp_ge_u32 s56, 32
    s_cselect_b32 s28, 0x40000000, s28
    s_add_u32 s56, s56, 1
    s_add_u32 m0, s34, 16896
    s_nop 0
    buffer_load_dwordx4 v4, s[12:15], s29 offen offset:0 nt lds
    v_exp_f32 v78, v78
    v_mfma_f32_16x16x32_bf16 v[100:103], v[16:19], v[144:147], v[100:103]
    v_exp_f32 v79, v79
    ds_read_b64_tr_b16 v[16:17], v2 offset:64
    ds_read_b64_tr_b16 v[18:19], v2 offset:576
    v_mfma_f32_16x16x32_bf16 v[84:87], v[20:23], v[116:119], v[84:87]
    v_pk_add_f32 v[44:45], v[44:45], v[76:77]
    v_mfma_f32_16x16x32_bf16 v[92:95], v[20:23], v[132:135], v[92:95]
    v_cvt_pk_bf16_f32 v74, v76, v77
    v_pk_add_f32 v[44:45], v[44:45], v[78:79]
    v_mfma_f32_16x16x32_bf16 v[100:103], v[20:23], v[148:151], v[100:103]
    v_cvt_pk_bf16_f32 v75, v78, v79
    ds_read_b64_tr_b16 v[20:21], v2 offset:96
    ds_read_b64_tr_b16 v[22:23], v2 offset:608
    s_waitcnt lgkmcnt(6)
    v_mfma_f32_16x16x32_bf16 v[152:155], v[8:11], v[56:59], v[152:155]
    v_max3_f32 v49, v80, v81, v82
    v_max3_f32 v49, v49, v83, v88
    v_mfma_f32_16x16x32_bf16 v[184:187], v[8:11], v[64:67], v[184:187]
    v_max3_f32 v49, v49, v89, v90
    v_max3_f32 v49, v49, v91, v96
    v_mfma_f32_16x16x32_bf16 v[216:219], v[8:11], v[72:75], v[216:219]
    v_max3_f32 v49, v49, v97, v98
    v_max_f32 v49, v49, v99
    ds_read_b64_tr_b16 v[8:9], v2 offset:128
    ds_read_b64_tr_b16 v[10:11], v2 offset:640
    s_waitcnt lgkmcnt(6)
    v_mfma_f32_16x16x32_bf16 v[156:159], v[12:15], v[56:59], v[156:159]
    v_max3_f32 v49, v49, v84, v85
    v_max3_f32 v49, v49, v86, v87
    v_mfma_f32_16x16x32_bf16 v[188:191], v[12:15], v[64:67], v[188:191]
    v_max3_f32 v49, v49, v92, v93
    v_max3_f32 v49, v49, v94, v95
    v_mfma_f32_16x16x32_bf16 v[220:223], v[12:15], v[72:75], v[220:223]
    v_max3_f32 v49, v49, v100, v101
    v_max3_f32 v49, v49, v102, v103
    ds_read_b64_tr_b16 v[12:13], v2 offset:160
    ds_read_b64_tr_b16 v[14:15], v2 offset:672
    s_waitcnt lgkmcnt(6)
    v_cmp_lt_f32 vcc, 0x41000000, v49
    s_cbranch_vccnz K1_r1_4
K1_b1_4:
    v_mfma_f32_16x16x32_bf16 v[160:163], v[16:19], v[56:59], v[160:163]
    v_exp_f32 v80, v80
    v_mfma_f32_16x16x32_bf16 v[192:195], v[16:19], v[64:67], v[192:195]
    s_add_u32 m0, s34, 17696
    s_nop 0
    buffer_load_dwordx4 v4, s[12:15], s29 offen offset:256 nt lds
    v_exp_f32 v81, v81
    v_mfma_f32_16x16x32_bf16 v[224:227], v[16:19], v[72:75], v[224:227]
    v_exp_f32 v82, v82
    ds_read_b64_tr_b16 v[16:17], v2 offset:192
    ds_read_b64_tr_b16 v[18:19], v2 offset:704
    s_waitcnt lgkmcnt(6)
    v_mfma_f32_16x16x32_bf16 v[164:167], v[20:23], v[56:59], v[164:167]
    v_exp_f32 v83, v83
    v_mfma_f32_16x16x32_bf16 v[196:199], v[20:23], v[64:67], v[196:199]
    v_pk_add_f32 v[40:41], v[40:41], v[80:81]
    v_mfma_f32_16x16x32_bf16 v[228:231], v[20:23], v[72:75], v[228:231]
    v_cvt_pk_bf16_f32 v80, v80, v81
    v_exp_f32 v84, v84
    ds_read_b64_tr_b16 v[20:21], v2 offset:224
    ds_read_b64_tr_b16 v[22:23], v2 offset:736
    s_waitcnt lgkmcnt(6)
    v_mfma_f32_16x16x32_bf16 v[168:171], v[8:11], v[56:59], v[168:171]
    v_mfma_f32_16x16x32_bf16 v[200:203], v[8:11], v[64:67], v[200:203]
    v_exp_f32 v85, v85
    v_mfma_f32_16x16x32_bf16 v[232:235], v[8:11], v[72:75], v[232:235]
    v_pk_add_f32 v[40:41], v[40:41], v[82:83]
    v_cvt_pk_bf16_f32 v81, v82, v83
    ds_read_b128 v[8:11], v1 offset:8448
    s_waitcnt lgkmcnt(5)
    v_mfma_f32_16x16x32_bf16 v[172:175], v[12:15], v[56:59], v[172:175]
    v_exp_f32 v86, v86
    v_mfma_f32_16x16x32_bf16 v[204:207], v[12:15], v[64:67], v[204:207]
    v_exp_f32 v87, v87
    v_mfma_f32_16x16x32_bf16 v[236:239], v[12:15], v[72:75], v[236:239]
    v_pk_add_f32 v[40:41], v[40:41], v[84:85]
    ds_read_b128 v[12:15], v1 offset:8512
    s_waitcnt lgkmcnt(4)
    v_mfma_f32_16x16x32_bf16 v[176:179], v[16:19], v[56:59], v[176:179]
    v_cvt_pk_bf16_f32 v82, v84, v85
    v_pk_add_f32 v[40:41], v[40:41], v[86:87]
    v_mfma_f32_16x16x32_bf16 v[208:211], v[16:19], v[64:67], v[208:211]
    s_add_u32 m0, s34, 25344
    s_nop 0
    buffer_load_dwordx4 v4, s[8:11], s28 offen offset:0 nt lds
    v_cvt_pk_bf16_f32 v83, v86, v87
    v_mfma_f32_16x16x32_bf16 v[240:243], v[16:19], v[72:75], v[240:243]
    v_exp_f32 v88, v88
    ds_read_b128 v[16:19], v1 offset:8576
    s_waitcnt lgkmcnt(3)
    v_mfma_f32_16x16x32_bf16 v[180:183], v[20:23], v[56:59], v[180:183]
    v_exp_f32 v89, v89
    v_mfma_f32_16x16x32_bf16 v[212:215], v[20:23], v[64:67], v[212:215]
    v_exp_f32 v90, v90
    v_mfma_f32_16x16x32_bf16 v[244:247], v[20:23], v[72:75], v[244:247]
    v_exp_f32 v91, v91
    ds_read_b128 v[20:23], v1 offset:8640
    s_waitcnt lgkmcnt(3)
    v_mfma_f32_16x16x32_bf16 v[56:59], v[8:11], v[104:107], v[28:31]
    v_pk_add_f32 v[42:43], v[42:43], v[88:89]
    v_mfma_f32_16x16x32_bf16 v[64:67], v[8:11], v[120:123], v[32:35]
    v_cvt_pk_bf16_f32 v88, v88, v89
    v_exp_f32 v92, v92
    v_mfma_f32_16x16x32_bf16 v[72:75], v[8:11], v[136:139], v[36:39]
    ds_read_b128 v[8:11], v1 offset:8960
    s_waitcnt lgkmcnt(3)
    v_mfma_f32_16x16x32_bf16 v[56:59], v[12:15], v[108:111], v[56:59]
    v_exp_f32 v93, v93
    v_mfma_f32_16x16x32_bf16 v[64:67], v[12:15], v[124:127], v[64:67]
    v_pk_add_f32 v[42:43], v[42:43], v[90:91]
    v_cvt_pk_bf16_f32 v89, v90, v91
    v_mfma_f32_16x16x32_bf16 v[72:75], v[12:15], v[140:143], v[72:75]
    v_exp_f32 v94, v94
    ds_read_b128 v[12:15], v1 offset:9024
    s_waitcnt lgkmcnt(3)
    s_cmp_lg_u32 s36, 0
    s_cbranch_scc1 K1_r2_5
K1_b2_5:
    v_mfma_f32_16x16x32_bf16 v[56:59], v[16:19], v[112:115], v[56:59]
    v_exp_f32 v95, v95
    v_mfma_f32_16x16x32_bf16 v[64:67], v[16:19], v[128:131], v[64:67]
    s_add_u32 m0, s34, 26144
    s_nop 0
    buffer_load_dwordx4 v4, s[8:11], s28 offen offset:256 nt lds
    v_pk_add_f32 v[42:43], v[42:43], v[92:93]
    v_mfma_f32_16x16x32_bf16 v[72:75], v[16:19], v[144:147], v[72:75]
    v_cvt_pk_bf16_f32 v90, v92, v93
    v_pk_add_f32 v[42:43], v[42:43], v[94:95]
    ds_read_b128 v[16:19], v1 offset:9088
    s_waitcnt lgkmcnt(3)
    v_mfma_f32_16x16x32_bf16 v[56:59], v[20:23], v[116:119], v[56:59]
    v_cvt_pk_bf16_f32 v91, v94, v95
    v_mfma_f32_16x16x32_bf16 v[64:67], v[20:23], v[132:135], v[64:67]
    v_exp_f32 v96, v96
    v_mfma_f32_16x16x32_bf16 v[72:75], v[20:23], v[148:151], v[72:75]
    v_exp_f32 v97, v97
    ds_read_b128 v[20:23], v1 offset:9152
    s_waitcnt lgkmcnt(3)
    v_mfma_f32_16x16x32_bf16 v[60:63], v[8:11], v[104:107], v[28:31]
    v_exp_f32 v98, v98
    v_mfma_f32_16x16x32_bf16 v[68:71], v[8:11], v[120:123], v[32:35]
    v_exp_f32 v99, v99
    v_mfma_f32_16x16x32_bf16 v[76:79], v[8:11], v[136:139], v[36:39]
    v_pk_add_f32 v[44:45], v[44:45], v[96:97]
    s_waitcnt lgkmcnt(2)
    v_mfma_f32_16x16x32_bf16 v[60:63], v[12:15], v[108:111], v[60:63]
    v_cvt_pk_bf16_f32 v96, v96, v97
    v_exp_f32 v100, v100
    v_mfma_f32_16x16x32_bf16 v[68:71], v[12:15], v[124:127], v[68:71]
    v_mfma_f32_16x16x32_bf16 v[76:79], v[12:15], v[140:143], v[76:79]
    v_exp_f32 v101, v101
    s_waitcnt vmcnt(4) lgkmcnt(0)
    s_barrier
    ds_read_b64_tr_b16 v[8:9], v2 offset:33792
    ds_read_b64_tr_b16 v[10:11], v2 offset:34304
    ds_read_b64_tr_b16 v[12:13], v2 offset:33824
    ds_read_b64_tr_b16 v[14:15], v2 offset:34336
    v_mfma_f32_16x16x32_bf16 v[60:63], v[16:19], v[112:115], v[60:63]
    v_pk_add_f32 v[44:45], v[44:45], v[98:99]
    v_cvt_pk_bf16_f32 v97, v98, v99
    v_mfma_f32_16x16x32_bf16 v[68:71], v[16:19], v[128:131], v[68:71]
    s_add_u32 s29, s55, s54
    s_and_b32 s29, s29, 31
    s_lshl_b32 s29, s29, 13
    s_cmp_ge_u32 s55, 32
    s_cselect_b32 s29, 0x40000000, s29
    s_add_u32 s55, s55, 1
    s_add_u32 s28, s56, s54
    s_and_b32 s28, s28, 31
    s_lshl_b32 s28, s28, 13
    s_cmp_ge_u32 s56, 32
    s_cselect_b32 s28, 0x40000000, s28
    s_add_u32 s56, s56, 1
    s_add_u32 m0, s34, 50688
    s_nop 0
    buffer_load_dwordx4 v4, s[12:15], s29 offen offset:0 nt lds
    v_exp_f32 v102, v102
    v_mfma_f32_16x16x32_bf16 v[76:79], v[16:19], v[144:147], v[76:79]
    v_exp_f32 v103, v103
    ds_read_b64_tr_b16 v[16:17], v2 offset:33856
    ds_read_b64_tr_b16 v[18:19], v2 offset:34368
    v_mfma_f32_16x16x32_bf16 v[60:63], v[20:23], v[116:119], v[60:63]
    v_pk_add_f32 v[44:45], v[44:45], v[100:101]
    v_mfma_f32_16x16x32_bf16 v[68:71], v[20:23], v[132:135], v[68:71]
    v_cvt_pk_bf16_f32 v98, v100, v101
    v_pk_add_f32 v[44:45], v[44:45], v[102:103]
    v_mfma_f32_16x16x32_bf16 v[76:79], v[20:23], v[148:151], v[76:79]
    v_cvt_pk_bf16_f32 v99, v102, v103
    ds_read_b64_tr_b16 v[20:21], v2 offset:33888
    ds_read_b64_tr_b16 v[22:23], v2 offset:34400
    s_waitcnt lgkmcnt(6)
    v_mfma_f32_16x16x32_bf16 v[152:155], v[8:11], v[80:83], v[152:155]
    v_max3_f32 v49, v56, v57, v58
    v_max3_f32 v49, v49, v59, v64
    v_mfma_f32_16x16x32_bf16 v[184:187], v[8:11], v[88:91], v[184:187]
    v_max3_f32 v49, v49, v65, v66
    v_max3_f32 v49, v49, v67, v72
    v_mfma_f32_16x16x32_bf16 v[216:219], v[8:11], v[96:99], v[216:219]
    v_max3_f32 v49, v49, v73, v74
    v_max_f32 v49, v49, v75
    ds_read_b64_tr_b16 v[8:9], v2 offset:33920
    ds_read_b64_tr_b16 v[10:11], v2 offset:34432
    s_waitcnt lgkmcnt(6)
    v_mfma_f32_16x16x32_bf16 v[156:159], v[12:15], v[80:83], v[156:159]
    v_max3_f32 v49, v49, v60, v61
    v_max3_f32 v49, v49, v62, v63
    v_mfma_f32_16x16x32_bf16 v[188:191], v[12:15], v[88:91], v[188:191]
    v_max3_f32 v49, v49, v68, v69
    v_max3_f32 v49, v49, v70, v71
    v_mfma_f32_16x16x32_bf16 v[220:223], v[12:15], v[96:99], v[220:223]
    v_max3_f32 v49, v49, v76, v77
    v_max3_f32 v49, v49, v78, v79
    ds_read_b64_tr_b16 v[12:13], v2 offset:33952
    ds_read_b64_tr_b16 v[14:15], v2 offset:34464
    s_waitcnt lgkmcnt(6)
    v_cmp_lt_f32 vcc, 0x41000000, v49
    s_cbranch_vccnz K1_r1_6
K1_b1_6:
    v_mfma_f32_16x16x32_bf16 v[160:163], v[16:19], v[80:83], v[160:163]
    v_exp_f32 v56, v56
    v_mfma_f32_16x16x32_bf16 v[192:195], v[16:19], v[88:91], v[192:195]
    s_add_u32 m0, s34, 51488
    s_nop 0
    buffer_load_dwordx4 v4, s[12:15], s29 offen offset:256 nt lds
    v_exp_f32 v57, v57
    v_mfma_f32_16x16x32_bf16 v[224:227], v[16:19], v[96:99], v[224:227]
    v_exp_f32 v58, v58
    ds_read_b64_tr_b16 v[16:17], v2 offset:33984
    ds_read_b64_tr_b16 v[18:19], v2 offset:34496
    s_waitcnt lgkmcnt(6)
    v_mfma_f32_16x16x32_bf16 v[164:167], v[20:23], v[80:83], v[164:167]
    v_exp_f32 v59, v59
    v_mfma_f32_16x16x32_bf16 v[196:199], v[20:23], v[88:91], v[196:199]
    v_pk_add_f32 v[40:41], v[40:41], v[56:57]
    v_mfma_f32_16x16x32_bf16 v[228:231], v[20:23], v[96:99], v[228:231]
    v_cvt_pk_bf16_f32 v56, v56, v57
    v_exp_f32 v60, v60
    ds_read_b64_tr_b16 v[20:21], v2 offset:34016
    ds_read_b64_tr_b16 v[22:23], v2 offset:34528
    s_waitcnt lgkmcnt(6)
    v_mfma_f32_16x16x32_bf16 v[168:171], v[8:11], v[80:83], v[168:171]
    v_mfma_f32_16x16x32_bf16 v[200:203], v[8:11], v[88:91], v[200:203]
    v_exp_f32 v61, v61
    v_mfma_f32_16x16x32_bf16 v[232:235], v[8:11], v[96:99], v[232:235]
    v_pk_add_f32 v[40:41], v[40:41], v[58:59]
    v_cvt_pk_bf16_f32 v57, v58, v59
    ds_read_b128 v[8:11], v1 offset:42240
    s_waitcnt lgkmcnt(5)
    v_mfma_f32_16x16x32_bf16 v[172:175], v[12:15], v[80:83], v[172:175]
    v_exp_f32 v62, v62
    v_mfma_f32_16x16x32_bf16 v[204:207], v[12:15], v[88:91], v[204:207]
    v_exp_f32 v63, v63
    v_mfma_f32_16x16x32_bf16 v[236:239], v[12:15], v[96:99], v[236:239]
    v_pk_add_f32 v[40:41], v[40:41], v[60:61]
    ds_read_b128 v[12:15], v1 offset:42304
    s_waitcnt lgkmcnt(4)
    v_mfma_f32_16x16x32_bf16 v[176:179], v[16:19], v[80:83], v[176:179]
    v_cvt_pk_bf16_f32 v58, v60, v61
    v_pk_add_f32 v[40:41], v[40:41], v[62:63]
    v_mfma_f32_16x16x32_bf16 v[208:211], v[16:19], v[88:91], v[208:211]
    s_add_u32 m0, s34, 59136
    s_nop 0
    buffer_load_dwordx4 v4, s[8:11], s28 offen offset:0 nt lds
    v_cvt_pk_bf16_f32 v59, v62, v63
    v_mfma_f32_16x16x32_bf16 v[240:243], v[16:19], v[96:99], v[240:243]
    v_exp_f32 v64, v64
    ds_read_b128 v[16:19], v1 offset:42368
    s_waitcnt lgkmcnt(3)
    v_mfma_f32_16x16x32_bf16 v[180:183], v[20:23], v[80:83], v[180:183]
    v_exp_f32 v65, v65
    v_mfma_f32_16x16x32_bf16 v[212:215], v[20:23], v[88:91], v[212:215]
    v_exp_f32 v66, v66
    v_mfma_f32_16x16x32_bf16 v[244:247], v[20:23], v[96:99], v[244:247]
    v_exp_f32 v67, v67
    ds_read_b128 v[20:23], v1 offset:42432
    s_waitcnt lgkmcnt(3)
    v_mfma_f32_16x16x32_bf16 v[80:83], v[8:11], v[104:107], v[28:31]
    v_pk_add_f32 v[42:43], v[42:43], v[64:65]
    v_mfma_f32_16x16x32_bf16 v[88:91], v[8:11], v[120:123], v[32:35]
    v_cvt_pk_bf16_f32 v64, v64, v65
    v_exp_f32 v68, v68
    v_mfma_f32_16x16x32_bf16 v[96:99], v[8:11], v[136:139], v[36:39]
    ds_read_b128 v[8:11], v1 offset:42752
    s_waitcnt lgkmcnt(3)
    v_mfma_f32_16x16x32_bf16 v[80:83], v[12:15], v[108:111], v[80:83]
    v_exp_f32 v69, v69
    v_mfma_f32_16x16x32_bf16 v[88:91], v[12:15], v[124:127], v[88:91]
    v_pk_add_f32 v[42:43], v[42:43], v[66:67]
    v_cvt_pk_bf16_f32 v65, v66, v67
    v_mfma_f32_16x16x32_bf16 v[96:99], v[12:15], v[140:143], v[96:99]
    v_exp_f32 v70, v70
    ds_read_b128 v[12:15], v1 offset:42816
    s_waitcnt lgkmcnt(3)
    s_cmp_lg_u32 s36, 0
    s_cbranch_scc1 K1_r2_7
K1_b2_7:
    v_mfma_f32_16x16x32_bf16 v[80:83], v[16:19], v[112:115], v[80:83]
    v_exp_f32 v71, v71
    v_mfma_f32_16x16x32_bf16 v[88:91], v[16:19], v[128:131], v[88:91]
    s_add_u32 m0, s34, 59936
    s_nop 0
    buffer_load_dwordx4 v4, s[8:11], s28 offen offset:256 nt lds
    v_pk_add_f32 v[42:43], v[42:43], v[68:69]
    v_mfma_f32_16x16x32_bf16 v[96:99], v[16:19], v[144:147], v[96:99]
    v_cvt_pk_bf16_f32 v66, v68, v69
    v_pk_add_f32 v[42:43], v[42:43], v[70:71]
    ds_read_b128 v[16:19], v1 offset:42880
    s_waitcnt lgkmcnt(3)
    v_mfma_f32_16x16x32_bf16 v[80:83], v[20:23], v[116:119], v[80:83]
    v_cvt_pk_bf16_f32 v67, v70, v71
    v_mfma_f32_16x16x32_bf16 v[88:91], v[20:23], v[132:135], v[88:91]
    v_exp_f32 v72, v72
    v_mfma_f32_16x16x32_bf16 v[96:99], v[20:23], v[148:151], v[96:99]
    v_exp_f32 v73, v73
    ds_read_b128 v[20:23], v1 offset:42944
    s_waitcnt lgkmcnt(3)
    v_mfma_f32_16x16x32_bf16 v[84:87], v[8:11], v[104:107], v[28:31]
    v_exp_f32 v74, v74
    v_mfma_f32_16x16x32_bf16 v[92:95], v[8:11], v[120:123], v[32:35]
    v_exp_f32 v75, v75
    v_mfma_f32_16x16x32_bf16 v[100:103], v[8:11], v[136:139], v[36:39]
    v_pk_add_f32 v[44:45], v[44:45], v[72:73]
    s_waitcnt lgkmcnt(2)
    v_mfma_f32_16x16x32_bf16 v[84:87], v[12:15], v[108:111], v[84:87]
    v_cvt_pk_bf16_f32 v72, v72, v73
    v_exp_f32 v76, v76
    v_mfma_f32_16x16x32_bf16 v[92:95], v[12:15], v[124:127], v[92:95]
    v_mfma_f32_16x16x32_bf16 v[100:103], v[12:15], v[140:143], v[100:103]
    v_exp_f32 v77, v77
    s_waitcnt vmcnt(4) lgkmcnt(0)
    s_barrier
    ds_read_b64_tr_b16 v[8:9], v2 offset:16896
    ds_read_b64_tr_b16 v[10:11], v2 offset:17408
    ds_read_b64_tr_b16 v[12:13], v2 offset:16928
    ds_read_b64_tr_b16 v[14:15], v2 offset:17440
    v_mfma_f32_16x16x32_bf16 v[84:87], v[16:19], v[112:115], v[84:87]
    v_pk_add_f32 v[44:45], v[44:45], v[74:75]
    v_cvt_pk_bf16_f32 v73, v74, v75
    v_mfma_f32_16x16x32_bf16 v[92:95], v[16:19], v[128:131], v[92:95]
    s_add_u32 s29, s55, s54
    s_and_b32 s29, s29, 31
    s_lshl_b32 s29, s29, 13
    s_cmp_ge_u32 s55, 32
    s_cselect_b32 s29, 0x40000000, s29
    s_add_u32 s55, s55, 1
    s_add_u32 s28, s56, s54
    s_and_b32 s28, s28, 31
    s_lshl_b32 s28, s28, 13
    s_cmp_ge_u32 s56, 32
    s_cselect_b32 s28, 0x40000000, s28
    s_add_u32 s56, s56, 1
    s_add_u32 m0, s34, 0
    s_nop 0
    buffer_load_dwordx4 v4, s[12:15], s29 offen offset:0 nt lds
    v_exp_f32 v78, v78
    v_mfma_f32_16x16x32_bf16 v[100:103], v[16:19], v[144:147], v[100:103]
    v_exp_f32 v79, v79
    ds_read_b64_tr_b16 v[16:17], v2 offset:16960
    ds_read_b64_tr_b16 v[18:19], v2 offset:17472
    v_mfma_f32_16x16x32_bf16 v[84:87], v[20:23], v[116:119], v[84:87]
    v_pk_add_f32 v[44:45], v[44:45], v[76:77]
    v_mfma_f32_16x16x32_bf16 v[92:95], v[20:23], v[132:135], v[92:95]
    v_cvt_pk_bf16_f32 v74, v76, v77
    v_pk_add_f32 v[44:45], v[44:45], v[78:79]
    v_mfma_f32_16x16x32_bf16 v[100:103], v[20:23], v[148:151], v[100:103]
    v_cvt_pk_bf16_f32 v75, v78, v79
    s_mov_b32 s35, 6
K1_loop:
    ds_read_b64_tr_b16 v[20:21], v2 offset:16992
    ds_read_b64_tr_b16 v[22:23], v2 offset:17504
    s_waitcnt lgkmcnt(6)
    v_mfma_f32_16x16x32_bf16 v[152:155], v[8:11], v[56:59], v[152:155]
    v_max3_f32 v49, v80, v81, v82
    v_max3_f32 v49, v49, v83, v88
    v_mfma_f32_16x16x32_bf16 v[184:187], v[8:11], v[64:67], v[184:187]
    v_max3_f32 v49, v49, v89, v90
    v_max3_f32 v49, v49, v91, v96
    v_mfma_f32_16x16x32_bf16 v[216:219], v[8:11], v[72:75], v[216:219]
    v_max3_f32 v49, v49, v97, v98
    v_max_f32 v49, v49, v99
    ds_read_b64_tr_b16 v[8:9], v2 offset:17024
    ds_read_b64_tr_b16 v[10:11], v2 offset:17536
    s_waitcnt lgkmcnt(6)
    v_mfma_f32_16x16x32_bf16 v[156:159], v[12:15], v[56:59], v[156:159]
    v_max3_f32 v49, v49, v84, v85
    v_max3_f32 v49, v49, v86, v87
    v_mfma_f32_16x16x32_bf16 v[188:191], v[12:15], v[64:67], v[188:191]
    v_max3_f32 v49, v49, v92, v93
    v_max3_f32 v49, v49, v94, v95
    v_mfma_f32_16x16x32_bf16 v[220:223], v[12:15], v[72:75], v[220:223]
    v_max3_f32 v49, v49, v100, v101
    v_max3_f32 v49, v49, v102, v103
    ds_read_b64_tr_b16 v[12:13], v2 offset:17056
    ds_read_b64_tr_b16 v[14:15], v2 offset:17568
    s_waitcnt lgkmcnt(6)
    v_cmp_lt_f32 vcc, 0x41000000, v49
    s_cbranch_vccnz K1_r1_8
K1_b1_8:
    v_mfma_f32_16x16x32_bf16 v[160:163], v[16:19], v[56:59], v[160:163]
    v_exp_f32 v80, v80
    v_mfma_f32_16x16x32_bf16 v[192:195], v[16:19], v[64:67], v[192:195]
    s_add_u32 m0, s34, 800
    s_nop 0
    buffer_load_dwordx4 v4, s[12:15], s29 offen offset:256 nt lds
    v_exp_f32 v81, v81
    v_mfma_f32_16x16x32_bf16 v[224:227], v[16:19], v[72:75], v[224:227]
    v_exp_f32 v82, v82
    ds_read_b64_tr_b16 v[16:17], v2 offset:17088
    ds_read_b64_tr_b16 v[18:19], v2 offset:17600
    s_waitcnt lgkmcnt(6)
    v_mfma_f32_16x16x32_bf16 v[164:167], v[20:23], v[56:59], v[164:167]
    v_exp_f32 v83, v83
    v_mfma_f32_16x16x32_bf16 v[196:199], v[20:23], v[64:67], v[196:199]
    v_pk_add_f32 v[40:41], v[40:41], v[80:81]
    v_mfma_f32_16x16x32_bf16 v[228:231], v[20:23], v[72:75], v[228:231]
    v_cvt_pk_bf16_f32 v80, v80, v81
    v_exp_f32 v84, v84
    ds_read_b64_tr_b16 v[20:21], v2 offset:17120
    ds_read_b64_tr_b16 v[22:23], v2 offset:17632
    s_waitcnt lgkmcnt(6)
    v_mfma_f32_16x16x32_bf16 v[168:171], v[8:11], v[56:59], v[168:171]
    v_mfma_f32_16x16x32_bf16 v[200:203], v[8:11], v[64:67], v[200:203]
    v_exp_f32 v85, v85
    v_mfma_f32_16x16x32_bf16 v[232:235], v[8:11], v[72:75], v[232:235]
    v_pk_add_f32 v[40:41], v[40:41], v[82:83]
    v_cvt_pk_bf16_f32 v81, v82, v83
    ds_read_b128 v[8:11], v1 offset:25344
    s_waitcnt lgkmcnt(5)
    v_mfma_f32_16x16x32_bf16 v[172:175], v[12:15], v[56:59], v[172:175]
    v_exp_f32 v86, v86
    v_mfma_f32_16x16x32_bf16 v[204:207], v[12:15], v[64:67], v[204:207]
    v_exp_f32 v87, v87
    v_mfma_f32_16x16x32_bf16 v[236:239], v[12:15], v[72:75], v[236:239]
    v_pk_add_f32 v[40:41], v[40:41], v[84:85]
    ds_read_b128 v[12:15], v1 offset:25408
    s_waitcnt lgkmcnt(4)
    v_mfma_f32_16x16x32_bf16 v[176:179], v[16:19], v[56:59], v[176:179]
    v_cvt_pk_bf16_f32 v82, v84, v85
    v_pk_add_f32 v[40:41], v[40:41], v[86:87]
    v_mfma_f32_16x16x32_bf16 v[208:211], v[16:19], v[64:67], v[208:211]
    s_add_u32 m0, s34, 8448
    s_nop 0
    buffer_load_dwordx4 v4, s[8:11], s28 offen offset:0 nt lds
    v_cvt_pk_bf16_f32 v83, v86, v87
    v_mfma_f32_16x16x32_bf16 v[240:243], v[16:19], v[72:75], v[240:243]
    v_exp_f32 v88, v88
    ds_read_b128 v[16:19], v1 offset:25472
    s_waitcnt lgkmcnt(3)
    v_mfma_f32_16x16x32_bf16 v[180:183], v[20:23], v[56:59], v[180:183]
    v_exp_f32 v89, v89
    v_mfma_f32_16x16x32_bf16 v[212:215], v[20:23], v[64:67], v[212:215]
    v_exp_f32 v90, v90
    v_mfma_f32_16x16x32_bf16 v[244:247], v[20:23], v[72:75], v[244:247]
    v_exp_f32 v91, v91
    ds_read_b128 v[20:23], v1 offset:25536
    s_waitcnt lgkmcnt(3)
    v_mfma_f32_16x16x32_bf16 v[56:59], v[8:11], v[104:107], v[28:31]
    v_pk_add_f32 v[42:43], v[42:43], v[88:89]
    v_mfma_f32_16x16x32_bf16 v[64:67], v[8:11], v[120:123], v[32:35]
    v_cvt_pk_bf16_f32 v88, v88, v89
    v_exp_f32 v92, v92
    v_mfma_f32_16x16x32_bf16 v[72:75], v[8:11], v[136:139], v[36:39]
    ds_read_b128 v[8:11], v1 offset:25856
    s_waitcnt lgkmcnt(3)
    v_mfma_f32_16x16x32_bf16 v[56:59], v[12:15], v[108:111], v[56:59]
    v_exp_f32 v93, v93
    v_mfma_f32_16x16x32_bf16 v[64:67], v[12:15], v[124:127], v[64:67]
    v_pk_add_f32 v[42:43], v[42:43], v[90:91]
    v_cvt_pk_bf16_f32 v89, v90, v91
    v_mfma_f32_16x16x32_bf16 v[72:75], v[12:15], v[140:143], v[72:75]
    v_exp_f32 v94, v94
    ds_read_b128 v[12:15], v1 offset:25920
    s_waitcnt lgkmcnt(3)
    s_cmp_lg_u32 s36, 0
    s_cbranch_scc1 K1_r2_9
K1_b2_9:
    v_mfma_f32_16x16x32_bf16 v[56:59], v[16:19], v[112:115], v[56:59]
    v_exp_f32 v95, v95
    v_mfma_f32_16x16x32_bf16 v[64:67], v[16:19], v[128:131], v[64:67]
    s_add_u32 m0, s34, 9248
    s_nop 0
    buffer_load_dwordx4 v4, s[8:11], s28 offen offset:256 nt lds
    v_pk_add_f32 v[42:43], v[42:43], v[92:93]
    v_mfma_f32_16x16x32_bf16 v[72:75], v[16:19], v[144:147], v[72:75]
    v_cvt_pk_bf16_f32 v90, v92, v93
    v_pk_add_f32 v[42:43], v[42:43], v[94:95]
    ds_read_b128 v[16:19], v1 offset:25984
    s_waitcnt lgkmcnt(3)
    v_mfma_f32_16x16x32_bf16 v[56:59], v[20:23], v[116:119], v[56:59]
    v_cvt_pk_bf16_f32 v91, v94, v95
    v_mfma_f32_16x16x32_bf16 v[64:67], v[20:23], v[132:135], v[64:67]
    v_exp_f32 v96, v96
    v_mfma_f32_16x16x32_bf16 v[72:75], v[20:23], v[148:151], v[72:75]
    v_exp_f32 v97, v97
    ds_read_b128 v[20:23], v1 offset:26048
    s_waitcnt lgkmcnt(3)
    v_mfma_f32_16x16x32_bf16 v[60:63], v[8:11], v[104:107], v[28:31]
    v_exp_f32 v98, v98
    v_mfma_f32_16x16x32_bf16 v[68:71], v[8:11], v[120:123], v[32:35]
    v_exp_f32 v99, v99
    v_mfma_f32_16x16x32_bf16 v[76:79], v[8:11], v[136:139], v[36:39]
    v_pk_add_f32 v[44:45], v[44:45], v[96:97]
    s_waitcnt lgkmcnt(2)
    v_mfma_f32_16x16x32_bf16 v[60:63], v[12:15], v[108:111], v[60:63]
    v_cvt_pk_bf16_f32 v96, v96, v97
    v_exp_f32 v100, v100
    v_mfma_f32_16x16x32_bf16 v[68:71], v[12:15], v[124:127], v[68:71]
    v_mfma_f32_16x16x32_bf16 v[76:79], v[12:15], v[140:143], v[76:79]
    v_exp_f32 v101, v101
    s_waitcnt vmcnt(4) lgkmcnt(0)
    s_barrier
    ds_read_b64_tr_b16 v[8:9], v2 offset:50688
    ds_read_b64_tr_b16 v[10:11], v2 offset:51200
    ds_read_b64_tr_b16 v[12:13], v2 offset:50720
    ds_read_b64_tr_b16 v[14:15], v2 offset:51232
    v_mfma_f32_16x16x32_bf16 v[60:63], v[16:19], v[112:115], v[60:63]
    v_pk_add_f32 v[44:45], v[44:45], v[98:99]
    v_cvt_pk_bf16_f32 v97, v98, v99
    v_mfma_f32_16x16x32_bf16 v[68:71], v[16:19], v[128:131], v[68:71]
    s_add_u32 s29, s55, s54
    s_and_b32 s29, s29, 31
    s_lshl_b32 s29, s29, 13
    s_cmp_ge_u32 s55, 32
    s_cselect_b32 s29, 0x40000000, s29
    s_add_u32 s55, s55, 1
    s_add_u32 s28, s56, s54
    s_and_b32 s28, s28, 31
    s_lshl_b32 s28, s28, 13
    s_cmp_ge_u32 s56, 32
    s_cselect_b32 s28, 0x40000000, s28
    s_add_u32 s56, s56, 1
    s_add_u32 m0, s34, 33792
    s_nop 0
    buffer_load_dwordx4 v4, s[12:15], s29 offen offset:0 nt lds
    v_exp_f32 v102, v102
    v_mfma_f32_16x16x32_bf16 v[76:79], v[16:19], v[144:147], v[76:79]
    v_exp_f32 v103, v103
    ds_read_b64_tr_b16 v[16:17], v2 offset:50752
    ds_read_b64_tr_b16 v[18:19], v2 offset:51264
    v_mfma_f32_16x16x32_bf16 v[60:63], v[20:23], v[116:119], v[60:63]
    v_pk_add_f32 v[44:45], v[44:45], v[100:101]
    v_mfma_f32_16x16x32_bf16 v[68:71], v[20:23], v[132:135], v[68:71]
    v_cvt_pk_bf16_f32 v98, v100, v101
    v_pk_add_f32 v[44:45], v[44:45], v[102:103]
    v_mfma_f32_16x16x32_bf16 v[76:79], v[20:23], v[148:151], v[76:79]
    v_cvt_pk_bf16_f32 v99, v102, v103
    ds_read_b64_tr_b16 v[20:21], v2 offset:50784
    ds_read_b64_tr_b16 v[22:23], v2 offset:51296
    s_waitcnt lgkmcnt(6)
    v_mfma_f32_16x16x32_bf16 v[152:155], v[8:11], v[80:83], v[152:155]
    v_max3_f32 v49, v56, v57, v58
    v_max3_f32 v49, v49, v59, v64
    v_mfma_f32_16x16x32_bf16 v[184:187], v[8:11], v[88:91], v[184:187]
    v_max3_f32 v49, v49, v65, v66
    v_max3_f32 v49, v49, v67, v72
    v_mfma_f32_16x16x32_bf16 v[216:219], v[8:11], v[96:99], v[216:219]
    v_max3_f32 v49, v49, v73, v74
    v_max_f32 v49, v49, v75
    ds_read_b64_tr_b16 v[8:9], v2 offset:50816
    ds_read_b64_tr_b16 v[10:11], v2 offset:51328
    s_waitcnt lgkmcnt(6)
    v_mfma_f32_16x16x32_bf16 v[156:159], v[12:15], v[80:83], v[156:159]
    v_max3_f32 v49, v49, v60, v61
    v_max3_f32 v49, v49, v62, v63
    v_mfma_f32_16x16x32_bf16 v[188:191], v[12:15], v[88:91], v[188:191]
    v_max3_f32 v49, v49, v68, v69
    v_max3_f32 v49, v49, v70, v71
    v_mfma_f32_16x16x32_bf16 v[220:223], v[12:15], v[96:99], v[220:223]
    v_max3_f32 v49, v49, v76, v77
    v_max3_f32 v49, v49, v78, v79
    ds_read_b64_tr_b16 v[12:13], v2 offset:50848
    ds_read_b64_tr_b16 v[14:15], v2 offset:51360
    s_waitcnt lgkmcnt(6)
    v_cmp_lt_f32 vcc, 0x41000000, v49
    s_cbranch_vccnz K1_r1_10
K1_b1_10:
    v_mfma_f32_16x16x32_bf16 v[160:163], v[16:19], v[80:83], v[160:163]
    v_exp_f32 v56, v56
    v_mfma_f32_16x16x32_bf16 v[192:195], v[16:19], v[88:91], v[192:195]
    s_add_u32 m0, s34, 34592
    s_nop 0
    buffer_load_dwordx4 v4, s[12:15], s29 offen offset:256 nt lds
    v_exp_f32 v57, v57
    v_mfma_f32_16x16x32_bf16 v[224:227], v[16:19], v[96:99], v[224:227]
    v_exp_f32 v58, v58
    ds_read_b64_tr_b16 v[16:17], v2 offset:50880
    ds_read_b64_tr_b16 v[18:19], v2 offset:51392
    s_waitcnt lgkmcnt(6)
    v_mfma_f32_16x16x32_bf16 v[164:167], v[20:23], v[80:83], v[164:167]
    v_exp_f32 v59, v59
    v_mfma_f32_16x16x32_bf16 v[196:199], v[20:23], v[88:91], v[196:199]
    v_pk_add_f32 v[40:41], v[40:41], v[56:57]
    v_mfma_f32_16x16x32_bf16 v[228:231], v[20:23], v[96:99], v[228:231]
    v_cvt_pk_bf16_f32 v56, v56, v57
    v_exp_f32 v60, v60
    ds_read_b64_tr_b16 v[20:21], v2 offset:50912
    ds_read_b64_tr_b16 v[22:23], v2 offset:51424
    s_waitcnt lgkmcnt(6)
    v_mfma_f32_16x16x32_bf16 v[168:171], v[8:11], v[80:83], v[168:171]
    v_mfma_f32_16x16x32_bf16 v[200:203], v[8:11], v[88:91], v[200:203]
    v_exp_f32 v61, v61
    v_mfma_f32_16x16x32_bf16 v[232:235], v[8:11], v[96:99], v[232:235]
    v_pk_add_f32 v[40:41], v[40:41], v[58:59]
    v_cvt_pk_bf16_f32 v57, v58, v59
    ds_read_b128 v[8:11], v1 offset:59136
    s_waitcnt lgkmcnt(5)
    v_mfma_f32_16x16x32_bf16 v[172:175], v[12:15], v[80:83], v[172:175]
    v_exp_f32 v62, v62
    v_mfma_f32_16x16x32_bf16 v[204:207], v[12:15], v[88:91], v[204:207]
    v_exp_f32 v63, v63
    v_mfma_f32_16x16x32_bf16 v[236:239], v[12:15], v[96:99], v[236:239]
    v_pk_add_f32 v[40:41], v[40:41], v[60:61]
    ds_read_b128 v[12:15], v1 offset:59200
    s_waitcnt lgkmcnt(4)
    v_mfma_f32_16x16x32_bf16 v[176:179], v[16:19], v[80:83], v[176:179]
    v_cvt_pk_bf16_f32 v58, v60, v61
    v_pk_add_f32 v[40:41], v[40:41], v[62:63]
    v_mfma_f32_16x16x32_bf16 v[208:211], v[16:19], v[88:91], v[208:211]
    s_add_u32 m0, s34, 42240
    s_nop 0
    buffer_load_dwordx4 v4, s[8:11], s28 offen offset:0 nt lds
    v_cvt_pk_bf16_f32 v59, v62, v63
    v_mfma_f32_16x16x32_bf16 v[240:243], v[16:19], v[96:99], v[240:243]
    v_exp_f32 v64, v64
    ds_read_b128 v[16:19], v1 offset:59264
    s_waitcnt lgkmcnt(3)
    v_mfma_f32_16x16x32_bf16 v[180:183], v[20:23], v[80:83], v[180:183]
    v_exp_f32 v65, v65
    v_mfma_f32_16x16x32_bf16 v[212:215], v[20:23], v[88:91], v[212:215]
    v_exp_f32 v66, v66
    v_mfma_f32_16x16x32_bf16 v[244:247], v[20:23], v[96:99], v[244:247]
    v_exp_f32 v67, v67
    ds_read_b128 v[20:23], v1 offset:59328
    s_waitcnt lgkmcnt(3)
    v_mfma_f32_16x16x32_bf16 v[80:83], v[8:11], v[104:107], v[28:31]
    v_pk_add_f32 v[42:43], v[42:43], v[64:65]
    v_mfma_f32_16x16x32_bf16 v[88:91], v[8:11], v[120:123], v[32:35]
    v_cvt_pk_bf16_f32 v64, v64, v65
    v_exp_f32 v68, v68
    v_mfma_f32_16x16x32_bf16 v[96:99], v[8:11], v[136:139], v[36:39]
    ds_read_b128 v[8:11], v1 offset:59648
    s_waitcnt lgkmcnt(3)
    v_mfma_f32_16x16x32_bf16 v[80:83], v[12:15], v[108:111], v[80:83]
    v_exp_f32 v69, v69
    v_mfma_f32_16x16x32_bf16 v[88:91], v[12:15], v[124:127], v[88:91]
    v_pk_add_f32 v[42:43], v[42:43], v[66:67]
    v_cvt_pk_bf16_f32 v65, v66, v67
    v_mfma_f32_16x16x32_bf16 v[96:99], v[12:15], v[140:143], v[96:99]
    v_exp_f32 v70, v70
    ds_read_b128 v[12:15], v1 offset:59712
    s_waitcnt lgkmcnt(3)
    s_cmp_lg_u32 s36, 0
    s_cbranch_scc1 K1_r2_11
K1_b2_11:
    v_mfma_f32_16x16x32_bf16 v[80:83], v[16:19], v[112:115], v[80:83]
    v_exp_f32 v71, v71
    v_mfma_f32_16x16x32_bf16 v[88:91], v[16:19], v[128:131], v[88:91]
    s_add_u32 m0, s34, 43040
    s_nop 0
    buffer_load_dwordx4 v4, s[8:11], s28 offen offset:256 nt lds
    v_pk_add_f32 v[42:43], v[42:43], v[68:69]
    v_mfma_f32_16x16x32_bf16 v[96:99], v[16:19], v[144:147], v[96:99]
    v_cvt_pk_bf16_f32 v66, v68, v69
    v_pk_add_f32 v[42:43], v[42:43], v[70:71]
    ds_read_b128 v[16:19], v1 offset:59776
    s_waitcnt lgkmcnt(3)
    v_mfma_f32_16x16x32_bf16 v[80:83], v[20:23], v[116:119], v[80:83]
    v_cvt_pk_bf16_f32 v67, v70, v71
    v_mfma_f32_16x16x32_bf16 v[88:91], v[20:23], v[132:135], v[88:91]
    v_exp_f32 v72, v72
    v_mfma_f32_16x16x32_bf16 v[96:99], v[20:23], v[148:151], v[96:99]
    v_exp_f32 v73, v73
    ds_read_b128 v[20:23], v1 offset:59840
    s_waitcnt lgkmcnt(3)
    v_mfma_f32_16x16x32_bf16 v[84:87], v[8:11], v[104:107], v[28:31]
    v_exp_f32 v74, v74
    v_mfma_f32_16x16x32_bf16 v[92:95], v[8:11], v[120:123], v[32:35]
    v_exp_f32 v75, v75
    v_mfma_f32_16x16x32_bf16 v[100:103], v[8:11], v[136:139], v[36:39]
    v_pk_add_f32 v[44:45], v[44:45], v[72:73]
    s_waitcnt lgkmcnt(2)
    v_mfma_f32_16x16x32_bf16 v[84:87], v[12:15], v[108:111], v[84:87]
    v_cvt_pk_bf16_f32 v72, v72, v73
    v_exp_f32 v76, v76
    v_mfma_f32_16x16x32_bf16 v[92:95], v[12:15], v[124:127], v[92:95]
    v_mfma_f32_16x16x32_bf16 v[100:103], v[12:15], v[140:143], v[100:103]
    v_exp_f32 v77, v77
    s_waitcnt vmcnt(4) lgkmcnt(0)
    s_barrier
    ds_read_b64_tr_b16 v[8:9], v2 offset:0
    ds_read_b64_tr_b16 v[10:11], v2 offset:512
    ds_read_b64_tr_b16 v[12:13], v2 offset:32
    ds_read_b64_tr_b16 v[14:15], v2 offset:544
    v_mfma_f32_16x16x32_bf16 v[84:87], v[16:19], v[112:115], v[84:87]
    v_pk_add_f32 v[44:45], v[44:45], v[74:75]
    v_cvt_pk_bf16_f32 v73, v74, v75
    v_mfma_f32_16x16x32_bf16 v[92:95], v[16:19], v[128:131], v[92:95]
    s_add_u32 s29, s55, s54
    s_and_b32 s29, s29, 31
    s_lshl_b32 s29, s29, 13
    s_cmp_ge_u32 s55, 32
    s_cselect_b32 s29, 0x40000000, s29
    s_add_u32 s55, s55, 1
    s_add_u32 s28, s56, s54
    s_and_b32 s28, s28, 31
    s_lshl_b32 s28, s28, 13
    s_cmp_ge_u32 s56, 32
    s_cselect_b32 s28, 0x40000000, s28
    s_add_u32 s56, s56, 1
    s_add_u32 m0, s34, 16896
    s_nop 0
    buffer_load_dwordx4 v4, s[12:15], s29 offen offset:0 nt lds
    v_exp_f32 v78, v78
    v_mfma_f32_16x16x32_bf16 v[100:103], v[16:19], v[144:147], v[100:103]
    v_exp_f32 v79, v79
    ds_read_b64_tr_b16 v[16:17], v2 offset:64
    ds_read_b64_tr_b16 v[18:19], v2 offset:576
    v_mfma_f32_16x16x32_bf16 v[84:87], v[20:23], v[116:119], v[84:87]
    v_pk_add_f32 v[44:45], v[44:45], v[76:77]
    v_mfma_f32_16x16x32_bf16 v[92:95], v[20:23], v[132:135], v[92:95]
    v_cvt_pk_bf16_f32 v74, v76, v77
    v_pk_add_f32 v[44:45], v[44:45], v[78:79]
    v_mfma_f32_16x16x32_bf16 v[100:103], v[20:23], v[148:151], v[100:103]
    v_cvt_pk_bf16_f32 v75, v78, v79
    ds_read_b64_tr_b16 v[20:21], v2 offset:96
    ds_read_b64_tr_b16 v[22:23], v2 offset:608
    s_waitcnt lgkmcnt(6)
    v_mfma_f32_16x16x32_bf16 v[152:155], v[8:11], v[56:59], v[152:155]
    v_max3_f32 v49, v80, v81, v82
    v_max3_f32 v49, v49, v83, v88
    v_mfma_f32_16x16x32_bf16 v[184:187], v[8:11], v[64:67], v[184:187]
    v_max3_f32 v49, v49, v89, v90
    v_max3_f32 v49, v49, v91, v96
    v_mfma_f32_16x16x32_bf16 v[216:219], v[8:11], v[72:75], v[216:219]
    v_max3_f32 v49, v49, v97, v98
    v_max_f32 v49, v49, v99
    ds_read_b64_tr_b16 v[8:9], v2 offset:128
    ds_read_b64_tr_b16 v[10:11], v2 offset:640
    s_waitcnt lgkmcnt(6)
    v_mfma_f32_16x16x32_bf16 v[156:159], v[12:15], v[56:59], v[156:159]
    v_max3_f32 v49, v49, v84, v85
    v_max3_f32 v49, v49, v86, v87
    v_mfma_f32_16x16x32_bf16 v[188:191], v[12:15], v[64:67], v[188:191]
    v_max3_f32 v49, v49, v92, v93
    v_max3_f32 v49, v49, v94, v95
    v_mfma_f32_16x16x32_bf16 v[220:223], v[12:15], v[72:75], v[220:223]
    v_max3_f32 v49, v49, v100, v101
    v_max3_f32 v49, v49, v102, v103
    ds_read_b64_tr_b16 v[12:13], v2 offset:160
    ds_read_b64_tr_b16 v[14:15], v2 offset:672
    s_waitcnt lgkmcnt(6)
    v_cmp_lt_f32 vcc, 0x41000000, v49
    s_cbranch_vccnz K1_r1_12
K1_b1_12:
    v_mfma_f32_16x16x32_bf16 v[160:163], v[16:19], v[56:59], v[160:163]
    v_exp_f32 v80, v80
    v_mfma_f32_16x16x32_bf16 v[192:195], v[16:19], v[64:67], v[192:195]
    s_add_u32 m0, s34, 17696
    s_nop 0
    buffer_load_dwordx4 v4, s[12:15], s29 offen offset:256 nt lds
    v_exp_f32 v81, v81
    v_mfma_f32_16x16x32_bf16 v[224:227], v[16:19], v[72:75], v[224:227]
    v_exp_f32 v82, v82
    ds_read_b64_tr_b16 v[16:17], v2 offset:192
    ds_read_b64_tr_b16 v[18:19], v2 offset:704
    s_waitcnt lgkmcnt(6)
    v_mfma_f32_16x16x32_bf16 v[164:167], v[20:23], v[56:59], v[164:167]
    v_exp_f32 v83, v83
    v_mfma_f32_16x16x32_bf16 v[196:199], v[20:23], v[64:67], v[196:199]
    v_pk_add_f32 v[40:41], v[40:41], v[80:81]
    v_mfma_f32_16x16x32_bf16 v[228:231], v[20:23], v[72:75], v[228:231]
    v_cvt_pk_bf16_f32 v80, v80, v81
    v_exp_f32 v84, v84
    ds_read_b64_tr_b16 v[20:21], v2 offset:224
    ds_read_b64_tr_b16 v[22:23], v2 offset:736
    s_waitcnt lgkmcnt(6)
    v_mfma_f32_16x16x32_bf16 v[168:171], v[8:11], v[56:59], v[168:171]
    v_mfma_f32_16x16x32_bf16 v[200:203], v[8:11], v[64:67], v[200:203]
    v_exp_f32 v85, v85
    v_mfma_f32_16x16x32_bf16 v[232:235], v[8:11], v[72:75], v[232:235]
    v_pk_add_f32 v[40:41], v[40:41], v[82:83]
    v_cvt_pk_bf16_f32 v81, v82, v83
    ds_read_b128 v[8:11], v1 offset:8448
    s_waitcnt lgkmcnt(5)
    v_mfma_f32_16x16x32_bf16 v[172:175], v[12:15], v[56:59], v[172:175]
    v_exp_f32 v86, v86
    v_mfma_f32_16x16x32_bf16 v[204:207], v[12:15], v[64:67], v[204:207]
    v_exp_f32 v87, v87
    v_mfma_f32_16x16x32_bf16 v[236:239], v[12:15], v[72:75], v[236:239]
    v_pk_add_f32 v[40:41], v[40:41], v[84:85]
    ds_read_b128 v[12:15], v1 offset:8512
    s_waitcnt lgkmcnt(4)
    v_mfma_f32_16x16x32_bf16 v[176:179], v[16:19], v[56:59], v[176:179]
    v_cvt_pk_bf16_f32 v82, v84, v85
    v_pk_add_f32 v[40:41], v[40:41], v[86:87]
    v_mfma_f32_16x16x32_bf16 v[208:211], v[16:19], v[64:67], v[208:211]
    s_add_u32 m0, s34, 25344
    s_nop 0
    buffer_load_dwordx4 v4, s[8:11], s28 offen offset:0 nt lds
    v_cvt_pk_bf16_f32 v83, v86, v87
    v_mfma_f32_16x16x32_bf16 v[240:243], v[16:19], v[72:75], v[240:243]
    v_exp_f32 v88, v88
    ds_read_b128 v[16:19], v1 offset:8576
    s_waitcnt lgkmcnt(3)
    v_mfma_f32_16x16x32_bf16 v[180:183], v[20:23], v[56:59], v[180:183]
    v_exp_f32 v89, v89
    v_mfma_f32_16x16x32_bf16 v[212:215], v[20:23], v[64:67], v[212:215]
    v_exp_f32 v90, v90
    v_mfma_f32_16x16x32_bf16 v[244:247], v[20:23], v[72:75], v[244:247]
    v_exp_f32 v91, v91
    ds_read_b128 v[20:23], v1 offset:8640
    s_waitcnt lgkmcnt(3)
    v_mfma_f32_16x16x32_bf16 v[56:59], v[8:11], v[104:107], v[28:31]
    v_pk_add_f32 v[42:43], v[42:43], v[88:89]
    v_mfma_f32_16x16x32_bf16 v[64:67], v[8:11], v[120:123], v[32:35]
    v_cvt_pk_bf16_f32 v88, v88, v89
    v_exp_f32 v92, v92
    v_mfma_f32_16x16x32_bf16 v[72:75], v[8:11], v[136:139], v[36:39]
    ds_read_b128 v[8:11], v1 offset:8960
    s_waitcnt lgkmcnt(3)
    v_mfma_f32_16x16x32_bf16 v[56:59], v[12:15], v[108:111], v[56:59]
    v_exp_f32 v93, v93
    v_mfma_f32_16x16x32_bf16 v[64:67], v[12:15], v[124:127], v[64:67]
    v_pk_add_f32 v[42:43], v[42:43], v[90:91]
    v_cvt_pk_bf16_f32 v89, v90, v91
    v_mfma_f32_16x16x32_bf16 v[72:75], v[12:15], v[140:143], v[72:75]
    v_exp_f32 v94, v94
    ds_read_b128 v[12:15], v1 offset:9024
    s_waitcnt lgkmcnt(3)
    s_cmp_lg_u32 s36, 0
    s_cbranch_scc1 K1_r2_13
K1_b2_13:
    v_mfma_f32_16x16x32_bf16 v[56:59], v[16:19], v[112:115], v[56:59]
    v_exp_f32 v95, v95
    v_mfma_f32_16x16x32_bf16 v[64:67], v[16:19], v[128:131], v[64:67]
    s_add_u32 m0, s34, 26144
    s_nop 0
    buffer_load_dwordx4 v4, s[8:11], s28 offen offset:256 nt lds
    v_pk_add_f32 v[42:43], v[42:43], v[92:93]
    v_mfma_f32_16x16x32_bf16 v[72:75], v[16:19], v[144:147], v[72:75]
    v_cvt_pk_bf16_f32 v90, v92, v93
    v_pk_add_f32 v[42:43], v[42:43], v[94:95]
    ds_read_b128 v[16:19], v1 offset:9088
    s_waitcnt lgkmcnt(3)
    v_mfma_f32_16x16x32_bf16 v[56:59], v[20:23], v[116:119], v[56:59]
    v_cvt_pk_bf16_f32 v91, v94, v95
    v_mfma_f32_16x16x32_bf16 v[64:67], v[20:23], v[132:135], v[64:67]
    v_exp_f32 v96, v96
    v_mfma_f32_16x16x32_bf16 v[72:75], v[20:23], v[148:151], v[72:75]
    v_exp_f32 v97, v97
    ds_read_b128 v[20:23], v1 offset:9152
    s_waitcnt lgkmcnt(3)
    v_mfma_f32_16x16x32_bf16 v[60:63], v[8:11], v[104:107], v[28:31]
    v_exp_f32 v98, v98
    v_mfma_f32_16x16x32_bf16 v[68:71], v[8:11], v[120:123], v[32:35]
    v_exp_f32 v99, v99
    v_mfma_f32_16x16x32_bf16 v[76:79], v[8:11], v[136:139], v[36:39]
    v_pk_add_f32 v[44:45], v[44:45], v[96:97]
    s_waitcnt lgkmcnt(2)
    v_mfma_f32_16x16x32_bf16 v[60:63], v[12:15], v[108:111], v[60:63]
    v_cvt_pk_bf16_f32 v96, v96, v97
    v_exp_f32 v100, v100
    v_mfma_f32_16x16x32_bf16 v[68:71], v[12:15], v[124:127], v[68:71]
    v_mfma_f32_16x16x32_bf16 v[76:79], v[12:15], v[140:143], v[76:79]
    v_exp_f32 v101, v101
    s_waitcnt vmcnt(4) lgkmcnt(0)
    s_barrier
    ds_read_b64_tr_b16 v[8:9], v2 offset:33792
    ds_read_b64_tr_b16 v[10:11], v2 offset:34304
    ds_read_b64_tr_b16 v[12:13], v2 offset:33824
    ds_read_b64_tr_b16 v[14:15], v2 offset:34336
    v_mfma_f32_16x16x32_bf16 v[60:63], v[16:19], v[112:115], v[60:63]
    v_pk_add_f32 v[44:45], v[44:45], v[98:99]
    v_cvt_pk_bf16_f32 v97, v98, v99
    v_mfma_f32_16x16x32_bf16 v[68:71], v[16:19], v[128:131], v[68:71]
    s_add_u32 s29, s55, s54
    s_and_b32 s29, s29, 31
    s_lshl_b32 s29, s29, 13
    s_cmp_ge_u32 s55, 32
    s_cselect_b32 s29, 0x40000000, s29
    s_add_u32 s55, s55, 1
    s_add_u32 s28, s56, s54
    s_and_b32 s28, s28, 31
    s_lshl_b32 s28, s28, 13
    s_cmp_ge_u32 s56, 32
    s_cselect_b32 s28, 0x40000000, s28
    s_add_u32 s56, s56, 1
    s_add_u32 m0, s34, 50688
    s_nop 0
    buffer_load_dwordx4 v4, s[12:15], s29 offen offset:0 nt lds
    v_exp_f32 v102, v102
    v_mfma_f32_16x16x32_bf16 v[76:79], v[16:19], v[144:147], v[76:79]
    v_exp_f32 v103, v103
    ds_read_b64_tr_b16 v[16:17], v2 offset:33856
    ds_read_b64_tr_b16 v[18:19], v2 offset:34368
    v_mfma_f32_16x16x32_bf16 v[60:63], v[20:23], v[116:119], v[60:63]
    v_pk_add_f32 v[44:45], v[44:45], v[100:101]
    v_mfma_f32_16x16x32_bf16 v[68:71], v[20:23], v[132:135], v[68:71]
    v_cvt_pk_bf16_f32 v98, v100, v101
    v_pk_add_f32 v[44:45], v[44:45], v[102:103]
    v_mfma_f32_16x16x32_bf16 v[76:79], v[20:23], v[148:151], v[76:79]
    v_cvt_pk_bf16_f32 v99, v102, v103
    ds_read_b64_tr_b16 v[20:21], v2 offset:33888
    ds_read_b64_tr_b16 v[22:23], v2 offset:34400
    s_waitcnt lgkmcnt(6)
    v_mfma_f32_16x16x32_bf16 v[152:155], v[8:11], v[80:83], v[152:155]
    v_max3_f32 v49, v56, v57, v58
    v_max3_f32 v49, v49, v59, v64
    v_mfma_f32_16x16x32_bf16 v[184:187], v[8:11], v[88:91], v[184:187]
    v_max3_f32 v49, v49, v65, v66
    v_max3_f32 v49, v49, v67, v72
    v_mfma_f32_16x16x32_bf16 v[216:219], v[8:11], v[96:99], v[216:219]
    v_max3_f32 v49, v49, v73, v74
    v_max_f32 v49, v49, v75
    ds_read_b64_tr_b16 v[8:9], v2 offset:33920
    ds_read_b64_tr_b16 v[10:11], v2 offset:34432
    s_waitcnt lgkmcnt(6)
    v_mfma_f32_16x16x32_bf16 v[156:159], v[12:15], v[80:83], v[156:159]
    v_max3_f32 v49, v49, v60, v61
    v_max3_f32 v49, v49, v62, v63
    v_mfma_f32_16x16x32_bf16 v[188:191], v[12:15], v[88:91], v[188:191]
    v_max3_f32 v49, v49, v68, v69
    v_max3_f32 v49, v49, v70, v71
    v_mfma_f32_16x16x32_bf16 v[220:223], v[12:15], v[96:99], v[220:223]
    v_max3_f32 v49, v49, v76, v77
    v_max3_f32 v49, v49, v78, v79
    ds_read_b64_tr_b16 v[12:13], v2 offset:33952
    ds_read_b64_tr_b16 v[14:15], v2 offset:34464
    s_waitcnt lgkmcnt(6)
    v_cmp_lt_f32 vcc, 0x41000000, v49
    s_cbranch_vccnz K1_r1_14
K1_b1_14:
    v_mfma_f32_16x16x32_bf16 v[160:163], v[16:19], v[80:83], v[160:163]
    v_exp_f32 v56, v56
    v_mfma_f32_16x16x32_bf16 v[192:195], v[16:19], v[88:91], v[192:195]
    s_add_u32 m0, s34, 51488
    s_nop 0
    buffer_load_dwordx4 v4, s[12:15], s29 offen offset:256 nt lds
    v_exp_f32 v57, v57
    v_mfma_f32_16x16x32_bf16 v[224:227], v[16:19], v[96:99], v[224:227]
    v_exp_f32 v58, v58
    ds_read_b64_tr_b16 v[16:17], v2 offset:33984
    ds_read_b64_tr_b16 v[18:19], v2 offset:34496
    s_waitcnt lgkmcnt(6)
    v_mfma_f32_16x16x32_bf16 v[164:167], v[20:23], v[80:83], v[164:167]
    v_exp_f32 v59, v59
    v_mfma_f32_16x16x32_bf16 v[196:199], v[20:23], v[88:91], v[196:199]
    v_pk_add_f32 v[40:41], v[40:41], v[56:57]
    v_mfma_f32_16x16x32_bf16 v[228:231], v[20:23], v[96:99], v[228:231]
    v_cvt_pk_bf16_f32 v56, v56, v57
    v_exp_f32 v60, v60
    ds_read_b64_tr_b16 v[20:21], v2 offset:34016
    ds_read_b64_tr_b16 v[22:23], v2 offset:34528
    s_waitcnt lgkmcnt(6)
    v_mfma_f32_16x16x32_bf16 v[168:171], v[8:11], v[80:83], v[168:171]
    v_mfma_f32_16x16x32_bf16 v[200:203], v[8:11], v[88:91], v[200:203]
    v_exp_f32 v61, v61
    v_mfma_f32_16x16x32_bf16 v[232:235], v[8:11], v[96:99], v[232:235]
    v_pk_add_f32 v[40:41], v[40:41], v[58:59]
    v_cvt_pk_bf16_f32 v57, v58, v59
    ds_read_b128 v[8:11], v1 offset:42240
    s_waitcnt lgkmcnt(5)
    v_mfma_f32_16x16x32_bf16 v[172:175], v[12:15], v[80:83], v[172:175]
    v_exp_f32 v62, v62
    v_mfma_f32_16x16x32_bf16 v[204:207], v[12:15], v[88:91], v[204:207]
    v_exp_f32 v63, v63
    v_mfma_f32_16x16x32_bf16 v[236:239], v[12:15], v[96:99], v[236:239]
    v_pk_add_f32 v[40:41], v[40:41], v[60:61]
    ds_read_b128 v[12:15], v1 offset:42304
    s_waitcnt lgkmcnt(4)
    v_mfma_f32_16x16x32_bf16 v[176:179], v[16:19], v[80:83], v[176:179]
    v_cvt_pk_bf16_f32 v58, v60, v61
    v_pk_add_f32 v[40:41], v[40:41], v[62:63]
    v_mfma_f32_16x16x32_bf16 v[208:211], v[16:19], v[88:91], v[208:211]
    s_add_u32 m0, s34, 59136
    s_nop 0
    buffer_load_dwordx4 v4, s[8:11], s28 offen offset:0 nt lds
    v_cvt_pk_bf16_f32 v59, v62, v63
    v_mfma_f32_16x16x32_bf16 v[240:243], v[16:19], v[96:99], v[240:243]
    v_exp_f32 v64, v64
    ds_read_b128 v[16:19], v1 offset:42368
    s_waitcnt lgkmcnt(3)
    v_mfma_f32_16x16x32_bf16 v[180:183], v[20:23], v[80:83], v[180:183]
    v_exp_f32 v65, v65
    v_mfma_f32_16x16x32_bf16 v[212:215], v[20:23], v[88:91], v[212:215]
    v_exp_f32 v66, v66
    v_mfma_f32_16x16x32_bf16 v[244:247], v[20:23], v[96:99], v[244:247]
    v_exp_f32 v67, v67
    ds_read_b128 v[20:23], v1 offset:42432
    s_waitcnt lgkmcnt(3)
    v_mfma_f32_16x16x32_bf16 v[80:83], v[8:11], v[104:107], v[28:31]
    v_pk_add_f32 v[42:43], v[42:43], v[64:65]
    v_mfma_f32_16x16x32_bf16 v[88:91], v[8:11], v[120:123], v[32:35]
    v_cvt_pk_bf16_f32 v64, v64, v65
    v_exp_f32 v68, v68
    v_mfma_f32_16x16x32_bf16 v[96:99], v[8:11], v[136:139], v[36:39]
    ds_read_b128 v[8:11], v1 offset:42752
    s_waitcnt lgkmcnt(3)
    v_mfma_f32_16x16x32_bf16 v[80:83], v[12:15], v[108:111], v[80:83]
    v_exp_f32 v69, v69
    v_mfma_f32_16x16x32_bf16 v[88:91], v[12:15], v[124:127], v[88:91]
    v_pk_add_f32 v[42:43], v[42:43], v[66:67]
    v_cvt_pk_bf16_f32 v65, v66, v67
    v_mfma_f32_16x16x32_bf16 v[96:99], v[12:15], v[140:143], v[96:99]
    v_exp_f32 v70, v70
    ds_read_b128 v[12:15], v1 offset:42816
    s_waitcnt lgkmcnt(3)
    s_cmp_lg_u32 s36, 0
    s_cbranch_scc1 K1_r2_15
K1_b2_15:
    v_mfma_f32_16x16x32_bf16 v[80:83], v[16:19], v[112:115], v[80:83]
    v_exp_f32 v71, v71
    v_mfma_f32_16x16x32_bf16 v[88:91], v[16:19], v[128:131], v[88:91]
    s_add_u32 m0, s34, 59936
    s_nop 0
    buffer_load_dwordx4 v4, s[8:11], s28 offen offset:256 nt lds
    v_pk_add_f32 v[42:43], v[42:43], v[68:69]
    v_mfma_f32_16x16x32_bf16 v[96:99], v[16:19], v[144:147], v[96:99]
    v_cvt_pk_bf16_f32 v66, v68, v69
    v_pk_add_f32 v[42:43], v[42:43], v[70:71]
    ds_read_b128 v[16:19], v1 offset:42880
    s_waitcnt lgkmcnt(3)
    v_mfma_f32_16x16x32_bf16 v[80:83], v[20:23], v[116:119], v[80:83]
    v_cvt_pk_bf16_f32 v67, v70, v71
    v_mfma_f32_16x16x32_bf16 v[88:91], v[20:23], v[132:135], v[88:91]
    v_exp_f32 v72, v72
    v_mfma_f32_16x16x32_bf16 v[96:99], v[20:23], v[148:151], v[96:99]
    v_exp_f32 v73, v73
    ds_read_b128 v[20:23], v1 offset:42944
    s_waitcnt lgkmcnt(3)
    v_mfma_f32_16x16x32_bf16 v[84:87], v[8:11], v[104:107], v[28:31]
    v_exp_f32 v74, v74
    v_mfma_f32_16x16x32_bf16 v[92:95], v[8:11], v[120:123], v[32:35]
    v_exp_f32 v75, v75
    v_mfma_f32_16x16x32_bf16 v[100:103], v[8:11], v[136:139], v[36:39]
    v_pk_add_f32 v[44:45], v[44:45], v[72:73]
    s_waitcnt lgkmcnt(2)
    v_mfma_f32_16x16x32_bf16 v[84:87], v[12:15], v[108:111], v[84:87]
    v_cvt_pk_bf16_f32 v72, v72, v73
    v_exp_f32 v76, v76
    v_mfma_f32_16x16x32_bf16 v[92:95], v[12:15], v[124:127], v[92:95]
    v_mfma_f32_16x16x32_bf16 v[100:103], v[12:15], v[140:143], v[100:103]
    v_exp_f32 v77, v77
    s_waitcnt vmcnt(4) lgkmcnt(0)
    s_barrier
    ds_read_b64_tr_b16 v[8:9], v2 offset:16896
    ds_read_b64_tr_b16 v[10:11], v2 offset:17408
    ds_read_b64_tr_b16 v[12:13], v2 offset:16928
    ds_read_b64_tr_b16 v[14:15], v2 offset:17440
    v_mfma_f32_16x16x32_bf16 v[84:87], v[16:19], v[112:115], v[84:87]
    v_pk_add_f32 v[44:45], v[44:45], v[74:75]
    v_cvt_pk_bf16_f32 v73, v74, v75
    v_mfma_f32_16x16x32_bf16 v[92:95], v[16:19], v[128:131], v[92:95]
    s_add_u32 s29, s55, s54
    s_and_b32 s29, s29, 31
    s_lshl_b32 s29, s29, 13
    s_cmp_ge_u32 s55, 32
    s_cselect_b32 s29, 0x40000000, s29
    s_add_u32 s55, s55, 1
    s_add_u32 s28, s56, s54
    s_and_b32 s28, s28, 31
    s_lshl_b32 s28, s28, 13
    s_cmp_ge_u32 s56, 32
    s_cselect_b32 s28, 0x40000000, s28
    s_add_u32 s56, s56, 1
    s_add_u32 m0, s34, 0
    s_nop 0
    buffer_load_dwordx4 v4, s[12:15], s29 offen offset:0 nt lds
    v_exp_f32 v78, v78
    v_mfma_f32_16x16x32_bf16 v[100:103], v[16:19], v[144:147], v[100:103]
    v_exp_f32 v79, v79
    ds_read_b64_tr_b16 v[16:17], v2 offset:16960
    ds_read_b64_tr_b16 v[18:19], v2 offset:17472
    v_mfma_f32_16x16x32_bf16 v[84:87], v[20:23], v[116:119], v[84:87]
    v_pk_add_f32 v[44:45], v[44:45], v[76:77]
    v_mfma_f32_16x16x32_bf16 v[92:95], v[20:23], v[132:135], v[92:95]
    v_cvt_pk_bf16_f32 v74, v76, v77
    v_pk_add_f32 v[44:45], v[44:45], v[78:79]
    v_mfma_f32_16x16x32_bf16 v[100:103], v[20:23], v[148:151], v[100:103]
    v_cvt_pk_bf16_f32 v75, v78, v79
    s_sub_u32 s35, s35, 1
    s_cmp_lg_u32 s35, 0
    s_cbranch_scc1 K1_loop
    ds_read_b64_tr_b16 v[20:21], v2 offset:16992
    ds_read_b64_tr_b16 v[22:23], v2 offset:17504
    s_waitcnt lgkmcnt(6)
    v_mfma_f32_16x16x32_bf16 v[152:155], v[8:11], v[56:59], v[152:155]
    v_max3_f32 v49, v80, v81, v82
    v_max3_f32 v49, v49, v83, v88
    v_mfma_f32_16x16x32_bf16 v[184:187], v[8:11], v[64:67], v[184:187]
    v_max3_f32 v49, v49, v89, v90
    v_max3_f32 v49, v49, v91, v96
    v_mfma_f32_16x16x32_bf16 v[216:219], v[8:11], v[72:75], v[216:219]
    v_max3_f32 v49, v49, v97, v98
    v_max_f32 v49, v49, v99
    ds_read_b64_tr_b16 v[8:9], v2 offset:17024
    ds_read_b64_tr_b16 v[10:11], v2 offset:17536
    s_waitcnt lgkmcnt(6)
    v_mfma_f32_16x16x32_bf16 v[156:159], v[12:15], v[56:59], v[156:159]
    v_max3_f32 v49, v49, v84, v85
    v_max3_f32 v49, v49, v86, v87
    v_mfma_f32_16x16x32_bf16 v[188:191], v[12:15], v[64:67], v[188:191]
    v_max3_f32 v49, v49, v92, v93
    v_max3_f32 v49, v49, v94, v95
    v_mfma_f32_16x16x32_bf16 v[220:223], v[12:15], v[72:75], v[220:223]
    v_max3_f32 v49, v49, v100, v101
    v_max3_f32 v49, v49, v102, v103
    ds_read_b64_tr_b16 v[12:13], v2 offset:17056
    ds_read_b64_tr_b16 v[14:15], v2 offset:17568
    s_waitcnt lgkmcnt(6)
    v_cmp_lt_f32 vcc, 0x41000000, v49
    s_cbranch_vccnz K1_r1_16
K1_b1_16:
    v_mfma_f32_16x16x32_bf16 v[160:163], v[16:19], v[56:59], v[160:163]
    v_exp_f32 v80, v80
    v_mfma_f32_16x16x32_bf16 v[192:195], v[16:19], v[64:67], v[192:195]
    s_add_u32 m0, s34, 800
    s_nop 0
    buffer_load_dwordx4 v4, s[12:15], s29 offen offset:256 nt lds
    v_exp_f32 v81, v81
    v_mfma_f32_16x16x32_bf16 v[224:227], v[16:19], v[72:75], v[224:227]
    v_exp_f32 v82, v82
    ds_read_b64_tr_b16 v[16:17], v2 offset:17088
    ds_read_b64_tr_b16 v[18:19], v2 offset:17600
    s_waitcnt lgkmcnt(6)
    v_mfma_f32_16x16x32_bf16 v[164:167], v[20:23], v[56:59], v[164:167]
    v_exp_f32 v83, v83
    v_mfma_f32_16x16x32_bf16 v[196:199], v[20:23], v[64:67], v[196:199]
    v_pk_add_f32 v[40:41], v[40:41], v[80:81]
    v_mfma_f32_16x16x32_bf16 v[228:231], v[20:23], v[72:75], v[228:231]
    v_cvt_pk_bf16_f32 v80, v80, v81
    v_exp_f32 v84, v84
    ds_read_b64_tr_b16 v[20:21], v2 offset:17120
    ds_read_b64_tr_b16 v[22:23], v2 offset:17632
    s_waitcnt lgkmcnt(6)
    v_mfma_f32_16x16x32_bf16 v[168:171], v[8:11], v[56:59], v[168:171]
    v_mfma_f32_16x16x32_bf16 v[200:203], v[8:11], v[64:67], v[200:203]
    v_exp_f32 v85, v85
    v_mfma_f32_16x16x32_bf16 v[232:235], v[8:11], v[72:75], v[232:235]
    v_pk_add_f32 v[40:41], v[40:41], v[82:83]
    v_cvt_pk_bf16_f32 v81, v82, v83
    ds_read_b128 v[8:11], v1 offset:25344
    s_waitcnt lgkmcnt(5)
    v_mfma_f32_16x16x32_bf16 v[172:175], v[12:15], v[56:59], v[172:175]
    v_exp_f32 v86, v86
    v_mfma_f32_16x16x32_bf16 v[204:207], v[12:15], v[64:67], v[204:207]
    v_exp_f32 v87, v87
    v_mfma_f32_16x16x32_bf16 v[236:239], v[12:15], v[72:75], v[236:239]
    v_pk_add_f32 v[40:41], v[40:41], v[84:85]
    ds_read_b128 v[12:15], v1 offset:25408
    s_waitcnt lgkmcnt(4)
    v_mfma_f32_16x16x32_bf16 v[176:179], v[16:19], v[56:59], v[176:179]
    v_cvt_pk_bf16_f32 v82, v84, v85
    v_pk_add_f32 v[40:41], v[40:41], v[86:87]
    v_mfma_f32_16x16x32_bf16 v[208:211], v[16:19], v[64:67], v[208:211]
    s_add_u32 m0, s34, 8448
    s_nop 0
    buffer_load_dwordx4 v4, s[8:11], s28 offen offset:0 nt lds
    v_cvt_pk_bf16_f32 v83, v86, v87
    v_mfma_f32_16x16x32_bf16 v[240:243], v[16:19], v[72:75], v[240:243]
    v_exp_f32 v88, v88
    ds_read_b128 v[16:19], v1 offset:25472
    s_waitcnt lgkmcnt(3)
    v_mfma_f32_16x16x32_bf16 v[180:183], v[20:23], v[56:59], v[180:183]
    v_exp_f32 v89, v89
    v_mfma_f32_16x16x32_bf16 v[212:215], v[20:23], v[64:67], v[212:215]
    v_exp_f32 v90, v90
    v_mfma_f32_16x16x32_bf16 v[244:247], v[20:23], v[72:75], v[244:247]
    v_exp_f32 v91, v91
    ds_read_b128 v[20:23], v1 offset:25536
    s_waitcnt lgkmcnt(3)
    v_mfma_f32_16x16x32_bf16 v[56:59], v[8:11], v[104:107], v[28:31]
    v_pk_add_f32 v[42:43], v[42:43], v[88:89]
    v_mfma_f32_16x16x32_bf16 v[64:67], v[8:11], v[120:123], v[32:35]
    v_cvt_pk_bf16_f32 v88, v88, v89
    v_exp_f32 v92, v92
    v_mfma_f32_16x16x32_bf16 v[72:75], v[8:11], v[136:139], v[36:39]
    ds_read_b128 v[8:11], v1 offset:25856
    s_waitcnt lgkmcnt(3)
    v_mfma_f32_16x16x32_bf16 v[56:59], v[12:15], v[108:111], v[56:59]
    v_exp_f32 v93, v93
    v_mfma_f32_16x16x32_bf16 v[64:67], v[12:15], v[124:127], v[64:67]
    v_pk_add_f32 v[42:43], v[42:43], v[90:91]
    v_cvt_pk_bf16_f32 v89, v90, v91
    v_mfma_f32_16x16x32_bf16 v[72:75], v[12:15], v[140:143], v[72:75]
    v_exp_f32 v94, v94
    ds_read_b128 v[12:15], v1 offset:25920
    s_waitcnt lgkmcnt(3)
    s_cmp_lg_u32 s36, 0
    s_cbranch_scc1 K1_r2_17
K1_b2_17:
    v_mfma_f32_16x16x32_bf16 v[56:59], v[16:19], v[112:115], v[56:59]
    v_exp_f32 v95, v95
    v_mfma_f32_16x16x32_bf16 v[64:67], v[16:19], v[128:131], v[64:67]
    s_add_u32 m0, s34, 9248
    s_nop 0
    buffer_load_dwordx4 v4, s[8:11], s28 offen offset:256 nt lds
    v_pk_add_f32 v[42:43], v[42:43], v[92:93]
    v_mfma_f32_16x16x32_bf16 v[72:75], v[16:19], v[144:147], v[72:75]
    v_cvt_pk_bf16_f32 v90, v92, v93
    v_pk_add_f32 v[42:43], v[42:43], v[94:95]
    ds_read_b128 v[16:19], v1 offset:25984
    s_waitcnt lgkmcnt(3)
    v_mfma_f32_16x16x32_bf16 v[56:59], v[20:23], v[116:119], v[56:59]
    v_cvt_pk_bf16_f32 v91, v94, v95
    v_mfma_f32_16x16x32_bf16 v[64:67], v[20:23], v[132:135], v[64:67]
    v_exp_f32 v96, v96
    v_mfma_f32_16x16x32_bf16 v[72:75], v[20:23], v[148:151], v[72:75]
    v_exp_f32 v97, v97
    ds_read_b128 v[20:23], v1 offset:26048
    s_waitcnt lgkmcnt(3)
    v_mfma_f32_16x16x32_bf16 v[60:63], v[8:11], v[104:107], v[28:31]
    v_exp_f32 v98, v98
    v_mfma_f32_16x16x32_bf16 v[68:71], v[8:11], v[120:123], v[32:35]
    v_exp_f32 v99, v99
    v_mfma_f32_16x16x32_bf16 v[76:79], v[8:11], v[136:139], v[36:39]
    v_pk_add_f32 v[44:45], v[44:45], v[96:97]
    s_waitcnt lgkmcnt(2)
    v_mfma_f32_16x16x32_bf16 v[60:63], v[12:15], v[108:111], v[60:63]
    v_cvt_pk_bf16_f32 v96, v96, v97
    v_exp_f32 v100, v100
    v_mfma_f32_16x16x32_bf16 v[68:71], v[12:15], v[124:127], v[68:71]
    v_mfma_f32_16x16x32_bf16 v[76:79], v[12:15], v[140:143], v[76:79]
    v_exp_f32 v101, v101
    s_waitcnt vmcnt(4) lgkmcnt(0)
    s_barrier
    ds_read_b64_tr_b16 v[8:9], v2 offset:50688
    ds_read_b64_tr_b16 v[10:11], v2 offset:51200
    ds_read_b64_tr_b16 v[12:13], v2 offset:50720
    ds_read_b64_tr_b16 v[14:15], v2 offset:51232
    v_mfma_f32_16x16x32_bf16 v[60:63], v[16:19], v[112:115], v[60:63]
    v_pk_add_f32 v[44:45], v[44:45], v[98:99]
    v_cvt_pk_bf16_f32 v97, v98, v99
    v_mfma_f32_16x16x32_bf16 v[68:71], v[16:19], v[128:131], v[68:71]
    s_add_u32 s29, s55, s54
    s_and_b32 s29, s29, 31
    s_lshl_b32 s29, s29, 13
    s_cmp_ge_u32 s55, 32
    s_cselect_b32 s29, 0x40000000, s29
    s_add_u32 s55, s55, 1
    s_add_u32 s28, s56, s54
    s_and_b32 s28, s28, 31
    s_lshl_b32 s28, s28, 13
    s_cmp_ge_u32 s56, 32
    s_cselect_b32 s28, 0x40000000, s28
    s_add_u32 s56, s56, 1
    s_add_u32 m0, s34, 33792
    s_nop 0
    buffer_load_dwordx4 v4, s[12:15], s29 offen offset:0 nt lds
    v_exp_f32 v102, v102
    v_mfma_f32_16x16x32_bf16 v[76:79], v[16:19], v[144:147], v[76:79]
    v_exp_f32 v103, v103
    ds_read_b64_tr_b16 v[16:17], v2 offset:50752
    ds_read_b64_tr_b16 v[18:19], v2 offset:51264
    v_mfma_f32_16x16x32_bf16 v[60:63], v[20:23], v[116:119], v[60:63]
    v_pk_add_f32 v[44:45], v[44:45], v[100:101]
    v_mfma_f32_16x16x32_bf16 v[68:71], v[20:23], v[132:135], v[68:71]
    v_cvt_pk_bf16_f32 v98, v100, v101
    v_pk_add_f32 v[44:45], v[44:45], v[102:103]
    v_mfma_f32_16x16x32_bf16 v[76:79], v[20:23], v[148:151], v[76:79]
    v_cvt_pk_bf16_f32 v99, v102, v103
    ds_read_b64_tr_b16 v[20:21], v2 offset:50784
    ds_read_b64_tr_b16 v[22:23], v2 offset:51296
    s_waitcnt lgkmcnt(6)
    v_mfma_f32_16x16x32_bf16 v[152:155], v[8:11], v[80:83], v[152:155]
    v_max3_f32 v49, v56, v57, v58
    v_max3_f32 v49, v49, v59, v64
    v_mfma_f32_16x16x32_bf16 v[184:187], v[8:11], v[88:91], v[184:187]
    v_max3_f32 v49, v49, v65, v66
    v_max3_f32 v49, v49, v67, v72
    v_mfma_f32_16x16x32_bf16 v[216:219], v[8:11], v[96:99], v[216:219]
    v_max3_f32 v49, v49, v73, v74
    v_max_f32 v49, v49, v75
    ds_read_b64_tr_b16 v[8:9], v2 offset:50816
    ds_read_b64_tr_b16 v[10:11], v2 offset:51328
    s_waitcnt lgkmcnt(6)
    v_mfma_f32_16x16x32_bf16 v[156:159], v[12:15], v[80:83], v[156:159]
    v_max3_f32 v49, v49, v60, v61
    v_max3_f32 v49, v49, v62, v63
    v_mfma_f32_16x16x32_bf16 v[188:191], v[12:15], v[88:91], v[188:191]
    v_max3_f32 v49, v49, v68, v69
    v_max3_f32 v49, v49, v70, v71
    v_mfma_f32_16x16x32_bf16 v[220:223], v[12:15], v[96:99], v[220:223]
    v_max3_f32 v49, v49, v76, v77
    v_max3_f32 v49, v49, v78, v79
    ds_read_b64_tr_b16 v[12:13], v2 offset:50848
    ds_read_b64_tr_b16 v[14:15], v2 offset:51360
    s_waitcnt lgkmcnt(6)
    v_cmp_lt_f32 vcc, 0x41000000, v49
    s_cbranch_vccnz K1_r1_18
K1_b1_18:
    v_mfma_f32_16x16x32_bf16 v[160:163], v[16:19], v[80:83], v[160:163]
    v_exp_f32 v56, v56
    v_mfma_f32_16x16x32_bf16 v[192:195], v[16:19], v[88:91], v[192:195]
    s_add_u32 m0, s34, 34592
    s_nop 0
    buffer_load_dwordx4 v4, s[12:15], s29 offen offset:256 nt lds
    v_exp_f32 v57, v57
    v_mfma_f32_16x16x32_bf16 v[224:227], v[16:19], v[96:99], v[224:227]
    v_exp_f32 v58, v58
    ds_read_b64_tr_b16 v[16:17], v2 offset:50880
    ds_read_b64_tr_b16 v[18:19], v2 offset:51392
    s_waitcnt lgkmcnt(6)
    v_mfma_f32_16x16x32_bf16 v[164:167], v[20:23], v[80:83], v[164:167]
    v_exp_f32 v59, v59
    v_mfma_f32_16x16x32_bf16 v[196:199], v[20:23], v[88:91], v[196:199]
    v_pk_add_f32 v[40:41], v[40:41], v[56:57]
    v_mfma_f32_16x16x32_bf16 v[228:231], v[20:23], v[96:99], v[228:231]
    v_cvt_pk_bf16_f32 v56, v56, v57
    v_exp_f32 v60, v60
    ds_read_b64_tr_b16 v[20:21], v2 offset:50912
    ds_read_b64_tr_b16 v[22:23], v2 offset:51424
    s_waitcnt lgkmcnt(6)
    v_mfma_f32_16x16x32_bf16 v[168:171], v[8:11], v[80:83], v[168:171]
    v_mfma_f32_16x16x32_bf16 v[200:203], v[8:11], v[88:91], v[200:203]
    v_exp_f32 v61, v61
    v_mfma_f32_16x16x32_bf16 v[232:235], v[8:11], v[96:99], v[232:235]
    v_pk_add_f32 v[40:41], v[40:41], v[58:59]
    v_cvt_pk_bf16_f32 v57, v58, v59
    ds_read_b128 v[8:11], v1 offset:59136
    s_waitcnt lgkmcnt(5)
    v_mfma_f32_16x16x32_bf16 v[172:175], v[12:15], v[80:83], v[172:175]
    v_exp_f32 v62, v62
    v_mfma_f32_16x16x32_bf16 v[204:207], v[12:15], v[88:91], v[204:207]
    v_exp_f32 v63, v63
    v_mfma_f32_16x16x32_bf16 v[236:239], v[12:15], v[96:99], v[236:239]
    v_pk_add_f32 v[40:41], v[40:41], v[60:61]
    ds_read_b128 v[12:15], v1 offset:59200
    s_waitcnt lgkmcnt(4)
    v_mfma_f32_16x16x32_bf16 v[176:179], v[16:19], v[80:83], v[176:179]
    v_cvt_pk_bf16_f32 v58, v60, v61
    v_pk_add_f32 v[40:41], v[40:41], v[62:63]
    v_mfma_f32_16x16x32_bf16 v[208:211], v[16:19], v[88:91], v[208:211]
    s_add_u32 m0, s34, 42240
    s_nop 0
    buffer_load_dwordx4 v4, s[8:11], s28 offen offset:0 nt lds
    v_cvt_pk_bf16_f32 v59, v62, v63
    v_mfma_f32_16x16x32_bf16 v[240:243], v[16:19], v[96:99], v[240:243]
    v_exp_f32 v64, v64
    ds_read_b128 v[16:19], v1 offset:59264
    s_waitcnt lgkmcnt(3)
    v_mfma_f32_16x16x32_bf16 v[180:183], v[20:23], v[80:83], v[180:183]
    v_exp_f32 v65, v65
    v_mfma_f32_16x16x32_bf16 v[212:215], v[20:23], v[88:91], v[212:215]
    v_exp_f32 v66, v66
    v_mfma_f32_16x16x32_bf16 v[244:247], v[20:23], v[96:99], v[244:247]
    v_exp_f32 v67, v67
    ds_read_b128 v[20:23], v1 offset:59328
    s_waitcnt lgkmcnt(3)
    v_mfma_f32_16x16x32_bf16 v[80:83], v[8:11], v[104:107], v[28:31]
    v_pk_add_f32 v[42:43], v[42:43], v[64:65]
    v_mfma_f32_16x16x32_bf16 v[88:91], v[8:11], v[120:123], v[32:35]
    v_cvt_pk_bf16_f32 v64, v64, v65
    v_exp_f32 v68, v68
    v_mfma_f32_16x16x32_bf16 v[96:99], v[8:11], v[136:139], v[36:39]
    ds_read_b128 v[8:11], v1 offset:59648
    s_waitcnt lgkmcnt(3)
    v_mfma_f32_16x16x32_bf16 v[80:83], v[12:15], v[108:111], v[80:83]
    v_exp_f32 v69, v69
    v_mfma_f32_16x16x32_bf16 v[88:91], v[12:15], v[124:127], v[88:91]
    v_pk_add_f32 v[42:43], v[42:43], v[66:67]
    v_cvt_pk_bf16_f32 v65, v66, v67
    v_mfma_f32_16x16x32_bf16 v[96:99], v[12:15], v[140:143], v[96:99]
    v_exp_f32 v70, v70
    ds_read_b128 v[12:15], v1 offset:59712
    s_waitcnt lgkmcnt(3)
    s_cmp_lg_u32 s36, 0
    s_cbranch_scc1 K1_r2_19
K1_b2_19:
    v_mfma_f32_16x16x32_bf16 v[80:83], v[16:19], v[112:115], v[80:83]
    v_exp_f32 v71, v71
    v_mfma_f32_16x16x32_bf16 v[88:91], v[16:19], v[128:131], v[88:91]
    s_add_u32 m0, s34, 43040
    s_nop 0
    buffer_load_dwordx4 v4, s[8:11], s28 offen offset:256 nt lds
    v_pk_add_f32 v[42:43], v[42:43], v[68:69]
    v_mfma_f32_16x16x32_bf16 v[96:99], v[16:19], v[144:147], v[96:99]
    v_cvt_pk_bf16_f32 v66, v68, v69
    v_pk_add_f32 v[42:43], v[42:43], v[70:71]
    ds_read_b128 v[16:19], v1 offset:59776
    s_waitcnt lgkmcnt(3)
    v_mfma_f32_16x16x32_bf16 v[80:83], v[20:23], v[116:119], v[80:83]
    v_cvt_pk_bf16_f32 v67, v70, v71
    v_mfma_f32_16x16x32_bf16 v[88:91], v[20:23], v[132:135], v[88:91]
    v_exp_f32 v72, v72
    v_mfma_f32_16x16x32_bf16 v[96:99], v[20:23], v[148:151], v[96:99]
    v_exp_f32 v73, v73
    ds_read_b128 v[20:23], v1 offset:59840
    s_waitcnt lgkmcnt(3)
    v_mfma_f32_16x16x32_bf16 v[84:87], v[8:11], v[104:107], v[28:31]
    v_exp_f32 v74, v74
    v_mfma_f32_16x16x32_bf16 v[92:95], v[8:11], v[120:123], v[32:35]
    v_exp_f32 v75, v75
    v_mfma_f32_16x16x32_bf16 v[100:103], v[8:11], v[136:139], v[36:39]
    v_pk_add_f32 v[44:45], v[44:45], v[72:73]
    s_waitcnt lgkmcnt(2)
    v_mfma_f32_16x16x32_bf16 v[84:87], v[12:15], v[108:111], v[84:87]
    v_cvt_pk_bf16_f32 v72, v72, v73
    v_exp_f32 v76, v76
    v_mfma_f32_16x16x32_bf16 v[92:95], v[12:15], v[124:127], v[92:95]
    v_mfma_f32_16x16x32_bf16 v[100:103], v[12:15], v[140:143], v[100:103]
    v_exp_f32 v77, v77
    s_waitcnt vmcnt(4) lgkmcnt(0)
    s_barrier
    ds_read_b64_tr_b16 v[8:9], v2 offset:0
    ds_read_b64_tr_b16 v[10:11], v2 offset:512
    ds_read_b64_tr_b16 v[12:13], v2 offset:32
    ds_read_b64_tr_b16 v[14:15], v2 offset:544
    v_mfma_f32_16x16x32_bf16 v[84:87], v[16:19], v[112:115], v[84:87]
    v_pk_add_f32 v[44:45], v[44:45], v[74:75]
    v_cvt_pk_bf16_f32 v73, v74, v75
    v_mfma_f32_16x16x32_bf16 v[92:95], v[16:19], v[128:131], v[92:95]
    s_mov_b32 s96, s100
    s_and_b32 s97, s101, 0xffff
    s_mov_b32 s98, 4194304
    s_mov_b32 s99, 0x00020000
    s_and_b32 s41, s2, 127
    s_lshl_b32 s41, s41, 15
    s_lshl_b32 s42, s90, 12
    s_add_u32 s41, s41, s42
    buffer_load_dwordx4 v[24:27], v7, s[96:99], s41 offen offset:0
    v_exp_f32 v78, v78
    v_mfma_f32_16x16x32_bf16 v[100:103], v[16:19], v[144:147], v[100:103]
    v_exp_f32 v79, v79
    ds_read_b64_tr_b16 v[16:17], v2 offset:64
    ds_read_b64_tr_b16 v[18:19], v2 offset:576
    v_mfma_f32_16x16x32_bf16 v[84:87], v[20:23], v[116:119], v[84:87]
    v_pk_add_f32 v[44:45], v[44:45], v[76:77]
    v_mfma_f32_16x16x32_bf16 v[92:95], v[20:23], v[132:135], v[92:95]
    v_cvt_pk_bf16_f32 v74, v76, v77
    v_pk_add_f32 v[44:45], v[44:45], v[78:79]
    v_mfma_f32_16x16x32_bf16 v[100:103], v[20:23], v[148:151], v[100:103]
    v_cvt_pk_bf16_f32 v75, v78, v79
    ds_read_b64_tr_b16 v[20:21], v2 offset:96
    ds_read_b64_tr_b16 v[22:23], v2 offset:608
    s_waitcnt lgkmcnt(6)
    v_mfma_f32_16x16x32_bf16 v[152:155], v[8:11], v[56:59], v[152:155]
    v_max3_f32 v49, v80, v81, v82
    v_max3_f32 v49, v49, v83, v88
    v_mfma_f32_16x16x32_bf16 v[184:187], v[8:11], v[64:67], v[184:187]
    v_max3_f32 v49, v49, v89, v90
    v_max3_f32 v49, v49, v91, v96
    v_mfma_f32_16x16x32_bf16 v[216:219], v[8:11], v[72:75], v[216:219]
    v_max3_f32 v49, v49, v97, v98
    v_max_f32 v49, v49, v99
    ds_read_b64_tr_b16 v[8:9], v2 offset:128
    ds_read_b64_tr_b16 v[10:11], v2 offset:640
    s_waitcnt lgkmcnt(6)
    v_mfma_f32_16x16x32_bf16 v[156:159], v[12:15], v[56:59], v[156:159]
    v_max3_f32 v49, v49, v84, v85
    v_max3_f32 v49, v49, v86, v87
    v_mfma_f32_16x16x32_bf16 v[188:191], v[12:15], v[64:67], v[188:191]
    v_max3_f32 v49, v49, v92, v93
    v_max3_f32 v49, v49, v94, v95
    v_mfma_f32_16x16x32_bf16 v[220:223], v[12:15], v[72:75], v[220:223]
    v_max3_f32 v49, v49, v100, v101
    v_max3_f32 v49, v49, v102, v103
    ds_read_b64_tr_b16 v[12:13], v2 offset:160
    ds_read_b64_tr_b16 v[14:15], v2 offset:672
    s_waitcnt lgkmcnt(6)
    v_cmp_lt_f32 vcc, 0x41000000, v49
    s_cbranch_vccnz K1_r1_20
K1_b1_20:
    v_mfma_f32_16x16x32_bf16 v[160:163], v[16:19], v[56:59], v[160:163]
    v_exp_f32 v80, v80
    v_exp_f32 v81, v81
    v_mfma_f32_16x16x32_bf16 v[192:195], v[16:19], v[64:67], v[192:195]
    buffer_load_dwordx4 v[24:27], v7, s[96:99], s41 offen offset:1024
    v_exp_f32 v82, v82
    v_exp_f32 v83, v83
    v_mfma_f32_16x16x32_bf16 v[224:227], v[16:19], v[72:75], v[224:227]
    v_pk_add_f32 v[40:41], v[40:41], v[80:81]
    v_cvt_pk_bf16_f32 v80, v80, v81
    v_exp_f32 v84, v84
    ds_read_b64_tr_b16 v[16:17], v2 offset:192
    ds_read_b64_tr_b16 v[18:19], v2 offset:704
    s_waitcnt lgkmcnt(6)
    v_mfma_f32_16x16x32_bf16 v[164:167], v[20:23], v[56:59], v[164:167]
    v_exp_f32 v85, v85
    v_pk_add_f32 v[40:41], v[40:41], v[82:83]
    v_cvt_pk_bf16_f32 v81, v82, v83
    v_mfma_f32_16x16x32_bf16 v[196:199], v[20:23], v[64:67], v[196:199]
    v_exp_f32 v86, v86
    v_exp_f32 v87, v87
    v_mfma_f32_16x16x32_bf16 v[228:231], v[20:23], v[72:75], v[228:231]
    v_pk_add_f32 v[40:41], v[40:41], v[84:85]
    v_cvt_pk_bf16_f32 v82, v84, v85
    v_pk_add_f32 v[40:41], v[40:41], v[86:87]
    v_cvt_pk_bf16_f32 v83, v86, v87
    ds_read_b64_tr_b16 v[20:21], v2 offset:224
    ds_read_b64_tr_b16 v[22:23], v2 offset:736
    s_waitcnt lgkmcnt(6)
    v_mfma_f32_16x16x32_bf16 v[168:171], v[8:11], v[56:59], v[168:171]
    v_exp_f32 v88, v88
    v_exp_f32 v89, v89
    v_mfma_f32_16x16x32_bf16 v[200:203], v[8:11], v[64:67], v[200:203]
    v_exp_f32 v90, v90
    v_exp_f32 v91, v91
    v_mfma_f32_16x16x32_bf16 v[232:235], v[8:11], v[72:75], v[232:235]
    v_pk_add_f32 v[42:43], v[42:43], v[88:89]
    v_cvt_pk_bf16_f32 v88, v88, v89
    v_exp_f32 v92, v92
    s_waitcnt lgkmcnt(4)
    v_mfma_f32_16x16x32_bf16 v[172:175], v[12:15], v[56:59], v[172:175]
    v_exp_f32 v93, v93
    v_pk_add_f32 v[42:43], v[42:43], v[90:91]
    v_cvt_pk_bf16_f32 v89, v90, v91
    v_mfma_f32_16x16x32_bf16 v[204:207], v[12:15], v[64:67], v[204:207]
    v_exp_f32 v94, v94
    v_exp_f32 v95, v95
    v_mfma_f32_16x16x32_bf16 v[236:239], v[12:15], v[72:75], v[236:239]
    v_pk_add_f32 v[42:43], v[42:43], v[92:93]
    v_cvt_pk_bf16_f32 v90, v92, v93
    v_pk_add_f32 v[42:43], v[42:43], v[94:95]
    v_cvt_pk_bf16_f32 v91, v94, v95
    s_waitcnt vmcnt(2) lgkmcnt(0)
    s_barrier
    ds_read_b64_tr_b16 v[8:9], v2 offset:33792
    ds_read_b64_tr_b16 v[10:11], v2 offset:34304
    ds_read_b64_tr_b16 v[12:13], v2 offset:33824
    ds_read_b64_tr_b16 v[14:15], v2 offset:34336
    v_mfma_f32_16x16x32_bf16 v[176:179], v[16:19], v[56:59], v[176:179]
    v_exp_f32 v96, v96
    v_exp_f32 v97, v97
    v_mfma_f32_16x16x32_bf16 v[208:211], v[16:19], v[64:67], v[208:211]
    buffer_load_dwordx4 v[24:27], v7, s[96:99], s41 offen offset:2048
    v_exp_f32 v98, v98
    v_exp_f32 v99, v99
    v_mfma_f32_16x16x32_bf16 v[240:243], v[16:19], v[72:75], v[240:243]
    v_pk_add_f32 v[44:45], v[44:45], v[96:97]
    v_cvt_pk_bf16_f32 v96, v96, v97
    v_exp_f32 v100, v100
    ds_read_b64_tr_b16 v[16:17], v2 offset:33856
    ds_read_b64_tr_b16 v[18:19], v2 offset:34368
    v_mfma_f32_16x16x32_bf16 v[180:183], v[20:23], v[56:59], v[180:183]
    v_exp_f32 v101, v101
    v_pk_add_f32 v[44:45], v[44:45], v[98:99]
    v_cvt_pk_bf16_f32 v97, v98, v99
    v_mfma_f32_16x16x32_bf16 v[212:215], v[20:23], v[64:67], v[212:215]
    v_exp_f32 v102, v102
    v_exp_f32 v103, v103
    v_mfma_f32_16x16x32_bf16 v[244:247], v[20:23], v[72:75], v[244:247]
    v_pk_add_f32 v[44:45], v[44:45], v[100:101]
    v_cvt_pk_bf16_f32 v98, v100, v101
    v_pk_add_f32 v[44:45], v[44:45], v[102:103]
    v_cvt_pk_bf16_f32 v99, v102, v103
    s_cmp_lg_u32 s36, 0
    s_cbranch_scc1 K1_r2_21
K1_b2_21:
    ds_read_b64_tr_b16 v[20:21], v2 offset:33888
    ds_read_b64_tr_b16 v[22:23], v2 offset:34400
    s_waitcnt lgkmcnt(6)
    v_mfma_f32_16x16x32_bf16 v[152:155], v[8:11], v[80:83], v[152:155]
    v_mfma_f32_16x16x32_bf16 v[184:187], v[8:11], v[88:91], v[184:187]
    v_mfma_f32_16x16x32_bf16 v[216:219], v[8:11], v[96:99], v[216:219]
    ds_read_b64_tr_b16 v[8:9], v2 offset:33920
    ds_read_b64_tr_b16 v[10:11], v2 offset:34432
    s_waitcnt lgkmcnt(6)
    v_mfma_f32_16x16x32_bf16 v[156:159], v[12:15], v[80:83], v[156:159]
    v_mfma_f32_16x16x32_bf16 v[188:191], v[12:15], v[88:91], v[188:191]
    v_mfma_f32_16x16x32_bf16 v[220:223], v[12:15], v[96:99], v[220:223]
    ds_read_b64_tr_b16 v[12:13], v2 offset:33952
    ds_read_b64_tr_b16 v[14:15], v2 offset:34464
    s_waitcnt lgkmcnt(6)
    v_mfma_f32_16x16x32_bf16 v[160:163], v[16:19], v[80:83], v[160:163]
    v_mfma_f32_16x16x32_bf16 v[192:195], v[16:19], v[88:91], v[192:195]
    buffer_load_dwordx4 v[24:27], v7, s[96:99], s41 offen offset:3072
    v_mfma_f32_16x16x32_bf16 v[224:227], v[16:19], v[96:99], v[224:227]
    ds_read_b64_tr_b16 v[16:17], v2 offset:33984
    ds_read_b64_tr_b16 v[18:19], v2 offset:34496
    s_waitcnt lgkmcnt(6)
    v_mfma_f32_16x16x32_bf16 v[164:167], v[20:23], v[80:83], v[164:167]
    v_mfma_f32_16x16x32_bf16 v[196:199], v[20:23], v[88:91], v[196:199]
    v_mfma_f32_16x16x32_bf16 v[228:231], v[20:23], v[96:99], v[228:231]
    ds_read_b64_tr_b16 v[20:21], v2 offset:34016
    ds_read_b64_tr_b16 v[22:23], v2 offset:34528
    s_waitcnt lgkmcnt(6)
    v_mfma_f32_16x16x32_bf16 v[168:171], v[8:11], v[80:83], v[168:171]
    v_mfma_f32_16x16x32_bf16 v[200:203], v[8:11], v[88:91], v[200:203]
    v_mfma_f32_16x16x32_bf16 v[232:235], v[8:11], v[96:99], v[232:235]
    s_waitcnt lgkmcnt(4)
    v_mfma_f32_16x16x32_bf16 v[172:175], v[12:15], v[80:83], v[172:175]
    v_mfma_f32_16x16x32_bf16 v[204:207], v[12:15], v[88:91], v[204:207]
    v_mfma_f32_16x16x32_bf16 v[236:239], v[12:15], v[96:99], v[236:239]
    s_waitcnt lgkmcnt(2)
    v_mfma_f32_16x16x32_bf16 v[176:179], v[16:19], v[80:83], v[176:179]
    v_mfma_f32_16x16x32_bf16 v[208:211], v[16:19], v[88:91], v[208:211]
    s_add_u32 s29, s55, s54
    s_and_b32 s29, s29, 31
    s_lshl_b32 s29, s29, 13
    s_cmp_ge_u32 s55, 32
    s_cselect_b32 s29, 0x40000000, s29
    s_add_u32 s55, s55, 1
    s_add_u32 s28, s56, s54
    s_and_b32 s28, s28, 31
    s_lshl_b32 s28, s28, 13
    s_cmp_ge_u32 s56, 32
    s_cselect_b32 s28, 0x40000000, s28
    s_add_u32 s56, s56, 1
    s_add_u32 m0, s34, 16896
    s_nop 0
    buffer_load_dwordx4 v4, s[12:15], s29 offen offset:0 nt lds
    v_mfma_f32_16x16x32_bf16 v[240:243], v[16:19], v[96:99], v[240:243]
    s_waitcnt lgkmcnt(0)
    v_mfma_f32_16x16x32_bf16 v[180:183], v[20:23], v[80:83], v[180:183]
    v_mfma_f32_16x16x32_bf16 v[212:215], v[20:23], v[88:91], v[212:215]
    v_mfma_f32_16x16x32_bf16 v[244:247], v[20:23], v[96:99], v[244:247]
    s_nop 7
    s_nop 7
    v_add_f32 v248, v40, v41
    ds_bpermute_b32 v249, v252, v248
    s_waitcnt lgkmcnt(0)
    v_add_f32 v248, v248, v249
    ds_bpermute_b32 v249, v253, v248
    s_waitcnt lgkmcnt(0)
    v_add_f32 v248, v248, v249
    v_rcp_f32 v46, v248
    v_add_f32 v248, v42, v43
    ds_bpermute_b32 v249, v252, v248
    s_waitcnt lgkmcnt(0)
    v_add_f32 v248, v248, v249
    ds_bpermute_b32 v249, v253, v248
    s_waitcnt lgkmcnt(0)
    v_add_f32 v248, v248, v249
    v_rcp_f32 v47, v248
    v_add_f32 v248, v44, v45
    ds_bpermute_b32 v249, v252, v248
    s_waitcnt lgkmcnt(0)
    v_add_f32 v248, v248, v249
    ds_bpermute_b32 v249, v253, v248
    s_waitcnt lgkmcnt(0)
    v_add_f32 v248, v248, v249
    v_rcp_f32 v48, v248
    s_nop 1
    s_add_u32 s30, s37, 0
    v_mul_f32 v152, v152, v46
    v_mul_f32 v153, v153, v46
    v_mul_f32 v154, v154, v46
    v_mul_f32 v155, v155, v46
    v_mul_f32 v156, v156, v46
    v_mul_f32 v157, v157, v46
    v_mul_f32 v158, v158, v46
    v_mul_f32 v159, v159, v46
    v_cvt_pk_bf16_f32 v56, v152, v153
    v_cvt_pk_bf16_f32 v57, v154, v155
    v_cvt_pk_bf16_f32 v58, v156, v157
    v_cvt_pk_bf16_f32 v59, v158, v159
    buffer_store_dwordx4 v[56:59], v7, s[24:27], s30 offen offset:0 sc0 sc1
    v_mul_f32 v160, v160, v46
    v_mul_f32 v161, v161, v46
    v_mul_f32 v162, v162, v46
    v_mul_f32 v163, v163, v46
    v_mul_f32 v164, v164, v46
    v_mul_f32 v165, v165, v46
    v_mul_f32 v166, v166, v46
    v_mul_f32 v167, v167, v46
    v_cvt_pk_bf16_f32 v60, v160, v161
    v_cvt_pk_bf16_f32 v61, v162, v163
    v_cvt_pk_bf16_f32 v62, v164, v165
    v_cvt_pk_bf16_f32 v63, v166, v167
    buffer_store_dwordx4 v[60:63], v7, s[24:27], s30 offen offset:1024 sc0 sc1
    v_mul_f32 v168, v168, v46
    v_mul_f32 v169, v169, v46
    v_mul_f32 v170, v170, v46
    v_mul_f32 v171, v171, v46
    v_mul_f32 v172, v172, v46
    v_mul_f32 v173, v173, v46
    v_mul_f32 v174, v174, v46
    v_mul_f32 v175, v175, v46
    v_cvt_pk_bf16_f32 v64, v168, v169
    v_cvt_pk_bf16_f32 v65, v170, v171
    v_cvt_pk_bf16_f32 v66, v172, v173
    v_cvt_pk_bf16_f32 v67, v174, v175
    buffer_store_dwordx4 v[64:67], v7, s[24:27], s30 offen offset:2048 sc0 sc1
    v_mul_f32 v176, v176, v46
    v_mul_f32 v177, v177, v46
    v_mul_f32 v178, v178, v46
    v_mul_f32 v179, v179, v46
    v_mul_f32 v180, v180, v46
    v_mul_f32 v181, v181, v46
    v_mul_f32 v182, v182, v46
    v_mul_f32 v183, v183, v46
    v_cvt_pk_bf16_f32 v68, v176, v177
    v_cvt_pk_bf16_f32 v69, v178, v179
    v_cvt_pk_bf16_f32 v70, v180, v181
    v_cvt_pk_bf16_f32 v71, v182, v183
    buffer_store_dwordx4 v[68:71], v7, s[24:27], s30 offen offset:3072 sc0 sc1
    s_add_u32 s30, s37, 131072
    v_mul_f32 v184, v184, v47
    v_mul_f32 v185, v185, v47
    v_mul_f32 v186, v186, v47
    v_mul_f32 v187, v187, v47
    v_mul_f32 v188, v188, v47
    v_mul_f32 v189, v189, v47
    v_mul_f32 v190, v190, v47
    v_mul_f32 v191, v191, v47
    v_cvt_pk_bf16_f32 v56, v184, v185
    v_cvt_pk_bf16_f32 v57, v186, v187
    v_cvt_pk_bf16_f32 v58, v188, v189
    v_cvt_pk_bf16_f32 v59, v190, v191
    buffer_store_dwordx4 v[56:59], v7, s[24:27], s30 offen offset:0 sc0 sc1
    v_mul_f32 v192, v192, v47
    v_mul_f32 v193, v193, v47
    v_mul_f32 v194, v194, v47
    v_mul_f32 v195, v195, v47
    v_mul_f32 v196, v196, v47
    v_mul_f32 v197, v197, v47
    v_mul_f32 v198, v198, v47
    v_mul_f32 v199, v199, v47
    v_cvt_pk_bf16_f32 v60, v192, v193
    v_cvt_pk_bf16_f32 v61, v194, v195
    v_cvt_pk_bf16_f32 v62, v196, v197
    v_cvt_pk_bf16_f32 v63, v198, v199
    buffer_store_dwordx4 v[60:63], v7, s[24:27], s30 offen offset:1024 sc0 sc1
    v_mul_f32 v200, v200, v47
    v_mul_f32 v201, v201, v47
    v_mul_f32 v202, v202, v47
    v_mul_f32 v203, v203, v47
    v_mul_f32 v204, v204, v47
    v_mul_f32 v205, v205, v47
    v_mul_f32 v206, v206, v47
    v_mul_f32 v207, v207, v47
    v_cvt_pk_bf16_f32 v64, v200, v201
    v_cvt_pk_bf16_f32 v65, v202, v203
    v_cvt_pk_bf16_f32 v66, v204, v205
    v_cvt_pk_bf16_f32 v67, v206, v207
    buffer_store_dwordx4 v[64:67], v7, s[24:27], s30 offen offset:2048 sc0 sc1
    v_mul_f32 v208, v208, v47
    v_mul_f32 v209, v209, v47
    v_mul_f32 v210, v210, v47
    v_mul_f32 v211, v211, v47
    v_mul_f32 v212, v212, v47
    v_mul_f32 v213, v213, v47
    v_mul_f32 v214, v214, v47
    v_mul_f32 v215, v215, v47
    v_cvt_pk_bf16_f32 v68, v208, v209
    v_cvt_pk_bf16_f32 v69, v210, v211
    v_cvt_pk_bf16_f32 v70, v212, v213
    v_cvt_pk_bf16_f32 v71, v214, v215
    buffer_store_dwordx4 v[68:71], v7, s[24:27], s30 offen offset:3072 sc0 sc1
    s_add_u32 s30, s37, 262144
    v_mul_f32 v216, v216, v48
    v_mul_f32 v217, v217, v48
    v_mul_f32 v218, v218, v48
    v_mul_f32 v219, v219, v48
    v_mul_f32 v220, v220, v48
    v_mul_f32 v221, v221, v48
    v_mul_f32 v222, v222, v48
    v_mul_f32 v223, v223, v48
    v_cvt_pk_bf16_f32 v56, v216, v217
    v_cvt_pk_bf16_f32 v57, v218, v219
    v_cvt_pk_bf16_f32 v58, v220, v221
    v_cvt_pk_bf16_f32 v59, v222, v223
    buffer_store_dwordx4 v[56:59], v7, s[24:27], s30 offen offset:0 sc0 sc1
    v_mul_f32 v224, v224, v48
    v_mul_f32 v225, v225, v48
    v_mul_f32 v226, v226, v48
    v_mul_f32 v227, v227, v48
    v_mul_f32 v228, v228, v48
    v_mul_f32 v229, v229, v48
    v_mul_f32 v230, v230, v48
    v_mul_f32 v231, v231, v48
    v_cvt_pk_bf16_f32 v60, v224, v225
    v_cvt_pk_bf16_f32 v61, v226, v227
    v_cvt_pk_bf16_f32 v62, v228, v229
    v_cvt_pk_bf16_f32 v63, v230, v231
    buffer_store_dwordx4 v[60:63], v7, s[24:27], s30 offen offset:1024 sc0 sc1
    v_mul_f32 v232, v232, v48
    v_mul_f32 v233, v233, v48
    v_mul_f32 v234, v234, v48
    v_mul_f32 v235, v235, v48
    v_mul_f32 v236, v236, v48
    v_mul_f32 v237, v237, v48
    v_mul_f32 v238, v238, v48
    v_mul_f32 v239, v239, v48
    v_cvt_pk_bf16_f32 v64, v232, v233
    v_cvt_pk_bf16_f32 v65, v234, v235
    v_cvt_pk_bf16_f32 v66, v236, v237
    v_cvt_pk_bf16_f32 v67, v238, v239
    buffer_store_dwordx4 v[64:67], v7, s[24:27], s30 offen offset:2048 sc0 sc1
    v_mul_f32 v240, v240, v48
    v_mul_f32 v241, v241, v48
    v_mul_f32 v242, v242, v48
    v_mul_f32 v243, v243, v48
    v_mul_f32 v244, v244, v48
    v_mul_f32 v245, v245, v48
    v_mul_f32 v246, v246, v48
    v_mul_f32 v247, v247, v48
    v_cvt_pk_bf16_f32 v68, v240, v241
    v_cvt_pk_bf16_f32 v69, v242, v243
    v_cvt_pk_bf16_f32 v70, v244, v245
    v_cvt_pk_bf16_f32 v71, v246, v247
    buffer_store_dwordx4 v[68:71], v7, s[24:27], s30 offen offset:3072 sc0 sc1
K1_done:
    s_endpgm
K1_r1_0:
    s_nop 7
    s_nop 7
    v_max3_f32 v248, v80, v81, v82
    v_max3_f32 v248, v248, v83, v84
    v_max3_f32 v248, v248, v85, v86
    v_max_f32 v248, v248, v87
    ds_bpermute_b32 v249, v252, v248
    s_waitcnt lgkmcnt(0)
    v_max_f32 v248, v248, v249
    ds_bpermute_b32 v249, v253, v248
    s_waitcnt lgkmcnt(0)
    v_max_f32 v248, v248, v249
    v_max_f32 v248, 0, v248
    v_sub_f32 v80, v80, v248
    v_sub_f32 v81, v81, v248
    v_sub_f32 v82, v82, v248
    v_sub_f32 v83, v83, v248
    v_sub_f32 v84, v84, v248
    v_sub_f32 v85, v85, v248
    v_sub_f32 v86, v86, v248
    v_sub_f32 v87, v87, v248
    v_sub_f32 v28, v28, v248
    v_sub_f32 v29, v29, v248
    v_sub_f32 v30, v30, v248
    v_sub_f32 v31, v31, v248
    v_exp_f32 v46, -v248
    s_nop 0
    v_mul_f32 v40, v40, v46
    v_mul_f32 v41, v41, v46
    v_max3_f32 v248, v88, v89, v90
    v_max3_f32 v248, v248, v91, v92
    v_max3_f32 v248, v248, v93, v94
    v_max_f32 v248, v248, v95
    ds_bpermute_b32 v249, v252, v248
    s_waitcnt lgkmcnt(0)
    v_max_f32 v248, v248, v249
    ds_bpermute_b32 v249, v253, v248
    s_waitcnt lgkmcnt(0)
    v_max_f32 v248, v248, v249
    v_max_f32 v248, 0, v248
    v_sub_f32 v88, v88, v248
    v_sub_f32 v89, v89, v248
    v_sub_f32 v90, v90, v248
    v_sub_f32 v91, v91, v248
    v_sub_f32 v92, v92, v248
    v_sub_f32 v93, v93, v248
    v_sub_f32 v94, v94, v248
    v_sub_f32 v95, v95, v248
    v_sub_f32 v32, v32, v248
    v_sub_f32 v33, v33, v248
    v_sub_f32 v34, v34, v248
    v_sub_f32 v35, v35, v248
    v_exp_f32 v47, -v248
    s_nop 0
    v_mul_f32 v42, v42, v47
    v_mul_f32 v43, v43, v47
    v_max3_f32 v248, v96, v97, v98
    v_max3_f32 v248, v248, v99, v100
    v_max3_f32 v248, v248, v101, v102
    v_max_f32 v248, v248, v103
    ds_bpermute_b32 v249, v252, v248
    s_waitcnt lgkmcnt(0)
    v_max_f32 v248, v248, v249
    ds_bpermute_b32 v249, v253, v248
    s_waitcnt lgkmcnt(0)
    v_max_f32 v248, v248, v249
    v_max_f32 v248, 0, v248
    v_sub_f32 v96, v96, v248
    v_sub_f32 v97, v97, v248
    v_sub_f32 v98, v98, v248
    v_sub_f32 v99, v99, v248
    v_sub_f32 v100, v100, v248
    v_sub_f32 v101, v101, v248
    v_sub_f32 v102, v102, v248
    v_sub_f32 v103, v103, v248
    v_sub_f32 v36, v36, v248
    v_sub_f32 v37, v37, v248
    v_sub_f32 v38, v38, v248
    v_sub_f32 v39, v39, v248
    v_exp_f32 v48, -v248
    s_nop 0
    v_mul_f32 v44, v44, v48
    v_mul_f32 v45, v45, v48
    s_mov_b32 s36, 1
    s_nop 3
    s_branch K1_b1_0
K1_r1_2:
    s_nop 7
    s_nop 7
    v_max3_f32 v248, v56, v57, v58
    v_max3_f32 v248, v248, v59, v60
    v_max3_f32 v248, v248, v61, v62
    v_max_f32 v248, v248, v63
    ds_bpermute_b32 v249, v252, v248
    s_waitcnt lgkmcnt(0)
    v_max_f32 v248, v248, v249
    ds_bpermute_b32 v249, v253, v248
    s_waitcnt lgkmcnt(0)
    v_max_f32 v248, v248, v249
    v_max_f32 v248, 0, v248
    v_sub_f32 v56, v56, v248
    v_sub_f32 v57, v57, v248
    v_sub_f32 v58, v58, v248
    v_sub_f32 v59, v59, v248
    v_sub_f32 v60, v60, v248
    v_sub_f32 v61, v61, v248
    v_sub_f32 v62, v62, v248
    v_sub_f32 v63, v63, v248
    v_sub_f32 v28, v28, v248
    v_sub_f32 v29, v29, v248
    v_sub_f32 v30, v30, v248
    v_sub_f32 v31, v31, v248
    v_exp_f32 v46, -v248
    s_nop 0
    v_mul_f32 v40, v40, v46
    v_mul_f32 v41, v41, v46
    v_max3_f32 v248, v64, v65, v66
    v_max3_f32 v248, v248, v67, v68
    v_max3_f32 v248, v248, v69, v70
    v_max_f32 v248, v248, v71
    ds_bpermute_b32 v249, v252, v248
    s_waitcnt lgkmcnt(0)
    v_max_f32 v248, v248, v249
    ds_bpermute_b32 v249, v253, v248
    s_waitcnt lgkmcnt(0)
    v_max_f32 v248, v248, v249
    v_max_f32 v248, 0, v248
    v_sub_f32 v64, v64, v248
    v_sub_f32 v65, v65, v248
    v_sub_f32 v66, v66, v248
    v_sub_f32 v67, v67, v248
    v_sub_f32 v68, v68, v248
    v_sub_f32 v69, v69, v248
    v_sub_f32 v70, v70, v248
    v_sub_f32 v71, v71, v248
    v_sub_f32 v32, v32, v248
    v_sub_f32 v33, v33, v248
    v_sub_f32 v34, v34, v248
    v_sub_f32 v35, v35, v248
    v_exp_f32 v47, -v248
    s_nop 0
    v_mul_f32 v42, v42, v47
    v_mul_f32 v43, v43, v47
    v_max3_f32 v248, v72, v73, v74
    v_max3_f32 v248, v248, v75, v76
    v_max3_f32 v248, v248, v77, v78
    v_max_f32 v248, v248, v79
    ds_bpermute_b32 v249, v252, v248
    s_waitcnt lgkmcnt(0)
    v_max_f32 v248, v248, v249
    ds_bpermute_b32 v249, v253, v248
    s_waitcnt lgkmcnt(0)
    v_max_f32 v248, v248, v249
    v_max_f32 v248, 0, v248
    v_sub_f32 v72, v72, v248
    v_sub_f32 v73, v73, v248
    v_sub_f32 v74, v74, v248
    v_sub_f32 v75, v75, v248
    v_sub_f32 v76, v76, v248
    v_sub_f32 v77, v77, v248
    v_sub_f32 v78, v78, v248
    v_sub_f32 v79, v79, v248
    v_sub_f32 v36, v36, v248
    v_sub_f32 v37, v37, v248
    v_sub_f32 v38, v38, v248
    v_sub_f32 v39, v39, v248
    v_exp_f32 v48, -v248
    s_nop 0
    v_mul_f32 v44, v44, v48
    v_mul_f32 v45, v45, v48
    s_mov_b32 s36, 1
    s_nop 3
    s_branch K1_b1_2
K1_r1_4:
    s_nop 7
    s_nop 7
    v_max3_f32 v248, v80, v81, v82
    v_max3_f32 v248, v248, v83, v84
    v_max3_f32 v248, v248, v85, v86
    v_max_f32 v248, v248, v87
    ds_bpermute_b32 v249, v252, v248
    s_waitcnt lgkmcnt(0)
    v_max_f32 v248, v248, v249
    ds_bpermute_b32 v249, v253, v248
    s_waitcnt lgkmcnt(0)
    v_max_f32 v248, v248, v249
    v_max_f32 v248, 0, v248
    v_sub_f32 v80, v80, v248
    v_sub_f32 v81, v81, v248
    v_sub_f32 v82, v82, v248
    v_sub_f32 v83, v83, v248
    v_sub_f32 v84, v84, v248
    v_sub_f32 v85, v85, v248
    v_sub_f32 v86, v86, v248
    v_sub_f32 v87, v87, v248
    v_sub_f32 v28, v28, v248
    v_sub_f32 v29, v29, v248
    v_sub_f32 v30, v30, v248
    v_sub_f32 v31, v31, v248
    v_exp_f32 v46, -v248
    s_nop 0
    v_mul_f32 v40, v40, v46
    v_mul_f32 v41, v41, v46
    v_max3_f32 v248, v88, v89, v90
    v_max3_f32 v248, v248, v91, v92
    v_max3_f32 v248, v248, v93, v94
    v_max_f32 v248, v248, v95
    ds_bpermute_b32 v249, v252, v248
    s_waitcnt lgkmcnt(0)
    v_max_f32 v248, v248, v249
    ds_bpermute_b32 v249, v253, v248
    s_waitcnt lgkmcnt(0)
    v_max_f32 v248, v248, v249
    v_max_f32 v248, 0, v248
    v_sub_f32 v88, v88, v248
    v_sub_f32 v89, v89, v248
    v_sub_f32 v90, v90, v248
    v_sub_f32 v91, v91, v248
    v_sub_f32 v92, v92, v248
    v_sub_f32 v93, v93, v248
    v_sub_f32 v94, v94, v248
    v_sub_f32 v95, v95, v248
    v_sub_f32 v32, v32, v248
    v_sub_f32 v33, v33, v248
    v_sub_f32 v34, v34, v248
    v_sub_f32 v35, v35, v248
    v_exp_f32 v47, -v248
    s_nop 0
    v_mul_f32 v42, v42, v47
    v_mul_f32 v43, v43, v47
    v_max3_f32 v248, v96, v97, v98
    v_max3_f32 v248, v248, v99, v100
    v_max3_f32 v248, v248, v101, v102
    v_max_f32 v248, v248, v103
    ds_bpermute_b32 v249, v252, v248
    s_waitcnt lgkmcnt(0)
    v_max_f32 v248, v248, v249
    ds_bpermute_b32 v249, v253, v248
    s_waitcnt lgkmcnt(0)
    v_max_f32 v248, v248, v249
    v_max_f32 v248, 0, v248
    v_sub_f32 v96, v96, v248
    v_sub_f32 v97, v97, v248
    v_sub_f32 v98, v98, v248
    v_sub_f32 v99, v99, v248
    v_sub_f32 v100, v100, v248
    v_sub_f32 v101, v101, v248
    v_sub_f32 v102, v102, v248
    v_sub_f32 v103, v103, v248
    v_sub_f32 v36, v36, v248
    v_sub_f32 v37, v37, v248
    v_sub_f32 v38, v38, v248
    v_sub_f32 v39, v39, v248
    v_exp_f32 v48, -v248
    s_nop 0
    v_mul_f32 v44, v44, v48
    v_mul_f32 v45, v45, v48
    s_mov_b32 s36, 1
    s_nop 3
    s_branch K1_b1_4
K1_r1_6:
    s_nop 7
    s_nop 7
    v_max3_f32 v248, v56, v57, v58
    v_max3_f32 v248, v248, v59, v60
    v_max3_f32 v248, v248, v61, v62
    v_max_f32 v248, v248, v63
    ds_bpermute_b32 v249, v252, v248
    s_waitcnt lgkmcnt(0)
    v_max_f32 v248, v248, v249
    ds_bpermute_b32 v249, v253, v248
    s_waitcnt lgkmcnt(0)
    v_max_f32 v248, v248, v249
    v_max_f32 v248, 0, v248
    v_sub_f32 v56, v56, v248
    v_sub_f32 v57, v57, v248
    v_sub_f32 v58, v58, v248
    v_sub_f32 v59, v59, v248
    v_sub_f32 v60, v60, v248
    v_sub_f32 v61, v61, v248
    v_sub_f32 v62, v62, v248
    v_sub_f32 v63, v63, v248
    v_sub_f32 v28, v28, v248
    v_sub_f32 v29, v29, v248
    v_sub_f32 v30, v30, v248
    v_sub_f32 v31, v31, v248
    v_exp_f32 v46, -v248
    s_nop 0
    v_mul_f32 v40, v40, v46
    v_mul_f32 v41, v41, v46
    v_max3_f32 v248, v64, v65, v66
    v_max3_f32 v248, v248, v67, v68
    v_max3_f32 v248, v248, v69, v70
    v_max_f32 v248, v248, v71
    ds_bpermute_b32 v249, v252, v248
    s_waitcnt lgkmcnt(0)
    v_max_f32 v248, v248, v249
    ds_bpermute_b32 v249, v253, v248
    s_waitcnt lgkmcnt(0)
    v_max_f32 v248, v248, v249
    v_max_f32 v248, 0, v248
    v_sub_f32 v64, v64, v248
    v_sub_f32 v65, v65, v248
    v_sub_f32 v66, v66, v248
    v_sub_f32 v67, v67, v248
    v_sub_f32 v68, v68, v248
    v_sub_f32 v69, v69, v248
    v_sub_f32 v70, v70, v248
    v_sub_f32 v71, v71, v248
    v_sub_f32 v32, v32, v248
    v_sub_f32 v33, v33, v248
    v_sub_f32 v34, v34, v248
    v_sub_f32 v35, v35, v248
    v_exp_f32 v47, -v248
    s_nop 0
    v_mul_f32 v42, v42, v47
    v_mul_f32 v43, v43, v47
    v_max3_f32 v248, v72, v73, v74
    v_max3_f32 v248, v248, v75, v76
    v_max3_f32 v248, v248, v77, v78
    v_max_f32 v248, v248, v79
    ds_bpermute_b32 v249, v252, v248
    s_waitcnt lgkmcnt(0)
    v_max_f32 v248, v248, v249
    ds_bpermute_b32 v249, v253, v248
    s_waitcnt lgkmcnt(0)
    v_max_f32 v248, v248, v249
    v_max_f32 v248, 0, v248
    v_sub_f32 v72, v72, v248
    v_sub_f32 v73, v73, v248
    v_sub_f32 v74, v74, v248
    v_sub_f32 v75, v75, v248
    v_sub_f32 v76, v76, v248
    v_sub_f32 v77, v77, v248
    v_sub_f32 v78, v78, v248
    v_sub_f32 v79, v79, v248
    v_sub_f32 v36, v36, v248
    v_sub_f32 v37, v37, v248
    v_sub_f32 v38, v38, v248
    v_sub_f32 v39, v39, v248
    v_exp_f32 v48, -v248
    s_nop 0
    v_mul_f32 v44, v44, v48
    v_mul_f32 v45, v45, v48
    s_mov_b32 s36, 1
    s_nop 3
    s_branch K1_b1_6
K1_r1_8:
    s_nop 7
    s_nop 7
    v_max3_f32 v248, v80, v81, v82
    v_max3_f32 v248, v248, v83, v84
    v_max3_f32 v248, v248, v85, v86
    v_max_f32 v248, v248, v87
    ds_bpermute_b32 v249, v252, v248
    s_waitcnt lgkmcnt(0)
    v_max_f32 v248, v248, v249
    ds_bpermute_b32 v249, v253, v248
    s_waitcnt lgkmcnt(0)
    v_max_f32 v248, v248, v249
    v_max_f32 v248, 0, v248
    v_sub_f32 v80, v80, v248
    v_sub_f32 v81, v81, v248
    v_sub_f32 v82, v82, v248
    v_sub_f32 v83, v83, v248
    v_sub_f32 v84, v84, v248
    v_sub_f32 v85, v85, v248
    v_sub_f32 v86, v86, v248
    v_sub_f32 v87, v87, v248
    v_sub_f32 v28, v28, v248
    v_sub_f32 v29, v29, v248
    v_sub_f32 v30, v30, v248
    v_sub_f32 v31, v31, v248
    v_exp_f32 v46, -v248
    s_nop 0
    v_mul_f32 v40, v40, v46
    v_mul_f32 v41, v41, v46
    v_max3_f32 v248, v88, v89, v90
    v_max3_f32 v248, v248, v91, v92
    v_max3_f32 v248, v248, v93, v94
    v_max_f32 v248, v248, v95
    ds_bpermute_b32 v249, v252, v248
    s_waitcnt lgkmcnt(0)
    v_max_f32 v248, v248, v249
    ds_bpermute_b32 v249, v253, v248
    s_waitcnt lgkmcnt(0)
    v_max_f32 v248, v248, v249
    v_max_f32 v248, 0, v248
    v_sub_f32 v88, v88, v248
    v_sub_f32 v89, v89, v248
    v_sub_f32 v90, v90, v248
    v_sub_f32 v91, v91, v248
    v_sub_f32 v92, v92, v248
    v_sub_f32 v93, v93, v248
    v_sub_f32 v94, v94, v248
    v_sub_f32 v95, v95, v248
    v_sub_f32 v32, v32, v248
    v_sub_f32 v33, v33, v248
    v_sub_f32 v34, v34, v248
    v_sub_f32 v35, v35, v248
    v_exp_f32 v47, -v248
    s_nop 0
    v_mul_f32 v42, v42, v47
    v_mul_f32 v43, v43, v47
    v_max3_f32 v248, v96, v97, v98
    v_max3_f32 v248, v248, v99, v100
    v_max3_f32 v248, v248, v101, v102
    v_max_f32 v248, v248, v103
    ds_bpermute_b32 v249, v252, v248
    s_waitcnt lgkmcnt(0)
    v_max_f32 v248, v248, v249
    ds_bpermute_b32 v249, v253, v248
    s_waitcnt lgkmcnt(0)
    v_max_f32 v248, v248, v249
    v_max_f32 v248, 0, v248
    v_sub_f32 v96, v96, v248
    v_sub_f32 v97, v97, v248
    v_sub_f32 v98, v98, v248
    v_sub_f32 v99, v99, v248
    v_sub_f32 v100, v100, v248
    v_sub_f32 v101, v101, v248
    v_sub_f32 v102, v102, v248
    v_sub_f32 v103, v103, v248
    v_sub_f32 v36, v36, v248
    v_sub_f32 v37, v37, v248
    v_sub_f32 v38, v38, v248
    v_sub_f32 v39, v39, v248
    v_exp_f32 v48, -v248
    s_nop 0
    v_mul_f32 v44, v44, v48
    v_mul_f32 v45, v45, v48
    s_mov_b32 s36, 1
    s_nop 3
    s_branch K1_b1_8
K1_r1_10:
    s_nop 7
    s_nop 7
    v_max3_f32 v248, v56, v57, v58
    v_max3_f32 v248, v248, v59, v60
    v_max3_f32 v248, v248, v61, v62
    v_max_f32 v248, v248, v63
    ds_bpermute_b32 v249, v252, v248
    s_waitcnt lgkmcnt(0)
    v_max_f32 v248, v248, v249
    ds_bpermute_b32 v249, v253, v248
    s_waitcnt lgkmcnt(0)
    v_max_f32 v248, v248, v249
    v_max_f32 v248, 0, v248
    v_sub_f32 v56, v56, v248
    v_sub_f32 v57, v57, v248
    v_sub_f32 v58, v58, v248
    v_sub_f32 v59, v59, v248
    v_sub_f32 v60, v60, v248
    v_sub_f32 v61, v61, v248
    v_sub_f32 v62, v62, v248
    v_sub_f32 v63, v63, v248
    v_sub_f32 v28, v28, v248
    v_sub_f32 v29, v29, v248
    v_sub_f32 v30, v30, v248
    v_sub_f32 v31, v31, v248
    v_exp_f32 v46, -v248
    s_nop 0
    v_mul_f32 v40, v40, v46
    v_mul_f32 v41, v41, v46
    v_max3_f32 v248, v64, v65, v66
    v_max3_f32 v248, v248, v67, v68
    v_max3_f32 v248, v248, v69, v70
    v_max_f32 v248, v248, v71
    ds_bpermute_b32 v249, v252, v248
    s_waitcnt lgkmcnt(0)
    v_max_f32 v248, v248, v249
    ds_bpermute_b32 v249, v253, v248
    s_waitcnt lgkmcnt(0)
    v_max_f32 v248, v248, v249
    v_max_f32 v248, 0, v248
    v_sub_f32 v64, v64, v248
    v_sub_f32 v65, v65, v248
    v_sub_f32 v66, v66, v248
    v_sub_f32 v67, v67, v248
    v_sub_f32 v68, v68, v248
    v_sub_f32 v69, v69, v248
    v_sub_f32 v70, v70, v248
    v_sub_f32 v71, v71, v248
    v_sub_f32 v32, v32, v248
    v_sub_f32 v33, v33, v248
    v_sub_f32 v34, v34, v248
    v_sub_f32 v35, v35, v248
    v_exp_f32 v47, -v248
    s_nop 0
    v_mul_f32 v42, v42, v47
    v_mul_f32 v43, v43, v47
    v_max3_f32 v248, v72, v73, v74
    v_max3_f32 v248, v248, v75, v76
    v_max3_f32 v248, v248, v77, v78
    v_max_f32 v248, v248, v79
    ds_bpermute_b32 v249, v252, v248
    s_waitcnt lgkmcnt(0)
    v_max_f32 v248, v248, v249
    ds_bpermute_b32 v249, v253, v248
    s_waitcnt lgkmcnt(0)
    v_max_f32 v248, v248, v249
    v_max_f32 v248, 0, v248
    v_sub_f32 v72, v72, v248
    v_sub_f32 v73, v73, v248
    v_sub_f32 v74, v74, v248
    v_sub_f32 v75, v75, v248
    v_sub_f32 v76, v76, v248
    v_sub_f32 v77, v77, v248
    v_sub_f32 v78, v78, v248
    v_sub_f32 v79, v79, v248
    v_sub_f32 v36, v36, v248
    v_sub_f32 v37, v37, v248
    v_sub_f32 v38, v38, v248
    v_sub_f32 v39, v39, v248
    v_exp_f32 v48, -v248
    s_nop 0
    v_mul_f32 v44, v44, v48
    v_mul_f32 v45, v45, v48
    s_mov_b32 s36, 1
    s_nop 3
    s_branch K1_b1_10
K1_r1_12:
    s_nop 7
    s_nop 7
    v_max3_f32 v248, v80, v81, v82
    v_max3_f32 v248, v248, v83, v84
    v_max3_f32 v248, v248, v85, v86
    v_max_f32 v248, v248, v87
    ds_bpermute_b32 v249, v252, v248
    s_waitcnt lgkmcnt(0)
    v_max_f32 v248, v248, v249
    ds_bpermute_b32 v249, v253, v248
    s_waitcnt lgkmcnt(0)
    v_max_f32 v248, v248, v249
    v_max_f32 v248, 0, v248
    v_sub_f32 v80, v80, v248
    v_sub_f32 v81, v81, v248
    v_sub_f32 v82, v82, v248
    v_sub_f32 v83, v83, v248
    v_sub_f32 v84, v84, v248
    v_sub_f32 v85, v85, v248
    v_sub_f32 v86, v86, v248
    v_sub_f32 v87, v87, v248
    v_sub_f32 v28, v28, v248
    v_sub_f32 v29, v29, v248
    v_sub_f32 v30, v30, v248
    v_sub_f32 v31, v31, v248
    v_exp_f32 v46, -v248
    s_nop 0
    v_mul_f32 v40, v40, v46
    v_mul_f32 v41, v41, v46
    v_max3_f32 v248, v88, v89, v90
    v_max3_f32 v248, v248, v91, v92
    v_max3_f32 v248, v248, v93, v94
    v_max_f32 v248, v248, v95
    ds_bpermute_b32 v249, v252, v248
    s_waitcnt lgkmcnt(0)
    v_max_f32 v248, v248, v249
    ds_bpermute_b32 v249, v253, v248
    s_waitcnt lgkmcnt(0)
    v_max_f32 v248, v248, v249
    v_max_f32 v248, 0, v248
    v_sub_f32 v88, v88, v248
    v_sub_f32 v89, v89, v248
    v_sub_f32 v90, v90, v248
    v_sub_f32 v91, v91, v248
    v_sub_f32 v92, v92, v248
    v_sub_f32 v93, v93, v248
    v_sub_f32 v94, v94, v248
    v_sub_f32 v95, v95, v248
    v_sub_f32 v32, v32, v248
    v_sub_f32 v33, v33, v248
    v_sub_f32 v34, v34, v248
    v_sub_f32 v35, v35, v248
    v_exp_f32 v47, -v248
    s_nop 0
    v_mul_f32 v42, v42, v47
    v_mul_f32 v43, v43, v47
    v_max3_f32 v248, v96, v97, v98
    v_max3_f32 v248, v248, v99, v100
    v_max3_f32 v248, v248, v101, v102
    v_max_f32 v248, v248, v103
    ds_bpermute_b32 v249, v252, v248
    s_waitcnt lgkmcnt(0)
    v_max_f32 v248, v248, v249
    ds_bpermute_b32 v249, v253, v248
    s_waitcnt lgkmcnt(0)
    v_max_f32 v248, v248, v249
    v_max_f32 v248, 0, v248
    v_sub_f32 v96, v96, v248
    v_sub_f32 v97, v97, v248
    v_sub_f32 v98, v98, v248
    v_sub_f32 v99, v99, v248
    v_sub_f32 v100, v100, v248
    v_sub_f32 v101, v101, v248
    v_sub_f32 v102, v102, v248
    v_sub_f32 v103, v103, v248
    v_sub_f32 v36, v36, v248
    v_sub_f32 v37, v37, v248
    v_sub_f32 v38, v38, v248
    v_sub_f32 v39, v39, v248
    v_exp_f32 v48, -v248
    s_nop 0
    v_mul_f32 v44, v44, v48
    v_mul_f32 v45, v45, v48
    s_mov_b32 s36, 1
    s_nop 3
    s_branch K1_b1_12
K1_r1_14:
    s_nop 7
    s_nop 7
    v_max3_f32 v248, v56, v57, v58
    v_max3_f32 v248, v248, v59, v60
    v_max3_f32 v248, v248, v61, v62
    v_max_f32 v248, v248, v63
    ds_bpermute_b32 v249, v252, v248
    s_waitcnt lgkmcnt(0)
    v_max_f32 v248, v248, v249
    ds_bpermute_b32 v249, v253, v248
    s_waitcnt lgkmcnt(0)
    v_max_f32 v248, v248, v249
    v_max_f32 v248, 0, v248
    v_sub_f32 v56, v56, v248
    v_sub_f32 v57, v57, v248
    v_sub_f32 v58, v58, v248
    v_sub_f32 v59, v59, v248
    v_sub_f32 v60, v60, v248
    v_sub_f32 v61, v61, v248
    v_sub_f32 v62, v62, v248
    v_sub_f32 v63, v63, v248
    v_sub_f32 v28, v28, v248
    v_sub_f32 v29, v29, v248
    v_sub_f32 v30, v30, v248
    v_sub_f32 v31, v31, v248
    v_exp_f32 v46, -v248
    s_nop 0
    v_mul_f32 v40, v40, v46
    v_mul_f32 v41, v41, v46
    v_max3_f32 v248, v64, v65, v66
    v_max3_f32 v248, v248, v67, v68
    v_max3_f32 v248, v248, v69, v70
    v_max_f32 v248, v248, v71
    ds_bpermute_b32 v249, v252, v248
    s_waitcnt lgkmcnt(0)
    v_max_f32 v248, v248, v249
    ds_bpermute_b32 v249, v253, v248
    s_waitcnt lgkmcnt(0)
    v_max_f32 v248, v248, v249
    v_max_f32 v248, 0, v248
    v_sub_f32 v64, v64, v248
    v_sub_f32 v65, v65, v248
    v_sub_f32 v66, v66, v248
    v_sub_f32 v67, v67, v248
    v_sub_f32 v68, v68, v248
    v_sub_f32 v69, v69, v248
    v_sub_f32 v70, v70, v248
    v_sub_f32 v71, v71, v248
    v_sub_f32 v32, v32, v248
    v_sub_f32 v33, v33, v248
    v_sub_f32 v34, v34, v248
    v_sub_f32 v35, v35, v248
    v_exp_f32 v47, -v248
    s_nop 0
    v_mul_f32 v42, v42, v47
    v_mul_f32 v43, v43, v47
    v_max3_f32 v248, v72, v73, v74
    v_max3_f32 v248, v248, v75, v76
    v_max3_f32 v248, v248, v77, v78
    v_max_f32 v248, v248, v79
    ds_bpermute_b32 v249, v252, v248
    s_waitcnt lgkmcnt(0)
    v_max_f32 v248, v248, v249
    ds_bpermute_b32 v249, v253, v248
    s_waitcnt lgkmcnt(0)
    v_max_f32 v248, v248, v249
    v_max_f32 v248, 0, v248
    v_sub_f32 v72, v72, v248
    v_sub_f32 v73, v73, v248
    v_sub_f32 v74, v74, v248
    v_sub_f32 v75, v75, v248
    v_sub_f32 v76, v76, v248
    v_sub_f32 v77, v77, v248
    v_sub_f32 v78, v78, v248
    v_sub_f32 v79, v79, v248
    v_sub_f32 v36, v36, v248
    v_sub_f32 v37, v37, v248
    v_sub_f32 v38, v38, v248
    v_sub_f32 v39, v39, v248
    v_exp_f32 v48, -v248
    s_nop 0
    v_mul_f32 v44, v44, v48
    v_mul_f32 v45, v45, v48
    s_mov_b32 s36, 1
    s_nop 3
    s_branch K1_b1_14
K1_r1_16:
    s_nop 7
    s_nop 7
    v_max3_f32 v248, v80, v81, v82
    v_max3_f32 v248, v248, v83, v84
    v_max3_f32 v248, v248, v85, v86
    v_max_f32 v248, v248, v87
    ds_bpermute_b32 v249, v252, v248
    s_waitcnt lgkmcnt(0)
    v_max_f32 v248, v248, v249
    ds_bpermute_b32 v249, v253, v248
    s_waitcnt lgkmcnt(0)
    v_max_f32 v248, v248, v249
    v_max_f32 v248, 0, v248
    v_sub_f32 v80, v80, v248
    v_sub_f32 v81, v81, v248
    v_sub_f32 v82, v82, v248
    v_sub_f32 v83, v83, v248
    v_sub_f32 v84, v84, v248
    v_sub_f32 v85, v85, v248
    v_sub_f32 v86, v86, v248
    v_sub_f32 v87, v87, v248
    v_sub_f32 v28, v28, v248
    v_sub_f32 v29, v29, v248
    v_sub_f32 v30, v30, v248
    v_sub_f32 v31, v31, v248
    v_exp_f32 v46, -v248
    s_nop 0
    v_mul_f32 v40, v40, v46
    v_mul_f32 v41, v41, v46
    v_max3_f32 v248, v88, v89, v90
    v_max3_f32 v248, v248, v91, v92
    v_max3_f32 v248, v248, v93, v94
    v_max_f32 v248, v248, v95
    ds_bpermute_b32 v249, v252, v248
    s_waitcnt lgkmcnt(0)
    v_max_f32 v248, v248, v249
    ds_bpermute_b32 v249, v253, v248
    s_waitcnt lgkmcnt(0)
    v_max_f32 v248, v248, v249
    v_max_f32 v248, 0, v248
    v_sub_f32 v88, v88, v248
    v_sub_f32 v89, v89, v248
    v_sub_f32 v90, v90, v248
    v_sub_f32 v91, v91, v248
    v_sub_f32 v92, v92, v248
    v_sub_f32 v93, v93, v248
    v_sub_f32 v94, v94, v248
    v_sub_f32 v95, v95, v248
    v_sub_f32 v32, v32, v248
    v_sub_f32 v33, v33, v248
    v_sub_f32 v34, v34, v248
    v_sub_f32 v35, v35, v248
    v_exp_f32 v47, -v248
    s_nop 0
    v_mul_f32 v42, v42, v47
    v_mul_f32 v43, v43, v47
    v_max3_f32 v248, v96, v97, v98
    v_max3_f32 v248, v248, v99, v100
    v_max3_f32 v248, v248, v101, v102
    v_max_f32 v248, v248, v103
    ds_bpermute_b32 v249, v252, v248
    s_waitcnt lgkmcnt(0)
    v_max_f32 v248, v248, v249
    ds_bpermute_b32 v249, v253, v248
    s_waitcnt lgkmcnt(0)
    v_max_f32 v248, v248, v249
    v_max_f32 v248, 0, v248
    v_sub_f32 v96, v96, v248
    v_sub_f32 v97, v97, v248
    v_sub_f32 v98, v98, v248
    v_sub_f32 v99, v99, v248
    v_sub_f32 v100, v100, v248
    v_sub_f32 v101, v101, v248
    v_sub_f32 v102, v102, v248
    v_sub_f32 v103, v103, v248
    v_sub_f32 v36, v36, v248
    v_sub_f32 v37, v37, v248
    v_sub_f32 v38, v38, v248
    v_sub_f32 v39, v39, v248
    v_exp_f32 v48, -v248
    s_nop 0
    v_mul_f32 v44, v44, v48
    v_mul_f32 v45, v45, v48
    s_mov_b32 s36, 1
    s_nop 3
    s_branch K1_b1_16
K1_r1_18:
    s_nop 7
    s_nop 7
    v_max3_f32 v248, v56, v57, v58
    v_max3_f32 v248, v248, v59, v60
    v_max3_f32 v248, v248, v61, v62
    v_max_f32 v248, v248, v63
    ds_bpermute_b32 v249, v252, v248
    s_waitcnt lgkmcnt(0)
    v_max_f32 v248, v248, v249
    ds_bpermute_b32 v249, v253, v248
    s_waitcnt lgkmcnt(0)
    v_max_f32 v248, v248, v249
    v_max_f32 v248, 0, v248
    v_sub_f32 v56, v56, v248
    v_sub_f32 v57, v57, v248
    v_sub_f32 v58, v58, v248
    v_sub_f32 v59, v59, v248
    v_sub_f32 v60, v60, v248
    v_sub_f32 v61, v61, v248
    v_sub_f32 v62, v62, v248
    v_sub_f32 v63, v63, v248
    v_sub_f32 v28, v28, v248
    v_sub_f32 v29, v29, v248
    v_sub_f32 v30, v30, v248
    v_sub_f32 v31, v31, v248
    v_exp_f32 v46, -v248
    s_nop 0
    v_mul_f32 v40, v40, v46
    v_mul_f32 v41, v41, v46
    v_max3_f32 v248, v64, v65, v66
    v_max3_f32 v248, v248, v67, v68
    v_max3_f32 v248, v248, v69, v70
    v_max_f32 v248, v248, v71
    ds_bpermute_b32 v249, v252, v248
    s_waitcnt lgkmcnt(0)
    v_max_f32 v248, v248, v249
    ds_bpermute_b32 v249, v253, v248
    s_waitcnt lgkmcnt(0)
    v_max_f32 v248, v248, v249
    v_max_f32 v248, 0, v248
    v_sub_f32 v64, v64, v248
    v_sub_f32 v65, v65, v248
    v_sub_f32 v66, v66, v248
    v_sub_f32 v67, v67, v248
    v_sub_f32 v68, v68, v248
    v_sub_f32 v69, v69, v248
    v_sub_f32 v70, v70, v248
    v_sub_f32 v71, v71, v248
    v_sub_f32 v32, v32, v248
    v_sub_f32 v33, v33, v248
    v_sub_f32 v34, v34, v248
    v_sub_f32 v35, v35, v248
    v_exp_f32 v47, -v248
    s_nop 0
    v_mul_f32 v42, v42, v47
    v_mul_f32 v43, v43, v47
    v_max3_f32 v248, v72, v73, v74
    v_max3_f32 v248, v248, v75, v76
    v_max3_f32 v248, v248, v77, v78
    v_max_f32 v248, v248, v79
    ds_bpermute_b32 v249, v252, v248
    s_waitcnt lgkmcnt(0)
    v_max_f32 v248, v248, v249
    ds_bpermute_b32 v249, v253, v248
    s_waitcnt lgkmcnt(0)
    v_max_f32 v248, v248, v249
    v_max_f32 v248, 0, v248
    v_sub_f32 v72, v72, v248
    v_sub_f32 v73, v73, v248
    v_sub_f32 v74, v74, v248
    v_sub_f32 v75, v75, v248
    v_sub_f32 v76, v76, v248
    v_sub_f32 v77, v77, v248
    v_sub_f32 v78, v78, v248
    v_sub_f32 v79, v79, v248
    v_sub_f32 v36, v36, v248
    v_sub_f32 v37, v37, v248
    v_sub_f32 v38, v38, v248
    v_sub_f32 v39, v39, v248
    v_exp_f32 v48, -v248
    s_nop 0
    v_mul_f32 v44, v44, v48
    v_mul_f32 v45, v45, v48
    s_mov_b32 s36, 1
    s_nop 3
    s_branch K1_b1_18
K1_r1_20:
    s_nop 7
    s_nop 7
    v_max3_f32 v248, v80, v81, v82
    v_max3_f32 v248, v248, v83, v84
    v_max3_f32 v248, v248, v85, v86
    v_max_f32 v248, v248, v87
    ds_bpermute_b32 v249, v252, v248
    s_waitcnt lgkmcnt(0)
    v_max_f32 v248, v248, v249
    ds_bpermute_b32 v249, v253, v248
    s_waitcnt lgkmcnt(0)
    v_max_f32 v248, v248, v249
    v_max_f32 v248, 0, v248
    v_sub_f32 v80, v80, v248
    v_sub_f32 v81, v81, v248
    v_sub_f32 v82, v82, v248
    v_sub_f32 v83, v83, v248
    v_sub_f32 v84, v84, v248
    v_sub_f32 v85, v85, v248
    v_sub_f32 v86, v86, v248
    v_sub_f32 v87, v87, v248
    v_sub_f32 v28, v28, v248
    v_sub_f32 v29, v29, v248
    v_sub_f32 v30, v30, v248
    v_sub_f32 v31, v31, v248
    v_exp_f32 v46, -v248
    s_nop 0
    v_mul_f32 v40, v40, v46
    v_mul_f32 v41, v41, v46
    v_max3_f32 v248, v88, v89, v90
    v_max3_f32 v248, v248, v91, v92
    v_max3_f32 v248, v248, v93, v94
    v_max_f32 v248, v248, v95
    ds_bpermute_b32 v249, v252, v248
    s_waitcnt lgkmcnt(0)
    v_max_f32 v248, v248, v249
    ds_bpermute_b32 v249, v253, v248
    s_waitcnt lgkmcnt(0)
    v_max_f32 v248, v248, v249
    v_max_f32 v248, 0, v248
    v_sub_f32 v88, v88, v248
    v_sub_f32 v89, v89, v248
    v_sub_f32 v90, v90, v248
    v_sub_f32 v91, v91, v248
    v_sub_f32 v92, v92, v248
    v_sub_f32 v93, v93, v248
    v_sub_f32 v94, v94, v248
    v_sub_f32 v95, v95, v248
    v_sub_f32 v32, v32, v248
    v_sub_f32 v33, v33, v248
    v_sub_f32 v34, v34, v248
    v_sub_f32 v35, v35, v248
    v_exp_f32 v47, -v248
    s_nop 0
    v_mul_f32 v42, v42, v47
    v_mul_f32 v43, v43, v47
    v_max3_f32 v248, v96, v97, v98
    v_max3_f32 v248, v248, v99, v100
    v_max3_f32 v248, v248, v101, v102
    v_max_f32 v248, v248, v103
    ds_bpermute_b32 v249, v252, v248
    s_waitcnt lgkmcnt(0)
    v_max_f32 v248, v248, v249
    ds_bpermute_b32 v249, v253, v248
    s_waitcnt lgkmcnt(0)
    v_max_f32 v248, v248, v249
    v_max_f32 v248, 0, v248
    v_sub_f32 v96, v96, v248
    v_sub_f32 v97, v97, v248
    v_sub_f32 v98, v98, v248
    v_sub_f32 v99, v99, v248
    v_sub_f32 v100, v100, v248
    v_sub_f32 v101, v101, v248
    v_sub_f32 v102, v102, v248
    v_sub_f32 v103, v103, v248
    v_sub_f32 v36, v36, v248
    v_sub_f32 v37, v37, v248
    v_sub_f32 v38, v38, v248
    v_sub_f32 v39, v39, v248
    v_exp_f32 v48, -v248
    s_nop 0
    v_mul_f32 v44, v44, v48
    v_mul_f32 v45, v45, v48
    s_mov_b32 s36, 1
    s_nop 3
    s_branch K1_b1_20
K1_r2_1:
    s_nop 7
    s_nop 7
    v_mul_f32 v152, v152, v46
    v_mul_f32 v153, v153, v46
    v_mul_f32 v154, v154, v46
    v_mul_f32 v155, v155, v46
    v_mul_f32 v156, v156, v46
    v_mul_f32 v157, v157, v46
    v_mul_f32 v158, v158, v46
    v_mul_f32 v159, v159, v46
    v_mul_f32 v160, v160, v46
    v_mul_f32 v161, v161, v46
    v_mul_f32 v162, v162, v46
    v_mul_f32 v163, v163, v46
    v_mul_f32 v164, v164, v46
    v_mul_f32 v165, v165, v46
    v_mul_f32 v166, v166, v46
    v_mul_f32 v167, v167, v46
    v_mul_f32 v168, v168, v46
    v_mul_f32 v169, v169, v46
    v_mul_f32 v170, v170, v46
    v_mul_f32 v171, v171, v46
    v_mul_f32 v172, v172, v46
    v_mul_f32 v173, v173, v46
    v_mul_f32 v174, v174, v46
    v_mul_f32 v175, v175, v46
    v_mul_f32 v176, v176, v46
    v_mul_f32 v177, v177, v46
    v_mul_f32 v178, v178, v46
    v_mul_f32 v179, v179, v46
    v_mul_f32 v180, v180, v46
    v_mul_f32 v181, v181, v46
    v_mul_f32 v182, v182, v46
    v_mul_f32 v183, v183, v46
    v_mul_f32 v184, v184, v47
    v_mul_f32 v185, v185, v47
    v_mul_f32 v186, v186, v47
    v_mul_f32 v187, v187, v47
    v_mul_f32 v188, v188, v47
    v_mul_f32 v189, v189, v47
    v_mul_f32 v190, v190, v47
    v_mul_f32 v191, v191, v47
    v_mul_f32 v192, v192, v47
    v_mul_f32 v193, v193, v47
    v_mul_f32 v194, v194, v47
    v_mul_f32 v195, v195, v47
    v_mul_f32 v196, v196, v47
    v_mul_f32 v197, v197, v47
    v_mul_f32 v198, v198, v47
    v_mul_f32 v199, v199, v47
    v_mul_f32 v200, v200, v47
    v_mul_f32 v201, v201, v47
    v_mul_f32 v202, v202, v47
    v_mul_f32 v203, v203, v47
    v_mul_f32 v204, v204, v47
    v_mul_f32 v205, v205, v47
    v_mul_f32 v206, v206, v47
    v_mul_f32 v207, v207, v47
    v_mul_f32 v208, v208, v47
    v_mul_f32 v209, v209, v47
    v_mul_f32 v210, v210, v47
    v_mul_f32 v211, v211, v47
    v_mul_f32 v212, v212, v47
    v_mul_f32 v213, v213, v47
    v_mul_f32 v214, v214, v47
    v_mul_f32 v215, v215, v47
    v_mul_f32 v216, v216, v48
    v_mul_f32 v217, v217, v48
    v_mul_f32 v218, v218, v48
    v_mul_f32 v219, v219, v48
    v_mul_f32 v220, v220, v48
    v_mul_f32 v221, v221, v48
    v_mul_f32 v222, v222, v48
    v_mul_f32 v223, v223, v48
    v_mul_f32 v224, v224, v48
    v_mul_f32 v225, v225, v48
    v_mul_f32 v226, v226, v48
    v_mul_f32 v227, v227, v48
    v_mul_f32 v228, v228, v48
    v_mul_f32 v229, v229, v48
    v_mul_f32 v230, v230, v48
    v_mul_f32 v231, v231, v48
    v_mul_f32 v232, v232, v48
    v_mul_f32 v233, v233, v48
    v_mul_f32 v234, v234, v48
    v_mul_f32 v235, v235, v48
    v_mul_f32 v236, v236, v48
    v_mul_f32 v237, v237, v48
    v_mul_f32 v238, v238, v48
    v_mul_f32 v239, v239, v48
    v_mul_f32 v240, v240, v48
    v_mul_f32 v241, v241, v48
    v_mul_f32 v242, v242, v48
    v_mul_f32 v243, v243, v48
    v_mul_f32 v244, v244, v48
    v_mul_f32 v245, v245, v48
    v_mul_f32 v246, v246, v48
    v_mul_f32 v247, v247, v48
    s_mov_b32 s36, 0
    s_nop 3
    s_branch K1_b2_1
K1_r2_3:
    s_nop 7
    s_nop 7
    v_mul_f32 v152, v152, v46
    v_mul_f32 v153, v153, v46
    v_mul_f32 v154, v154, v46
    v_mul_f32 v155, v155, v46
    v_mul_f32 v156, v156, v46
    v_mul_f32 v157, v157, v46
    v_mul_f32 v158, v158, v46
    v_mul_f32 v159, v159, v46
    v_mul_f32 v160, v160, v46
    v_mul_f32 v161, v161, v46
    v_mul_f32 v162, v162, v46
    v_mul_f32 v163, v163, v46
    v_mul_f32 v164, v164, v46
    v_mul_f32 v165, v165, v46
    v_mul_f32 v166, v166, v46
    v_mul_f32 v167, v167, v46
    v_mul_f32 v168, v168, v46
    v_mul_f32 v169, v169, v46
    v_mul_f32 v170, v170, v46
    v_mul_f32 v171, v171, v46
    v_mul_f32 v172, v172, v46
    v_mul_f32 v173, v173, v46
    v_mul_f32 v174, v174, v46
    v_mul_f32 v175, v175, v46
    v_mul_f32 v176, v176, v46
    v_mul_f32 v177, v177, v46
    v_mul_f32 v178, v178, v46
    v_mul_f32 v179, v179, v46
    v_mul_f32 v180, v180, v46
    v_mul_f32 v181, v181, v46
    v_mul_f32 v182, v182, v46
    v_mul_f32 v183, v183, v46
    v_mul_f32 v184, v184, v47
    v_mul_f32 v185, v185, v47
    v_mul_f32 v186, v186, v47
    v_mul_f32 v187, v187, v47
    v_mul_f32 v188, v188, v47
    v_mul_f32 v189, v189, v47
    v_mul_f32 v190, v190, v47
    v_mul_f32 v191, v191, v47
    v_mul_f32 v192, v192, v47
    v_mul_f32 v193, v193, v47
    v_mul_f32 v194, v194, v47
    v_mul_f32 v195, v195, v47
    v_mul_f32 v196, v196, v47
    v_mul_f32 v197, v197, v47
    v_mul_f32 v198, v198, v47
    v_mul_f32 v199, v199, v47
    v_mul_f32 v200, v200, v47
    v_mul_f32 v201, v201, v47
    v_mul_f32 v202, v202, v47
    v_mul_f32 v203, v203, v47
    v_mul_f32 v204, v204, v47
    v_mul_f32 v205, v205, v47
    v_mul_f32 v206, v206, v47
    v_mul_f32 v207, v207, v47
    v_mul_f32 v208, v208, v47
    v_mul_f32 v209, v209, v47
    v_mul_f32 v210, v210, v47
    v_mul_f32 v211, v211, v47
    v_mul_f32 v212, v212, v47
    v_mul_f32 v213, v213, v47
    v_mul_f32 v214, v214, v47
    v_mul_f32 v215, v215, v47
    v_mul_f32 v216, v216, v48
    v_mul_f32 v217, v217, v48
    v_mul_f32 v218, v218, v48
    v_mul_f32 v219, v219, v48
    v_mul_f32 v220, v220, v48
    v_mul_f32 v221, v221, v48
    v_mul_f32 v222, v222, v48
    v_mul_f32 v223, v223, v48
    v_mul_f32 v224, v224, v48
    v_mul_f32 v225, v225, v48
    v_mul_f32 v226, v226, v48
    v_mul_f32 v227, v227, v48
    v_mul_f32 v228, v228, v48
    v_mul_f32 v229, v229, v48
    v_mul_f32 v230, v230, v48
    v_mul_f32 v231, v231, v48
    v_mul_f32 v232, v232, v48
    v_mul_f32 v233, v233, v48
    v_mul_f32 v234, v234, v48
    v_mul_f32 v235, v235, v48
    v_mul_f32 v236, v236, v48
    v_mul_f32 v237, v237, v48
    v_mul_f32 v238, v238, v48
    v_mul_f32 v239, v239, v48
    v_mul_f32 v240, v240, v48
    v_mul_f32 v241, v241, v48
    v_mul_f32 v242, v242, v48
    v_mul_f32 v243, v243, v48
    v_mul_f32 v244, v244, v48
    v_mul_f32 v245, v245, v48
    v_mul_f32 v246, v246, v48
    v_mul_f32 v247, v247, v48
    s_mov_b32 s36, 0
    s_nop 3
    s_branch K1_b2_3
K1_r2_5:
    s_nop 7
    s_nop 7
    v_mul_f32 v152, v152, v46
    v_mul_f32 v153, v153, v46
    v_mul_f32 v154, v154, v46
    v_mul_f32 v155, v155, v46
    v_mul_f32 v156, v156, v46
    v_mul_f32 v157, v157, v46
    v_mul_f32 v158, v158, v46
    v_mul_f32 v159, v159, v46
    v_mul_f32 v160, v160, v46
    v_mul_f32 v161, v161, v46
    v_mul_f32 v162, v162, v46
    v_mul_f32 v163, v163, v46
    v_mul_f32 v164, v164, v46
    v_mul_f32 v165, v165, v46
    v_mul_f32 v166, v166, v46
    v_mul_f32 v167, v167, v46
    v_mul_f32 v168, v168, v46
    v_mul_f32 v169, v169, v46
    v_mul_f32 v170, v170, v46
    v_mul_f32 v171, v171, v46
    v_mul_f32 v172, v172, v46
    v_mul_f32 v173, v173, v46
    v_mul_f32 v174, v174, v46
    v_mul_f32 v175, v175, v46
    v_mul_f32 v176, v176, v46
    v_mul_f32 v177, v177, v46
    v_mul_f32 v178, v178, v46
    v_mul_f32 v179, v179, v46
    v_mul_f32 v180, v180, v46
    v_mul_f32 v181, v181, v46
    v_mul_f32 v182, v182, v46
    v_mul_f32 v183, v183, v46
    v_mul_f32 v184, v184, v47
    v_mul_f32 v185, v185, v47
    v_mul_f32 v186, v186, v47
    v_mul_f32 v187, v187, v47
    v_mul_f32 v188, v188, v47
    v_mul_f32 v189, v189, v47
    v_mul_f32 v190, v190, v47
    v_mul_f32 v191, v191, v47
    v_mul_f32 v192, v192, v47
    v_mul_f32 v193, v193, v47
    v_mul_f32 v194, v194, v47
    v_mul_f32 v195, v195, v47
    v_mul_f32 v196, v196, v47
    v_mul_f32 v197, v197, v47
    v_mul_f32 v198, v198, v47
    v_mul_f32 v199, v199, v47
    v_mul_f32 v200, v200, v47
    v_mul_f32 v201, v201, v47
    v_mul_f32 v202, v202, v47
    v_mul_f32 v203, v203, v47
    v_mul_f32 v204, v204, v47
    v_mul_f32 v205, v205, v47
    v_mul_f32 v206, v206, v47
    v_mul_f32 v207, v207, v47
    v_mul_f32 v208, v208, v47
    v_mul_f32 v209, v209, v47
    v_mul_f32 v210, v210, v47
    v_mul_f32 v211, v211, v47
    v_mul_f32 v212, v212, v47
    v_mul_f32 v213, v213, v47
    v_mul_f32 v214, v214, v47
    v_mul_f32 v215, v215, v47
    v_mul_f32 v216, v216, v48
    v_mul_f32 v217, v217, v48
    v_mul_f32 v218, v218, v48
    v_mul_f32 v219, v219, v48
    v_mul_f32 v220, v220, v48
    v_mul_f32 v221, v221, v48
    v_mul_f32 v222, v222, v48
    v_mul_f32 v223, v223, v48
    v_mul_f32 v224, v224, v48
    v_mul_f32 v225, v225, v48
    v_mul_f32 v226, v226, v48
    v_mul_f32 v227, v227, v48
    v_mul_f32 v228, v228, v48
    v_mul_f32 v229, v229, v48
    v_mul_f32 v230, v230, v48
    v_mul_f32 v231, v231, v48
    v_mul_f32 v232, v232, v48
    v_mul_f32 v233, v233, v48
    v_mul_f32 v234, v234, v48
    v_mul_f32 v235, v235, v48
    v_mul_f32 v236, v236, v48
    v_mul_f32 v237, v237, v48
    v_mul_f32 v238, v238, v48
    v_mul_f32 v239, v239, v48
    v_mul_f32 v240, v240, v48
    v_mul_f32 v241, v241, v48
    v_mul_f32 v242, v242, v48
    v_mul_f32 v243, v243, v48
    v_mul_f32 v244, v244, v48
    v_mul_f32 v245, v245, v48
    v_mul_f32 v246, v246, v48
    v_mul_f32 v247, v247, v48
    s_mov_b32 s36, 0
    s_nop 3
    s_branch K1_b2_5
K1_r2_7:
    s_nop 7
    s_nop 7
    v_mul_f32 v152, v152, v46
    v_mul_f32 v153, v153, v46
    v_mul_f32 v154, v154, v46
    v_mul_f32 v155, v155, v46
    v_mul_f32 v156, v156, v46
    v_mul_f32 v157, v157, v46
    v_mul_f32 v158, v158, v46
    v_mul_f32 v159, v159, v46
    v_mul_f32 v160, v160, v46
    v_mul_f32 v161, v161, v46
    v_mul_f32 v162, v162, v46
    v_mul_f32 v163, v163, v46
    v_mul_f32 v164, v164, v46
    v_mul_f32 v165, v165, v46
    v_mul_f32 v166, v166, v46
    v_mul_f32 v167, v167, v46
    v_mul_f32 v168, v168, v46
    v_mul_f32 v169, v169, v46
    v_mul_f32 v170, v170, v46
    v_mul_f32 v171, v171, v46
    v_mul_f32 v172, v172, v46
    v_mul_f32 v173, v173, v46
    v_mul_f32 v174, v174, v46
    v_mul_f32 v175, v175, v46
    v_mul_f32 v176, v176, v46
    v_mul_f32 v177, v177, v46
    v_mul_f32 v178, v178, v46
    v_mul_f32 v179, v179, v46
    v_mul_f32 v180, v180, v46
    v_mul_f32 v181, v181, v46
    v_mul_f32 v182, v182, v46
    v_mul_f32 v183, v183, v46
    v_mul_f32 v184, v184, v47
    v_mul_f32 v185, v185, v47
    v_mul_f32 v186, v186, v47
    v_mul_f32 v187, v187, v47
    v_mul_f32 v188, v188, v47
    v_mul_f32 v189, v189, v47
    v_mul_f32 v190, v190, v47
    v_mul_f32 v191, v191, v47
    v_mul_f32 v192, v192, v47
    v_mul_f32 v193, v193, v47
    v_mul_f32 v194, v194, v47
    v_mul_f32 v195, v195, v47
    v_mul_f32 v196, v196, v47
    v_mul_f32 v197, v197, v47
    v_mul_f32 v198, v198, v47
    v_mul_f32 v199, v199, v47
    v_mul_f32 v200, v200, v47
    v_mul_f32 v201, v201, v47
    v_mul_f32 v202, v202, v47
    v_mul_f32 v203, v203, v47
    v_mul_f32 v204, v204, v47
    v_mul_f32 v205, v205, v47
    v_mul_f32 v206, v206, v47
    v_mul_f32 v207, v207, v47
    v_mul_f32 v208, v208, v47
    v_mul_f32 v209, v209, v47
    v_mul_f32 v210, v210, v47
    v_mul_f32 v211, v211, v47
    v_mul_f32 v212, v212, v47
    v_mul_f32 v213, v213, v47
    v_mul_f32 v214, v214, v47
    v_mul_f32 v215, v215, v47
    v_mul_f32 v216, v216, v48
    v_mul_f32 v217, v217, v48
    v_mul_f32 v218, v218, v48
    v_mul_f32 v219, v219, v48
    v_mul_f32 v220, v220, v48
    v_mul_f32 v221, v221, v48
    v_mul_f32 v222, v222, v48
    v_mul_f32 v223, v223, v48
    v_mul_f32 v224, v224, v48
    v_mul_f32 v225, v225, v48
    v_mul_f32 v226, v226, v48
    v_mul_f32 v227, v227, v48
    v_mul_f32 v228, v228, v48
    v_mul_f32 v229, v229, v48
    v_mul_f32 v230, v230, v48
    v_mul_f32 v231, v231, v48
    v_mul_f32 v232, v232, v48
    v_mul_f32 v233, v233, v48
    v_mul_f32 v234, v234, v48
    v_mul_f32 v235, v235, v48
    v_mul_f32 v236, v236, v48
    v_mul_f32 v237, v237, v48
    v_mul_f32 v238, v238, v48
    v_mul_f32 v239, v239, v48
    v_mul_f32 v240, v240, v48
    v_mul_f32 v241, v241, v48
    v_mul_f32 v242, v242, v48
    v_mul_f32 v243, v243, v48
    v_mul_f32 v244, v244, v48
    v_mul_f32 v245, v245, v48
    v_mul_f32 v246, v246, v48
    v_mul_f32 v247, v247, v48
    s_mov_b32 s36, 0
    s_nop 3
    s_branch K1_b2_7
K1_r2_9:
    s_nop 7
    s_nop 7
    v_mul_f32 v152, v152, v46
    v_mul_f32 v153, v153, v46
    v_mul_f32 v154, v154, v46
    v_mul_f32 v155, v155, v46
    v_mul_f32 v156, v156, v46
    v_mul_f32 v157, v157, v46
    v_mul_f32 v158, v158, v46
    v_mul_f32 v159, v159, v46
    v_mul_f32 v160, v160, v46
    v_mul_f32 v161, v161, v46
    v_mul_f32 v162, v162, v46
    v_mul_f32 v163, v163, v46
    v_mul_f32 v164, v164, v46
    v_mul_f32 v165, v165, v46
    v_mul_f32 v166, v166, v46
    v_mul_f32 v167, v167, v46
    v_mul_f32 v168, v168, v46
    v_mul_f32 v169, v169, v46
    v_mul_f32 v170, v170, v46
    v_mul_f32 v171, v171, v46
    v_mul_f32 v172, v172, v46
    v_mul_f32 v173, v173, v46
    v_mul_f32 v174, v174, v46
    v_mul_f32 v175, v175, v46
    v_mul_f32 v176, v176, v46
    v_mul_f32 v177, v177, v46
    v_mul_f32 v178, v178, v46
    v_mul_f32 v179, v179, v46
    v_mul_f32 v180, v180, v46
    v_mul_f32 v181, v181, v46
    v_mul_f32 v182, v182, v46
    v_mul_f32 v183, v183, v46
    v_mul_f32 v184, v184, v47
    v_mul_f32 v185, v185, v47
    v_mul_f32 v186, v186, v47
    v_mul_f32 v187, v187, v47
    v_mul_f32 v188, v188, v47
    v_mul_f32 v189, v189, v47
    v_mul_f32 v190, v190, v47
    v_mul_f32 v191, v191, v47
    v_mul_f32 v192, v192, v47
    v_mul_f32 v193, v193, v47
    v_mul_f32 v194, v194, v47
    v_mul_f32 v195, v195, v47
    v_mul_f32 v196, v196, v47
    v_mul_f32 v197, v197, v47
    v_mul_f32 v198, v198, v47
    v_mul_f32 v199, v199, v47
    v_mul_f32 v200, v200, v47
    v_mul_f32 v201, v201, v47
    v_mul_f32 v202, v202, v47
    v_mul_f32 v203, v203, v47
    v_mul_f32 v204, v204, v47
    v_mul_f32 v205, v205, v47
    v_mul_f32 v206, v206, v47
    v_mul_f32 v207, v207, v47
    v_mul_f32 v208, v208, v47
    v_mul_f32 v209, v209, v47
    v_mul_f32 v210, v210, v47
    v_mul_f32 v211, v211, v47
    v_mul_f32 v212, v212, v47
    v_mul_f32 v213, v213, v47
    v_mul_f32 v214, v214, v47
    v_mul_f32 v215, v215, v47
    v_mul_f32 v216, v216, v48
    v_mul_f32 v217, v217, v48
    v_mul_f32 v218, v218, v48
    v_mul_f32 v219, v219, v48
    v_mul_f32 v220, v220, v48
    v_mul_f32 v221, v221, v48
    v_mul_f32 v222, v222, v48
    v_mul_f32 v223, v223, v48
    v_mul_f32 v224, v224, v48
    v_mul_f32 v225, v225, v48
    v_mul_f32 v226, v226, v48
    v_mul_f32 v227, v227, v48
    v_mul_f32 v228, v228, v48
    v_mul_f32 v229, v229, v48
    v_mul_f32 v230, v230, v48
    v_mul_f32 v231, v231, v48
    v_mul_f32 v232, v232, v48
    v_mul_f32 v233, v233, v48
    v_mul_f32 v234, v234, v48
    v_mul_f32 v235, v235, v48
    v_mul_f32 v236, v236, v48
    v_mul_f32 v237, v237, v48
    v_mul_f32 v238, v238, v48
    v_mul_f32 v239, v239, v48
    v_mul_f32 v240, v240, v48
    v_mul_f32 v241, v241, v48
    v_mul_f32 v242, v242, v48
    v_mul_f32 v243, v243, v48
    v_mul_f32 v244, v244, v48
    v_mul_f32 v245, v245, v48
    v_mul_f32 v246, v246, v48
    v_mul_f32 v247, v247, v48
    s_mov_b32 s36, 0
    s_nop 3
    s_branch K1_b2_9
K1_r2_11:
    s_nop 7
    s_nop 7
    v_mul_f32 v152, v152, v46
    v_mul_f32 v153, v153, v46
    v_mul_f32 v154, v154, v46
    v_mul_f32 v155, v155, v46
    v_mul_f32 v156, v156, v46
    v_mul_f32 v157, v157, v46
    v_mul_f32 v158, v158, v46
    v_mul_f32 v159, v159, v46
    v_mul_f32 v160, v160, v46
    v_mul_f32 v161, v161, v46
    v_mul_f32 v162, v162, v46
    v_mul_f32 v163, v163, v46
    v_mul_f32 v164, v164, v46
    v_mul_f32 v165, v165, v46
    v_mul_f32 v166, v166, v46
    v_mul_f32 v167, v167, v46
    v_mul_f32 v168, v168, v46
    v_mul_f32 v169, v169, v46
    v_mul_f32 v170, v170, v46
    v_mul_f32 v171, v171, v46
    v_mul_f32 v172, v172, v46
    v_mul_f32 v173, v173, v46
    v_mul_f32 v174, v174, v46
    v_mul_f32 v175, v175, v46
    v_mul_f32 v176, v176, v46
    v_mul_f32 v177, v177, v46
    v_mul_f32 v178, v178, v46
    v_mul_f32 v179, v179, v46
    v_mul_f32 v180, v180, v46
    v_mul_f32 v181, v181, v46
    v_mul_f32 v182, v182, v46
    v_mul_f32 v183, v183, v46
    v_mul_f32 v184, v184, v47
    v_mul_f32 v185, v185, v47
    v_mul_f32 v186, v186, v47
    v_mul_f32 v187, v187, v47
    v_mul_f32 v188, v188, v47
    v_mul_f32 v189, v189, v47
    v_mul_f32 v190, v190, v47
    v_mul_f32 v191, v191, v47
    v_mul_f32 v192, v192, v47
    v_mul_f32 v193, v193, v47
    v_mul_f32 v194, v194, v47
    v_mul_f32 v195, v195, v47
    v_mul_f32 v196, v196, v47
    v_mul_f32 v197, v197, v47
    v_mul_f32 v198, v198, v47
    v_mul_f32 v199, v199, v47
    v_mul_f32 v200, v200, v47
    v_mul_f32 v201, v201, v47
    v_mul_f32 v202, v202, v47
    v_mul_f32 v203, v203, v47
    v_mul_f32 v204, v204, v47
    v_mul_f32 v205, v205, v47
    v_mul_f32 v206, v206, v47
    v_mul_f32 v207, v207, v47
    v_mul_f32 v208, v208, v47
    v_mul_f32 v209, v209, v47
    v_mul_f32 v210, v210, v47
    v_mul_f32 v211, v211, v47
    v_mul_f32 v212, v212, v47
    v_mul_f32 v213, v213, v47
    v_mul_f32 v214, v214, v47
    v_mul_f32 v215, v215, v47
    v_mul_f32 v216, v216, v48
    v_mul_f32 v217, v217, v48
    v_mul_f32 v218, v218, v48
    v_mul_f32 v219, v219, v48
    v_mul_f32 v220, v220, v48
    v_mul_f32 v221, v221, v48
    v_mul_f32 v222, v222, v48
    v_mul_f32 v223, v223, v48
    v_mul_f32 v224, v224, v48
    v_mul_f32 v225, v225, v48
    v_mul_f32 v226, v226, v48
    v_mul_f32 v227, v227, v48
    v_mul_f32 v228, v228, v48
    v_mul_f32 v229, v229, v48
    v_mul_f32 v230, v230, v48
    v_mul_f32 v231, v231, v48
    v_mul_f32 v232, v232, v48
    v_mul_f32 v233, v233, v48
    v_mul_f32 v234, v234, v48
    v_mul_f32 v235, v235, v48
    v_mul_f32 v236, v236, v48
    v_mul_f32 v237, v237, v48
    v_mul_f32 v238, v238, v48
    v_mul_f32 v239, v239, v48
    v_mul_f32 v240, v240, v48
    v_mul_f32 v241, v241, v48
    v_mul_f32 v242, v242, v48
    v_mul_f32 v243, v243, v48
    v_mul_f32 v244, v244, v48
    v_mul_f32 v245, v245, v48
    v_mul_f32 v246, v246, v48
    v_mul_f32 v247, v247, v48
    s_mov_b32 s36, 0
    s_nop 3
    s_branch K1_b2_11
K1_r2_13:
    s_nop 7
    s_nop 7
    v_mul_f32 v152, v152, v46
    v_mul_f32 v153, v153, v46
    v_mul_f32 v154, v154, v46
    v_mul_f32 v155, v155, v46
    v_mul_f32 v156, v156, v46
    v_mul_f32 v157, v157, v46
    v_mul_f32 v158, v158, v46
    v_mul_f32 v159, v159, v46
    v_mul_f32 v160, v160, v46
    v_mul_f32 v161, v161, v46
    v_mul_f32 v162, v162, v46
    v_mul_f32 v163, v163, v46
    v_mul_f32 v164, v164, v46
    v_mul_f32 v165, v165, v46
    v_mul_f32 v166, v166, v46
    v_mul_f32 v167, v167, v46
    v_mul_f32 v168, v168, v46
    v_mul_f32 v169, v169, v46
    v_mul_f32 v170, v170, v46
    v_mul_f32 v171, v171, v46
    v_mul_f32 v172, v172, v46
    v_mul_f32 v173, v173, v46
    v_mul_f32 v174, v174, v46
    v_mul_f32 v175, v175, v46
    v_mul_f32 v176, v176, v46
    v_mul_f32 v177, v177, v46
    v_mul_f32 v178, v178, v46
    v_mul_f32 v179, v179, v46
    v_mul_f32 v180, v180, v46
    v_mul_f32 v181, v181, v46
    v_mul_f32 v182, v182, v46
    v_mul_f32 v183, v183, v46
    v_mul_f32 v184, v184, v47
    v_mul_f32 v185, v185, v47
    v_mul_f32 v186, v186, v47
    v_mul_f32 v187, v187, v47
    v_mul_f32 v188, v188, v47
    v_mul_f32 v189, v189, v47
    v_mul_f32 v190, v190, v47
    v_mul_f32 v191, v191, v47
    v_mul_f32 v192, v192, v47
    v_mul_f32 v193, v193, v47
    v_mul_f32 v194, v194, v47
    v_mul_f32 v195, v195, v47
    v_mul_f32 v196, v196, v47
    v_mul_f32 v197, v197, v47
    v_mul_f32 v198, v198, v47
    v_mul_f32 v199, v199, v47
    v_mul_f32 v200, v200, v47
    v_mul_f32 v201, v201, v47
    v_mul_f32 v202, v202, v47
    v_mul_f32 v203, v203, v47
    v_mul_f32 v204, v204, v47
    v_mul_f32 v205, v205, v47
    v_mul_f32 v206, v206, v47
    v_mul_f32 v207, v207, v47
    v_mul_f32 v208, v208, v47
    v_mul_f32 v209, v209, v47
    v_mul_f32 v210, v210, v47
    v_mul_f32 v211, v211, v47
    v_mul_f32 v212, v212, v47
    v_mul_f32 v213, v213, v47
    v_mul_f32 v214, v214, v47
    v_mul_f32 v215, v215, v47
    v_mul_f32 v216, v216, v48
    v_mul_f32 v217, v217, v48
    v_mul_f32 v218, v218, v48
    v_mul_f32 v219, v219, v48
    v_mul_f32 v220, v220, v48
    v_mul_f32 v221, v221, v48
    v_mul_f32 v222, v222, v48
    v_mul_f32 v223, v223, v48
    v_mul_f32 v224, v224, v48
    v_mul_f32 v225, v225, v48
    v_mul_f32 v226, v226, v48
    v_mul_f32 v227, v227, v48
    v_mul_f32 v228, v228, v48
    v_mul_f32 v229, v229, v48
    v_mul_f32 v230, v230, v48
    v_mul_f32 v231, v231, v48
    v_mul_f32 v232, v232, v48
    v_mul_f32 v233, v233, v48
    v_mul_f32 v234, v234, v48
    v_mul_f32 v235, v235, v48
    v_mul_f32 v236, v236, v48
    v_mul_f32 v237, v237, v48
    v_mul_f32 v238, v238, v48
    v_mul_f32 v239, v239, v48
    v_mul_f32 v240, v240, v48
    v_mul_f32 v241, v241, v48
    v_mul_f32 v242, v242, v48
    v_mul_f32 v243, v243, v48
    v_mul_f32 v244, v244, v48
    v_mul_f32 v245, v245, v48
    v_mul_f32 v246, v246, v48
    v_mul_f32 v247, v247, v48
    s_mov_b32 s36, 0
    s_nop 3
    s_branch K1_b2_13
K1_r2_15:
    s_nop 7
    s_nop 7
    v_mul_f32 v152, v152, v46
    v_mul_f32 v153, v153, v46
    v_mul_f32 v154, v154, v46
    v_mul_f32 v155, v155, v46
    v_mul_f32 v156, v156, v46
    v_mul_f32 v157, v157, v46
    v_mul_f32 v158, v158, v46
    v_mul_f32 v159, v159, v46
    v_mul_f32 v160, v160, v46
    v_mul_f32 v161, v161, v46
    v_mul_f32 v162, v162, v46
    v_mul_f32 v163, v163, v46
    v_mul_f32 v164, v164, v46
    v_mul_f32 v165, v165, v46
    v_mul_f32 v166, v166, v46
    v_mul_f32 v167, v167, v46
    v_mul_f32 v168, v168, v46
    v_mul_f32 v169, v169, v46
    v_mul_f32 v170, v170, v46
    v_mul_f32 v171, v171, v46
    v_mul_f32 v172, v172, v46
    v_mul_f32 v173, v173, v46
    v_mul_f32 v174, v174, v46
    v_mul_f32 v175, v175, v46
    v_mul_f32 v176, v176, v46
    v_mul_f32 v177, v177, v46
    v_mul_f32 v178, v178, v46
    v_mul_f32 v179, v179, v46
    v_mul_f32 v180, v180, v46
    v_mul_f32 v181, v181, v46
    v_mul_f32 v182, v182, v46
    v_mul_f32 v183, v183, v46
    v_mul_f32 v184, v184, v47
    v_mul_f32 v185, v185, v47
    v_mul_f32 v186, v186, v47
    v_mul_f32 v187, v187, v47
    v_mul_f32 v188, v188, v47
    v_mul_f32 v189, v189, v47
    v_mul_f32 v190, v190, v47
    v_mul_f32 v191, v191, v47
    v_mul_f32 v192, v192, v47
    v_mul_f32 v193, v193, v47
    v_mul_f32 v194, v194, v47
    v_mul_f32 v195, v195, v47
    v_mul_f32 v196, v196, v47
    v_mul_f32 v197, v197, v47
    v_mul_f32 v198, v198, v47
    v_mul_f32 v199, v199, v47
    v_mul_f32 v200, v200, v47
    v_mul_f32 v201, v201, v47
    v_mul_f32 v202, v202, v47
    v_mul_f32 v203, v203, v47
    v_mul_f32 v204, v204, v47
    v_mul_f32 v205, v205, v47
    v_mul_f32 v206, v206, v47
    v_mul_f32 v207, v207, v47
    v_mul_f32 v208, v208, v47
    v_mul_f32 v209, v209, v47
    v_mul_f32 v210, v210, v47
    v_mul_f32 v211, v211, v47
    v_mul_f32 v212, v212, v47
    v_mul_f32 v213, v213, v47
    v_mul_f32 v214, v214, v47
    v_mul_f32 v215, v215, v47
    v_mul_f32 v216, v216, v48
    v_mul_f32 v217, v217, v48
    v_mul_f32 v218, v218, v48
    v_mul_f32 v219, v219, v48
    v_mul_f32 v220, v220, v48
    v_mul_f32 v221, v221, v48
    v_mul_f32 v222, v222, v48
    v_mul_f32 v223, v223, v48
    v_mul_f32 v224, v224, v48
    v_mul_f32 v225, v225, v48
    v_mul_f32 v226, v226, v48
    v_mul_f32 v227, v227, v48
    v_mul_f32 v228, v228, v48
    v_mul_f32 v229, v229, v48
    v_mul_f32 v230, v230, v48
    v_mul_f32 v231, v231, v48
    v_mul_f32 v232, v232, v48
    v_mul_f32 v233, v233, v48
    v_mul_f32 v234, v234, v48
    v_mul_f32 v235, v235, v48
    v_mul_f32 v236, v236, v48
    v_mul_f32 v237, v237, v48
    v_mul_f32 v238, v238, v48
    v_mul_f32 v239, v239, v48
    v_mul_f32 v240, v240, v48
    v_mul_f32 v241, v241, v48
    v_mul_f32 v242, v242, v48
    v_mul_f32 v243, v243, v48
    v_mul_f32 v244, v244, v48
    v_mul_f32 v245, v245, v48
    v_mul_f32 v246, v246, v48
    v_mul_f32 v247, v247, v48
    s_mov_b32 s36, 0
    s_nop 3
    s_branch K1_b2_15
K1_r2_17:
    s_nop 7
    s_nop 7
    v_mul_f32 v152, v152, v46
    v_mul_f32 v153, v153, v46
    v_mul_f32 v154, v154, v46
    v_mul_f32 v155, v155, v46
    v_mul_f32 v156, v156, v46
    v_mul_f32 v157, v157, v46
    v_mul_f32 v158, v158, v46
    v_mul_f32 v159, v159, v46
    v_mul_f32 v160, v160, v46
    v_mul_f32 v161, v161, v46
    v_mul_f32 v162, v162, v46
    v_mul_f32 v163, v163, v46
    v_mul_f32 v164, v164, v46
    v_mul_f32 v165, v165, v46
    v_mul_f32 v166, v166, v46
    v_mul_f32 v167, v167, v46
    v_mul_f32 v168, v168, v46
    v_mul_f32 v169, v169, v46
    v_mul_f32 v170, v170, v46
    v_mul_f32 v171, v171, v46
    v_mul_f32 v172, v172, v46
    v_mul_f32 v173, v173, v46
    v_mul_f32 v174, v174, v46
    v_mul_f32 v175, v175, v46
    v_mul_f32 v176, v176, v46
    v_mul_f32 v177, v177, v46
    v_mul_f32 v178, v178, v46
    v_mul_f32 v179, v179, v46
    v_mul_f32 v180, v180, v46
    v_mul_f32 v181, v181, v46
    v_mul_f32 v182, v182, v46
    v_mul_f32 v183, v183, v46
    v_mul_f32 v184, v184, v47
    v_mul_f32 v185, v185, v47
    v_mul_f32 v186, v186, v47
    v_mul_f32 v187, v187, v47
    v_mul_f32 v188, v188, v47
    v_mul_f32 v189, v189, v47
    v_mul_f32 v190, v190, v47
    v_mul_f32 v191, v191, v47
    v_mul_f32 v192, v192, v47
    v_mul_f32 v193, v193, v47
    v_mul_f32 v194, v194, v47
    v_mul_f32 v195, v195, v47
    v_mul_f32 v196, v196, v47
    v_mul_f32 v197, v197, v47
    v_mul_f32 v198, v198, v47
    v_mul_f32 v199, v199, v47
    v_mul_f32 v200, v200, v47
    v_mul_f32 v201, v201, v47
    v_mul_f32 v202, v202, v47
    v_mul_f32 v203, v203, v47
    v_mul_f32 v204, v204, v47
    v_mul_f32 v205, v205, v47
    v_mul_f32 v206, v206, v47
    v_mul_f32 v207, v207, v47
    v_mul_f32 v208, v208, v47
    v_mul_f32 v209, v209, v47
    v_mul_f32 v210, v210, v47
    v_mul_f32 v211, v211, v47
    v_mul_f32 v212, v212, v47
    v_mul_f32 v213, v213, v47
    v_mul_f32 v214, v214, v47
    v_mul_f32 v215, v215, v47
    v_mul_f32 v216, v216, v48
    v_mul_f32 v217, v217, v48
    v_mul_f32 v218, v218, v48
    v_mul_f32 v219, v219, v48
    v_mul_f32 v220, v220, v48
    v_mul_f32 v221, v221, v48
    v_mul_f32 v222, v222, v48
    v_mul_f32 v223, v223, v48
    v_mul_f32 v224, v224, v48
    v_mul_f32 v225, v225, v48
    v_mul_f32 v226, v226, v48
    v_mul_f32 v227, v227, v48
    v_mul_f32 v228, v228, v48
    v_mul_f32 v229, v229, v48
    v_mul_f32 v230, v230, v48
    v_mul_f32 v231, v231, v48
    v_mul_f32 v232, v232, v48
    v_mul_f32 v233, v233, v48
    v_mul_f32 v234, v234, v48
    v_mul_f32 v235, v235, v48
    v_mul_f32 v236, v236, v48
    v_mul_f32 v237, v237, v48
    v_mul_f32 v238, v238, v48
    v_mul_f32 v239, v239, v48
    v_mul_f32 v240, v240, v48
    v_mul_f32 v241, v241, v48
    v_mul_f32 v242, v242, v48
    v_mul_f32 v243, v243, v48
    v_mul_f32 v244, v244, v48
    v_mul_f32 v245, v245, v48
    v_mul_f32 v246, v246, v48
    v_mul_f32 v247, v247, v48
    s_mov_b32 s36, 0
    s_nop 3
    s_branch K1_b2_17
K1_r2_19:
    s_nop 7
    s_nop 7
    v_mul_f32 v152, v152, v46
    v_mul_f32 v153, v153, v46
    v_mul_f32 v154, v154, v46
    v_mul_f32 v155, v155, v46
    v_mul_f32 v156, v156, v46
    v_mul_f32 v157, v157, v46
    v_mul_f32 v158, v158, v46
    v_mul_f32 v159, v159, v46
    v_mul_f32 v160, v160, v46
    v_mul_f32 v161, v161, v46
    v_mul_f32 v162, v162, v46
    v_mul_f32 v163, v163, v46
    v_mul_f32 v164, v164, v46
    v_mul_f32 v165, v165, v46
    v_mul_f32 v166, v166, v46
    v_mul_f32 v167, v167, v46
    v_mul_f32 v168, v168, v46
    v_mul_f32 v169, v169, v46
    v_mul_f32 v170, v170, v46
    v_mul_f32 v171, v171, v46
    v_mul_f32 v172, v172, v46
    v_mul_f32 v173, v173, v46
    v_mul_f32 v174, v174, v46
    v_mul_f32 v175, v175, v46
    v_mul_f32 v176, v176, v46
    v_mul_f32 v177, v177, v46
    v_mul_f32 v178, v178, v46
    v_mul_f32 v179, v179, v46
    v_mul_f32 v180, v180, v46
    v_mul_f32 v181, v181, v46
    v_mul_f32 v182, v182, v46
    v_mul_f32 v183, v183, v46
    v_mul_f32 v184, v184, v47
    v_mul_f32 v185, v185, v47
    v_mul_f32 v186, v186, v47
    v_mul_f32 v187, v187, v47
    v_mul_f32 v188, v188, v47
    v_mul_f32 v189, v189, v47
    v_mul_f32 v190, v190, v47
    v_mul_f32 v191, v191, v47
    v_mul_f32 v192, v192, v47
    v_mul_f32 v193, v193, v47
    v_mul_f32 v194, v194, v47
    v_mul_f32 v195, v195, v47
    v_mul_f32 v196, v196, v47
    v_mul_f32 v197, v197, v47
    v_mul_f32 v198, v198, v47
    v_mul_f32 v199, v199, v47
    v_mul_f32 v200, v200, v47
    v_mul_f32 v201, v201, v47
    v_mul_f32 v202, v202, v47
    v_mul_f32 v203, v203, v47
    v_mul_f32 v204, v204, v47
    v_mul_f32 v205, v205, v47
    v_mul_f32 v206, v206, v47
    v_mul_f32 v207, v207, v47
    v_mul_f32 v208, v208, v47
    v_mul_f32 v209, v209, v47
    v_mul_f32 v210, v210, v47
    v_mul_f32 v211, v211, v47
    v_mul_f32 v212, v212, v47
    v_mul_f32 v213, v213, v47
    v_mul_f32 v214, v214, v47
    v_mul_f32 v215, v215, v47
    v_mul_f32 v216, v216, v48
    v_mul_f32 v217, v217, v48
    v_mul_f32 v218, v218, v48
    v_mul_f32 v219, v219, v48
    v_mul_f32 v220, v220, v48
    v_mul_f32 v221, v221, v48
    v_mul_f32 v222, v222, v48
    v_mul_f32 v223, v223, v48
    v_mul_f32 v224, v224, v48
    v_mul_f32 v225, v225, v48
    v_mul_f32 v226, v226, v48
    v_mul_f32 v227, v227, v48
    v_mul_f32 v228, v228, v48
    v_mul_f32 v229, v229, v48
    v_mul_f32 v230, v230, v48
    v_mul_f32 v231, v231, v48
    v_mul_f32 v232, v232, v48
    v_mul_f32 v233, v233, v48
    v_mul_f32 v234, v234, v48
    v_mul_f32 v235, v235, v48
    v_mul_f32 v236, v236, v48
    v_mul_f32 v237, v237, v48
    v_mul_f32 v238, v238, v48
    v_mul_f32 v239, v239, v48
    v_mul_f32 v240, v240, v48
    v_mul_f32 v241, v241, v48
    v_mul_f32 v242, v242, v48
    v_mul_f32 v243, v243, v48
    v_mul_f32 v244, v244, v48
    v_mul_f32 v245, v245, v48
    v_mul_f32 v246, v246, v48
    v_mul_f32 v247, v247, v48
    s_mov_b32 s36, 0
    s_nop 3
    s_branch K1_b2_19
K1_r2_21:
    s_nop 7
    s_nop 7
    v_mul_f32 v152, v152, v46
    v_mul_f32 v153, v153, v46
    v_mul_f32 v154, v154, v46
    v_mul_f32 v155, v155, v46
    v_mul_f32 v156, v156, v46
    v_mul_f32 v157, v157, v46
    v_mul_f32 v158, v158, v46
    v_mul_f32 v159, v159, v46
    v_mul_f32 v160, v160, v46
    v_mul_f32 v161, v161, v46
    v_mul_f32 v162, v162, v46
    v_mul_f32 v163, v163, v46
    v_mul_f32 v164, v164, v46
    v_mul_f32 v165, v165, v46
    v_mul_f32 v166, v166, v46
    v_mul_f32 v167, v167, v46
    v_mul_f32 v168, v168, v46
    v_mul_f32 v169, v169, v46
    v_mul_f32 v170, v170, v46
    v_mul_f32 v171, v171, v46
    v_mul_f32 v172, v172, v46
    v_mul_f32 v173, v173, v46
    v_mul_f32 v174, v174, v46
    v_mul_f32 v175, v175, v46
    v_mul_f32 v176, v176, v46
    v_mul_f32 v177, v177, v46
    v_mul_f32 v178, v178, v46
    v_mul_f32 v179, v179, v46
    v_mul_f32 v180, v180, v46
    v_mul_f32 v181, v181, v46
    v_mul_f32 v182, v182, v46
    v_mul_f32 v183, v183, v46
    v_mul_f32 v184, v184, v47
    v_mul_f32 v185, v185, v47
    v_mul_f32 v186, v186, v47
    v_mul_f32 v187, v187, v47
    v_mul_f32 v188, v188, v47
    v_mul_f32 v189, v189, v47
    v_mul_f32 v190, v190, v47
    v_mul_f32 v191, v191, v47
    v_mul_f32 v192, v192, v47
    v_mul_f32 v193, v193, v47
    v_mul_f32 v194, v194, v47
    v_mul_f32 v195, v195, v47
    v_mul_f32 v196, v196, v47
    v_mul_f32 v197, v197, v47
    v_mul_f32 v198, v198, v47
    v_mul_f32 v199, v199, v47
    v_mul_f32 v200, v200, v47
    v_mul_f32 v201, v201, v47
    v_mul_f32 v202, v202, v47
    v_mul_f32 v203, v203, v47
    v_mul_f32 v204, v204, v47
    v_mul_f32 v205, v205, v47
    v_mul_f32 v206, v206, v47
    v_mul_f32 v207, v207, v47
    v_mul_f32 v208, v208, v47
    v_mul_f32 v209, v209, v47
    v_mul_f32 v210, v210, v47
    v_mul_f32 v211, v211, v47
    v_mul_f32 v212, v212, v47
    v_mul_f32 v213, v213, v47
    v_mul_f32 v214, v214, v47
    v_mul_f32 v215, v215, v47
    v_mul_f32 v216, v216, v48
    v_mul_f32 v217, v217, v48
    v_mul_f32 v218, v218, v48
    v_mul_f32 v219, v219, v48
    v_mul_f32 v220, v220, v48
    v_mul_f32 v221, v221, v48
    v_mul_f32 v222, v222, v48
    v_mul_f32 v223, v223, v48
    v_mul_f32 v224, v224, v48
    v_mul_f32 v225, v225, v48
    v_mul_f32 v226, v226, v48
    v_mul_f32 v227, v227, v48
    v_mul_f32 v228, v228, v48
    v_mul_f32 v229, v229, v48
    v_mul_f32 v230, v230, v48
    v_mul_f32 v231, v231, v48
    v_mul_f32 v232, v232, v48
    v_mul_f32 v233, v233, v48
    v_mul_f32 v234, v234, v48
    v_mul_f32 v235, v235, v48
    v_mul_f32 v236, v236, v48
    v_mul_f32 v237, v237, v48
    v_mul_f32 v238, v238, v48
    v_mul_f32 v239, v239, v48
    v_mul_f32 v240, v240, v48
    v_mul_f32 v241, v241, v48
    v_mul_f32 v242, v242, v48
    v_mul_f32 v243, v243, v48
    v_mul_f32 v244, v244, v48
    v_mul_f32 v245, v245, v48
    v_mul_f32 v246, v246, v48
    v_mul_f32 v247, v247, v48
    s_mov_b32 s36, 0
    s_nop 3
    s_branch K1_b2_21
.globl oproj_kernel
.p2align 8
.type oproj_kernel,@function
oproj_kernel:
    s_cmp_ge_u32 s2, 256
    s_cbranch_scc1 K2_done
    s_and_b32 s4, s2, 7
    s_lshr_b32 s5, s2, 3
    s_lshr_b32 s6, s4, 2
    s_and_b32 s4, s4, 3
    s_and_b32 s7, s5, 3
    s_lshr_b32 s5, s5, 2
    s_mul_i32 s40, s6, 40
    s_add_u32 s40, s40, 32
    s_load_dwordx2 s[44:45], s[0:1], s40
    s_load_dwordx2 s[48:49], s[0:1], 96
    v_lshrrev_b32 v8, 6, v0
    v_and_b32 v9, 63, v0
    s_nop 0
    v_readfirstlane_b32 s3, v8
    v_and_b32 v10, 15, v9
    v_lshrrev_b32 v11, 4, v9
    v_and_b32 v12, 3, v9
    v_bfe_u32 v13, v9, 2, 2
    s_mov_b32 s40, 1056
    s_and_b32 s41, s3, 3
    s_lshr_b32 s42, s3, 2
    v_and_b32 v14, 1, v11
    v_lshl_add_u32 v14, v14, 2, v13
    v_mul_lo_u32 v14, v14, s40
    v_lshrrev_b32 v15, 1, v11
    v_lshl_add_u32 v14, v15, 7, v14
    v_lshl_add_u32 v14, v12, 3, v14
    s_mul_i32 s43, s42, 8448
    s_add_u32 s43, s43, 24576
    s_add_u32 s50, s43, 0
    v_add_u32 v4, s50, v14
    s_add_u32 s50, s43, 41472
    v_add_u32 v5, s50, v14
    s_add_u32 s50, s43, 82944
    v_add_u32 v6, s50, v14
    v_lshlrev_b32 v3, 4, v9
    s_mul_i32 s50, s41, 6144
    s_add_u32 s51, s50, 0
    v_add_u32 v24, s51, v3
    s_add_u32 s51, s50, 41472
    v_add_u32 v25, s51, v3
    s_add_u32 s51, s50, 82944
    v_add_u32 v26, s51, v3
    v_lshrrev_b32 v14, 3, v9
    v_lshlrev_b32 v2, 13, v14
    v_and_b32 v14, 7, v9
    v_lshl_add_u32 v2, v14, 4, v2
    s_lshl_b32 s50, s41, 11
    s_lshl_b32 s51, s42, 7
    s_add_u32 s50, s50, s51
    v_add_u32 v2, s50, v2
    s_mul_i32 s50, s41, 2112
    s_add_u32 s34, s43, s50
    s_mul_i32 s35, s3, 3072
    s_mul_i32 s50, s6, 96
    s_mul_i32 s51, s5, 12
    s_add_u32 s50, s50, s51
    s_mul_i32 s51, s3, 3
    s_add_u32 s51, s51, 0
    s_lshr_b32 s52, s51, 1
    s_add_u32 s52, s52, s50
    s_lshl_b32 s52, s52, 7
    s_and_b32 s51, s51, 1
    s_add_u32 s52, s52, s51
    s_lshl_b32 s51, s4, 5
    s_add_u32 s52, s52, s51
    s_lshl_b32 s28, s52, 10
    s_mul_i32 s51, s3, 3
    s_add_u32 s51, s51, 1
    s_lshr_b32 s52, s51, 1
    s_add_u32 s52, s52, s50
    s_lshl_b32 s52, s52, 7
    s_and_b32 s51, s51, 1
    s_add_u32 s52, s52, s51
    s_lshl_b32 s51, s4, 5
    s_add_u32 s52, s52, s51
    s_lshl_b32 s29, s52, 10
    s_mul_i32 s51, s3, 3
    s_add_u32 s51, s51, 2
    s_lshr_b32 s52, s51, 1
    s_add_u32 s52, s52, s50
    s_lshl_b32 s52, s52, 7
    s_and_b32 s51, s51, 1
    s_add_u32 s52, s52, s51
    s_lshl_b32 s51, s4, 5
    s_add_u32 s52, s52, s51
    s_lshl_b32 s31, s52, 10
    s_lshl_b32 s32, s4, 20
    s_lshl_b32 s51, s7, 8
    s_add_u32 s32, s32, s51
    s_lshl_b32 s50, s6, 3
    s_add_u32 s50, s50, s5
    s_lshl_b32 s50, s50, 2
    s_add_u32 s50, s50, s7
    s_mul_i32 s50, s50, 196608
    s_mul_i32 s51, s4, 49152
    s_add_u32 s50, s50, s51
    s_mul_i32 s51, s3, 6144
    s_add_u32 s33, s50, s51
    s_waitcnt lgkmcnt(0)
    s_mov_b32 s8, s48
    s_and_b32 s9, s49, 0xffff
    s_mov_b32 s10, 25165824
    s_mov_b32 s11, 0x00020000
    s_mov_b32 s12, s44
    s_and_b32 s13, s45, 0xffff
    s_mov_b32 s14, 4194304
    s_mov_b32 s15, 0x00020000
    s_add_u32 s48, s48, 33554432
    s_addc_u32 s49, s49, 0
    s_mov_b32 s16, s48
    s_and_b32 s17, s49, 0xffff
    s_mov_b32 s18, 25165824
    s_mov_b32 s19, 0x00020000
    s_add_u32 m0, s35, 0
    s_add_u32 s52, s28, 0
    buffer_load_dwordx4 v3, s[8:11], s52 offen lds
    s_add_u32 m0, s35, 1024
    s_add_u32 s52, s29, 0
    buffer_load_dwordx4 v3, s[8:11], s52 offen lds
    s_add_u32 m0, s35, 2048
    s_add_u32 s52, s31, 0
    buffer_load_dwordx4 v3, s[8:11], s52 offen lds
    s_add_u32 s52, s32, 0
    s_add_u32 m0, s34, 0
    s_nop 0
    buffer_load_dwordx4 v2, s[12:15], s52 offen offset:0 lds
    s_add_u32 s52, s32, 0
    s_add_u32 m0, s34, 32
    s_nop 0
    buffer_load_dwordx4 v2, s[12:15], s52 offen offset:1024 lds
    s_add_u32 m0, s35, 41472
    s_add_u32 s52, s28, 2048
    buffer_load_dwordx4 v3, s[8:11], s52 offen lds
    s_add_u32 m0, s35, 42496
    s_add_u32 s52, s29, 2048
    buffer_load_dwordx4 v3, s[8:11], s52 offen lds
    s_add_u32 m0, s35, 43520
    s_add_u32 s52, s31, 2048
    buffer_load_dwordx4 v3, s[8:11], s52 offen lds
    s_add_u32 s52, s32, 65536
    s_add_u32 m0, s34, 41472
    s_nop 0
    buffer_load_dwordx4 v2, s[12:15], s52 offen offset:0 lds
    s_add_u32 s52, s32, 65536
    s_add_u32 m0, s34, 41504
    s_nop 0
    buffer_load_dwordx4 v2, s[12:15], s52 offen offset:1024 lds
    s_add_u32 m0, s35, 82944
    s_add_u32 s52, s28, 4096
    buffer_load_dwordx4 v3, s[8:11], s52 offen lds
    s_add_u32 m0, s35, 83968
    s_add_u32 s52, s29, 4096
    buffer_load_dwordx4 v3, s[8:11], s52 offen lds
    s_add_u32 m0, s35, 84992
    s_add_u32 s52, s31, 4096
    buffer_load_dwordx4 v3, s[8:11], s52 offen lds
    s_add_u32 s52, s32, 131072
    s_add_u32 m0, s34, 82944
    s_nop 0
    buffer_load_dwordx4 v2, s[12:15], s52 offen offset:0 lds
    s_add_u32 s52, s32, 131072
    s_add_u32 m0, s34, 82976
    s_nop 0
    buffer_load_dwordx4 v2, s[12:15], s52 offen offset:1024 lds
    s_waitcnt vmcnt(10)
    s_barrier
    ds_read_b64_tr_b16 v[124:125], v4 offset:0
    ds_read_b64_tr_b16 v[126:127], v4 offset:256
    ds_read_b128 v[76:79], v24 offset:0
    ds_read_b128 v[84:87], v24 offset:2048
    ds_read_b128 v[92:95], v24 offset:4096
    ds_read_b64_tr_b16 v[128:129], v4 offset:32
    ds_read_b64_tr_b16 v[130:131], v4 offset:288
    ds_read_b64_tr_b16 v[132:133], v4 offset:64
    ds_read_b64_tr_b16 v[134:135], v4 offset:320
    ds_read_b64_tr_b16 v[136:137], v4 offset:96
    ds_read_b64_tr_b16 v[138:139], v4 offset:352
    ds_read_b128 v[80:83], v24 offset:1024
    ds_read_b128 v[88:91], v24 offset:3072
    ds_read_b128 v[96:99], v24 offset:5120
    ds_read_b64_tr_b16 v[140:141], v4 offset:512
    ds_read_b64_tr_b16 v[142:143], v4 offset:768
    s_waitcnt lgkmcnt(11)
    v_mfma_f32_16x16x32_bf16 v[28:31], v[124:127], v[76:79], 0
    v_mfma_f32_16x16x32_bf16 v[44:47], v[124:127], v[84:87], 0
    v_mfma_f32_16x16x32_bf16 v[60:63], v[124:127], v[92:95], 0
    ds_read_b64_tr_b16 v[124:125], v4 offset:544
    ds_read_b64_tr_b16 v[126:127], v4 offset:800
    s_waitcnt lgkmcnt(11)
    v_mfma_f32_16x16x32_bf16 v[32:35], v[128:131], v[76:79], 0
    v_mfma_f32_16x16x32_bf16 v[48:51], v[128:131], v[84:87], 0
    v_mfma_f32_16x16x32_bf16 v[64:67], v[128:131], v[92:95], 0
    ds_read_b64_tr_b16 v[128:129], v4 offset:576
    ds_read_b64_tr_b16 v[130:131], v4 offset:832
    s_waitcnt lgkmcnt(11)
    v_mfma_f32_16x16x32_bf16 v[36:39], v[132:135], v[76:79], 0
    v_mfma_f32_16x16x32_bf16 v[52:55], v[132:135], v[84:87], 0
    v_mfma_f32_16x16x32_bf16 v[68:71], v[132:135], v[92:95], 0
    ds_read_b64_tr_b16 v[132:133], v4 offset:608
    ds_read_b64_tr_b16 v[134:135], v4 offset:864
    s_waitcnt lgkmcnt(11)
    v_mfma_f32_16x16x32_bf16 v[40:43], v[136:139], v[76:79], 0
    v_mfma_f32_16x16x32_bf16 v[56:59], v[136:139], v[84:87], 0
    v_mfma_f32_16x16x32_bf16 v[72:75], v[136:139], v[92:95], 0
    s_waitcnt vmcnt(5) lgkmcnt(0)
    s_barrier
    ds_read_b64_tr_b16 v[136:137], v5 offset:0
    ds_read_b64_tr_b16 v[138:139], v5 offset:256
    v_mfma_f32_16x16x32_bf16 v[28:31], v[140:143], v[80:83], v[28:31]
    v_mfma_f32_16x16x32_bf16 v[44:47], v[140:143], v[88:91], v[44:47]
    s_add_u32 m0, s35, 0
    s_add_u32 s52, s28, 6144
    buffer_load_dwordx4 v3, s[8:11], s52 offen lds
    v_mfma_f32_16x16x32_bf16 v[60:63], v[140:143], v[96:99], v[60:63]
    ds_read_b64_tr_b16 v[140:141], v5 offset:32
    ds_read_b64_tr_b16 v[142:143], v5 offset:288
    ds_read_b128 v[100:103], v25 offset:0
    ds_read_b128 v[108:111], v25 offset:2048
    ds_read_b128 v[116:119], v25 offset:4096
    v_mfma_f32_16x16x32_bf16 v[32:35], v[124:127], v[80:83], v[32:35]
    v_mfma_f32_16x16x32_bf16 v[48:51], v[124:127], v[88:91], v[48:51]
    s_add_u32 m0, s35, 1024
    s_add_u32 s52, s29, 6144
    buffer_load_dwordx4 v3, s[8:11], s52 offen lds
    v_mfma_f32_16x16x32_bf16 v[64:67], v[124:127], v[96:99], v[64:67]
    ds_read_b64_tr_b16 v[124:125], v5 offset:64
    ds_read_b64_tr_b16 v[126:127], v5 offset:320
    v_mfma_f32_16x16x32_bf16 v[36:39], v[128:131], v[80:83], v[36:39]
    v_mfma_f32_16x16x32_bf16 v[52:55], v[128:131], v[88:91], v[52:55]
    s_add_u32 m0, s35, 2048
    s_add_u32 s52, s31, 6144
    buffer_load_dwordx4 v3, s[8:11], s52 offen lds
    v_mfma_f32_16x16x32_bf16 v[68:71], v[128:131], v[96:99], v[68:71]
    ds_read_b64_tr_b16 v[128:129], v5 offset:96
    ds_read_b64_tr_b16 v[130:131], v5 offset:352
    ds_read_b128 v[104:107], v25 offset:1024
    ds_read_b128 v[112:115], v25 offset:3072
    ds_read_b128 v[120:123], v25 offset:5120
    v_mfma_f32_16x16x32_bf16 v[40:43], v[132:135], v[80:83], v[40:43]
    v_mfma_f32_16x16x32_bf16 v[56:59], v[132:135], v[88:91], v[56:59]
    s_add_u32 s52, s32, 196608
    s_add_u32 m0, s34, 0
    s_nop 0
    buffer_load_dwordx4 v2, s[12:15], s52 offen offset:0 lds
    v_mfma_f32_16x16x32_bf16 v[72:75], v[132:135], v[96:99], v[72:75]
    ds_read_b64_tr_b16 v[132:133], v5 offset:512
    ds_read_b64_tr_b16 v[134:135], v5 offset:768
    s_waitcnt lgkmcnt(9)
    v_mfma_f32_16x16x32_bf16 v[28:31], v[136:139], v[100:103], v[28:31]
    v_mfma_f32_16x16x32_bf16 v[44:47], v[136:139], v[108:111], v[44:47]
    s_add_u32 s52, s32, 196608
    s_add_u32 m0, s34, 32
    s_nop 0
    buffer_load_dwordx4 v2, s[12:15], s52 offen offset:1024 lds
    v_mfma_f32_16x16x32_bf16 v[60:63], v[136:139], v[116:119], v[60:63]
    ds_read_b64_tr_b16 v[136:137], v5 offset:544
    ds_read_b64_tr_b16 v[138:139], v5 offset:800
    v_mfma_f32_16x16x32_bf16 v[32:35], v[140:143], v[100:103], v[32:35]
    v_mfma_f32_16x16x32_bf16 v[48:51], v[140:143], v[108:111], v[48:51]
    v_mfma_f32_16x16x32_bf16 v[64:67], v[140:143], v[116:119], v[64:67]
    ds_read_b64_tr_b16 v[140:141], v5 offset:576
    ds_read_b64_tr_b16 v[142:143], v5 offset:832
    s_waitcnt lgkmcnt(11)
    v_mfma_f32_16x16x32_bf16 v[36:39], v[124:127], v[100:103], v[36:39]
    v_mfma_f32_16x16x32_bf16 v[52:55], v[124:127], v[108:111], v[52:55]
    v_mfma_f32_16x16x32_bf16 v[68:71], v[124:127], v[116:119], v[68:71]
    ds_read_b64_tr_b16 v[124:125], v5 offset:608
    ds_read_b64_tr_b16 v[126:127], v5 offset:864
    s_waitcnt lgkmcnt(11)
    v_mfma_f32_16x16x32_bf16 v[40:43], v[128:131], v[100:103], v[40:43]
    v_mfma_f32_16x16x32_bf16 v[56:59], v[128:131], v[108:111], v[56:59]
    v_mfma_f32_16x16x32_bf16 v[72:75], v[128:131], v[116:119], v[72:75]
    s_waitcnt vmcnt(5) lgkmcnt(0)
    s_barrier
    ds_read_b64_tr_b16 v[128:129], v6 offset:0
    ds_read_b64_tr_b16 v[130:131], v6 offset:256
    v_mfma_f32_16x16x32_bf16 v[28:31], v[132:135], v[104:107], v[28:31]
    v_mfma_f32_16x16x32_bf16 v[44:47], v[132:135], v[112:115], v[44:47]
    s_add_u32 m0, s35, 41472
    s_add_u32 s52, s28, 8192
    buffer_load_dwordx4 v3, s[8:11], s52 offen lds
    v_mfma_f32_16x16x32_bf16 v[60:63], v[132:135], v[120:123], v[60:63]
    ds_read_b64_tr_b16 v[132:133], v6 offset:32
    ds_read_b64_tr_b16 v[134:135], v6 offset:288
    ds_read_b128 v[76:79], v26 offset:0
    ds_read_b128 v[84:87], v26 offset:2048
    ds_read_b128 v[92:95], v26 offset:4096
    v_mfma_f32_16x16x32_bf16 v[32:35], v[136:139], v[104:107], v[32:35]
    v_mfma_f32_16x16x32_bf16 v[48:51], v[136:139], v[112:115], v[48:51]
    s_add_u32 m0, s35, 42496
    s_add_u32 s52, s29, 8192
    buffer_load_dwordx4 v3, s[8:11], s52 offen lds
    v_mfma_f32_16x16x32_bf16 v[64:67], v[136:139], v[120:123], v[64:67]
    ds_read_b64_tr_b16 v[136:137], v6 offset:64
    ds_read_b64_tr_b16 v[138:139], v6 offset:320
    v_mfma_f32_16x16x32_bf16 v[36:39], v[140:143], v[104:107], v[36:39]
    v_mfma_f32_16x16x32_bf16 v[52:55], v[140:143], v[112:115], v[52:55]
    s_add_u32 m0, s35, 43520
    s_add_u32 s52, s31, 8192
    buffer_load_dwordx4 v3, s[8:11], s52 offen lds
    v_mfma_f32_16x16x32_bf16 v[68:71], v[140:143], v[120:123], v[68:71]
    ds_read_b64_tr_b16 v[140:141], v6 offset:96
    ds_read_b64_tr_b16 v[142:143], v6 offset:352
    ds_read_b128 v[80:83], v26 offset:1024
    ds_read_b128 v[88:91], v26 offset:3072
    ds_read_b128 v[96:99], v26 offset:5120
    v_mfma_f32_16x16x32_bf16 v[40:43], v[124:127], v[104:107], v[40:43]
    v_mfma_f32_16x16x32_bf16 v[56:59], v[124:127], v[112:115], v[56:59]
    s_add_u32 s52, s32, 262144
    s_add_u32 m0, s34, 41472
    s_nop 0
    buffer_load_dwordx4 v2, s[12:15], s52 offen offset:0 lds
    v_mfma_f32_16x16x32_bf16 v[72:75], v[124:127], v[120:123], v[72:75]
    ds_read_b64_tr_b16 v[124:125], v6 offset:512
    ds_read_b64_tr_b16 v[126:127], v6 offset:768
    s_waitcnt lgkmcnt(9)
    v_mfma_f32_16x16x32_bf16 v[28:31], v[128:131], v[76:79], v[28:31]
    v_mfma_f32_16x16x32_bf16 v[44:47], v[128:131], v[84:87], v[44:47]
    s_add_u32 s52, s32, 262144
    s_add_u32 m0, s34, 41504
    s_nop 0
    buffer_load_dwordx4 v2, s[12:15], s52 offen offset:1024 lds
    v_mfma_f32_16x16x32_bf16 v[60:63], v[128:131], v[92:95], v[60:63]
    ds_read_b64_tr_b16 v[128:129], v6 offset:544
    ds_read_b64_tr_b16 v[130:131], v6 offset:800
    v_mfma_f32_16x16x32_bf16 v[32:35], v[132:135], v[76:79], v[32:35]
    v_mfma_f32_16x16x32_bf16 v[48:51], v[132:135], v[84:87], v[48:51]
    v_mfma_f32_16x16x32_bf16 v[64:67], v[132:135], v[92:95], v[64:67]
    ds_read_b64_tr_b16 v[132:133], v6 offset:576
    ds_read_b64_tr_b16 v[134:135], v6 offset:832
    s_waitcnt lgkmcnt(11)
    v_mfma_f32_16x16x32_bf16 v[36:39], v[136:139], v[76:79], v[36:39]
    v_mfma_f32_16x16x32_bf16 v[52:55], v[136:139], v[84:87], v[52:55]
    v_mfma_f32_16x16x32_bf16 v[68:71], v[136:139], v[92:95], v[68:71]
    ds_read_b64_tr_b16 v[136:137], v6 offset:608
    ds_read_b64_tr_b16 v[138:139], v6 offset:864
    s_waitcnt lgkmcnt(11)
    v_mfma_f32_16x16x32_bf16 v[40:43], v[140:143], v[76:79], v[40:43]
    v_mfma_f32_16x16x32_bf16 v[56:59], v[140:143], v[84:87], v[56:59]
    v_mfma_f32_16x16x32_bf16 v[72:75], v[140:143], v[92:95], v[72:75]
    s_waitcnt vmcnt(5) lgkmcnt(0)
    s_barrier
    ds_read_b64_tr_b16 v[140:141], v4 offset:0
    ds_read_b64_tr_b16 v[142:143], v4 offset:256
    v_mfma_f32_16x16x32_bf16 v[28:31], v[124:127], v[80:83], v[28:31]
    v_mfma_f32_16x16x32_bf16 v[44:47], v[124:127], v[88:91], v[44:47]
    s_add_u32 m0, s35, 82944
    s_add_u32 s52, s28, 10240
    buffer_load_dwordx4 v3, s[8:11], s52 offen lds
    v_mfma_f32_16x16x32_bf16 v[60:63], v[124:127], v[96:99], v[60:63]
    ds_read_b64_tr_b16 v[124:125], v4 offset:32
    ds_read_b64_tr_b16 v[126:127], v4 offset:288
    ds_read_b128 v[100:103], v24 offset:0
    ds_read_b128 v[108:111], v24 offset:2048
    ds_read_b128 v[116:119], v24 offset:4096
    v_mfma_f32_16x16x32_bf16 v[32:35], v[128:131], v[80:83], v[32:35]
    v_mfma_f32_16x16x32_bf16 v[48:51], v[128:131], v[88:91], v[48:51]
    s_add_u32 m0, s35, 83968
    s_add_u32 s52, s29, 10240
    buffer_load_dwordx4 v3, s[8:11], s52 offen lds
    v_mfma_f32_16x16x32_bf16 v[64:67], v[128:131], v[96:99], v[64:67]
    ds_read_b64_tr_b16 v[128:129], v4 offset:64
    ds_read_b64_tr_b16 v[130:131], v4 offset:320
    v_mfma_f32_16x16x32_bf16 v[36:39], v[132:135], v[80:83], v[36:39]
    v_mfma_f32_16x16x32_bf16 v[52:55], v[132:135], v[88:91], v[52:55]
    s_add_u32 m0, s35, 84992
    s_add_u32 s52, s31, 10240
    buffer_load_dwordx4 v3, s[8:11], s52 offen lds
    v_mfma_f32_16x16x32_bf16 v[68:71], v[132:135], v[96:99], v[68:71]
    ds_read_b64_tr_b16 v[132:133], v4 offset:96
    ds_read_b64_tr_b16 v[134:135], v4 offset:352
    ds_read_b128 v[104:107], v24 offset:1024
    ds_read_b128 v[112:115], v24 offset:3072
    ds_read_b128 v[120:123], v24 offset:5120
    v_mfma_f32_16x16x32_bf16 v[40:43], v[136:139], v[80:83], v[40:43]
    v_mfma_f32_16x16x32_bf16 v[56:59], v[136:139], v[88:91], v[56:59]
    s_add_u32 s52, s32, 327680
    s_add_u32 m0, s34, 82944
    s_nop 0
    buffer_load_dwordx4 v2, s[12:15], s52 offen offset:0 lds
    v_mfma_f32_16x16x32_bf16 v[72:75], v[136:139], v[96:99], v[72:75]
    ds_read_b64_tr_b16 v[136:137], v4 offset:512
    ds_read_b64_tr_b16 v[138:139], v4 offset:768
    s_waitcnt lgkmcnt(9)
    v_mfma_f32_16x16x32_bf16 v[28:31], v[140:143], v[100:103], v[28:31]
    v_mfma_f32_16x16x32_bf16 v[44:47], v[140:143], v[108:111], v[44:47]
    s_add_u32 s52, s32, 327680
    s_add_u32 m0, s34, 82976
    s_nop 0
    buffer_load_dwordx4 v2, s[12:15], s52 offen offset:1024 lds
    v_mfma_f32_16x16x32_bf16 v[60:63], v[140:143], v[116:119], v[60:63]
    ds_read_b64_tr_b16 v[140:141], v4 offset:544
    ds_read_b64_tr_b16 v[142:143], v4 offset:800
    v_mfma_f32_16x16x32_bf16 v[32:35], v[124:127], v[100:103], v[32:35]
    v_mfma_f32_16x16x32_bf16 v[48:51], v[124:127], v[108:111], v[48:51]
    v_mfma_f32_16x16x32_bf16 v[64:67], v[124:127], v[116:119], v[64:67]
    ds_read_b64_tr_b16 v[124:125], v4 offset:576
    ds_read_b64_tr_b16 v[126:127], v4 offset:832
    s_waitcnt lgkmcnt(11)
    v_mfma_f32_16x16x32_bf16 v[36:39], v[128:131], v[100:103], v[36:39]
    v_mfma_f32_16x16x32_bf16 v[52:55], v[128:131], v[108:111], v[52:55]
    v_mfma_f32_16x16x32_bf16 v[68:71], v[128:131], v[116:119], v[68:71]
    ds_read_b64_tr_b16 v[128:129], v4 offset:608
    ds_read_b64_tr_b16 v[130:131], v4 offset:864
    s_waitcnt lgkmcnt(11)
    v_mfma_f32_16x16x32_bf16 v[40:43], v[132:135], v[100:103], v[40:43]
    v_mfma_f32_16x16x32_bf16 v[56:59], v[132:135], v[108:111], v[56:59]
    v_mfma_f32_16x16x32_bf16 v[72:75], v[132:135], v[116:119], v[72:75]
    s_waitcnt vmcnt(5) lgkmcnt(0)
    s_barrier
    ds_read_b64_tr_b16 v[132:133], v5 offset:0
    ds_read_b64_tr_b16 v[134:135], v5 offset:256
    v_mfma_f32_16x16x32_bf16 v[28:31], v[136:139], v[104:107], v[28:31]
    v_mfma_f32_16x16x32_bf16 v[44:47], v[136:139], v[112:115], v[44:47]
    s_add_u32 m0, s35, 0
    s_add_u32 s52, s28, 12288
    buffer_load_dwordx4 v3, s[8:11], s52 offen lds
    v_mfma_f32_16x16x32_bf16 v[60:63], v[136:139], v[120:123], v[60:63]
    ds_read_b64_tr_b16 v[136:137], v5 offset:32
    ds_read_b64_tr_b16 v[138:139], v5 offset:288
    ds_read_b128 v[76:79], v25 offset:0
    ds_read_b128 v[84:87], v25 offset:2048
    ds_read_b128 v[92:95], v25 offset:4096
    v_mfma_f32_16x16x32_bf16 v[32:35], v[140:143], v[104:107], v[32:35]
    v_mfma_f32_16x16x32_bf16 v[48:51], v[140:143], v[112:115], v[48:51]
    s_add_u32 m0, s35, 1024
    s_add_u32 s52, s29, 12288
    buffer_load_dwordx4 v3, s[8:11], s52 offen lds
    v_mfma_f32_16x16x32_bf16 v[64:67], v[140:143], v[120:123], v[64:67]
    ds_read_b64_tr_b16 v[140:141], v5 offset:64
    ds_read_b64_tr_b16 v[142:143], v5 offset:320
    v_mfma_f32_16x16x32_bf16 v[36:39], v[124:127], v[104:107], v[36:39]
    v_mfma_f32_16x16x32_bf16 v[52:55], v[124:127], v[112:115], v[52:55]
    s_add_u32 m0, s35, 2048
    s_add_u32 s52, s31, 12288
    buffer_load_dwordx4 v3, s[8:11], s52 offen lds
    v_mfma_f32_16x16x32_bf16 v[68:71], v[124:127], v[120:123], v[68:71]
    ds_read_b64_tr_b16 v[124:125], v5 offset:96
    ds_read_b64_tr_b16 v[126:127], v5 offset:352
    ds_read_b128 v[80:83], v25 offset:1024
    ds_read_b128 v[88:91], v25 offset:3072
    ds_read_b128 v[96:99], v25 offset:5120
    v_mfma_f32_16x16x32_bf16 v[40:43], v[128:131], v[104:107], v[40:43]
    v_mfma_f32_16x16x32_bf16 v[56:59], v[128:131], v[112:115], v[56:59]
    s_add_u32 s52, s32, 393216
    s_add_u32 m0, s34, 0
    s_nop 0
    buffer_load_dwordx4 v2, s[12:15], s52 offen offset:0 lds
    v_mfma_f32_16x16x32_bf16 v[72:75], v[128:131], v[120:123], v[72:75]
    ds_read_b64_tr_b16 v[128:129], v5 offset:512
    ds_read_b64_tr_b16 v[130:131], v5 offset:768
    s_waitcnt lgkmcnt(9)
    v_mfma_f32_16x16x32_bf16 v[28:31], v[132:135], v[76:79], v[28:31]
    v_mfma_f32_16x16x32_bf16 v[44:47], v[132:135], v[84:87], v[44:47]
    s_add_u32 s52, s32, 393216
    s_add_u32 m0, s34, 32
    s_nop 0
    buffer_load_dwordx4 v2, s[12:15], s52 offen offset:1024 lds
    v_mfma_f32_16x16x32_bf16 v[60:63], v[132:135], v[92:95], v[60:63]
    ds_read_b64_tr_b16 v[132:133], v5 offset:544
    ds_read_b64_tr_b16 v[134:135], v5 offset:800
    v_mfma_f32_16x16x32_bf16 v[32:35], v[136:139], v[76:79], v[32:35]
    v_mfma_f32_16x16x32_bf16 v[48:51], v[136:139], v[84:87], v[48:51]
    v_mfma_f32_16x16x32_bf16 v[64:67], v[136:139], v[92:95], v[64:67]
    ds_read_b64_tr_b16 v[136:137], v5 offset:576
    ds_read_b64_tr_b16 v[138:139], v5 offset:832
    s_waitcnt lgkmcnt(11)
    v_mfma_f32_16x16x32_bf16 v[36:39], v[140:143], v[76:79], v[36:39]
    v_mfma_f32_16x16x32_bf16 v[52:55], v[140:143], v[84:87], v[52:55]
    v_mfma_f32_16x16x32_bf16 v[68:71], v[140:143], v[92:95], v[68:71]
    ds_read_b64_tr_b16 v[140:141], v5 offset:608
    ds_read_b64_tr_b16 v[142:143], v5 offset:864
    s_waitcnt lgkmcnt(11)
    v_mfma_f32_16x16x32_bf16 v[40:43], v[124:127], v[76:79], v[40:43]
    v_mfma_f32_16x16x32_bf16 v[56:59], v[124:127], v[84:87], v[56:59]
    v_mfma_f32_16x16x32_bf16 v[72:75], v[124:127], v[92:95], v[72:75]
    s_waitcnt vmcnt(5) lgkmcnt(0)
    s_barrier
    ds_read_b64_tr_b16 v[124:125], v6 offset:0
    ds_read_b64_tr_b16 v[126:127], v6 offset:256
    v_mfma_f32_16x16x32_bf16 v[28:31], v[128:131], v[80:83], v[28:31]
    v_mfma_f32_16x16x32_bf16 v[44:47], v[128:131], v[88:91], v[44:47]
    s_add_u32 m0, s35, 41472
    s_add_u32 s52, s28, 14336
    buffer_load_dwordx4 v3, s[8:11], s52 offen lds
    v_mfma_f32_16x16x32_bf16 v[60:63], v[128:131], v[96:99], v[60:63]
    ds_read_b64_tr_b16 v[128:129], v6 offset:32
    ds_read_b64_tr_b16 v[130:131], v6 offset:288
    ds_read_b128 v[100:103], v26 offset:0
    ds_read_b128 v[108:111], v26 offset:2048
    ds_read_b128 v[116:119], v26 offset:4096
    v_mfma_f32_16x16x32_bf16 v[32:35], v[132:135], v[80:83], v[32:35]
    v_mfma_f32_16x16x32_bf16 v[48:51], v[132:135], v[88:91], v[48:51]
    s_add_u32 m0, s35, 42496
    s_add_u32 s52, s29, 14336
    buffer_load_dwordx4 v3, s[8:11], s52 offen lds
    v_mfma_f32_16x16x32_bf16 v[64:67], v[132:135], v[96:99], v[64:67]
    ds_read_b64_tr_b16 v[132:133], v6 offset:64
    ds_read_b64_tr_b16 v[134:135], v6 offset:320
    v_mfma_f32_16x16x32_bf16 v[36:39], v[136:139], v[80:83], v[36:39]
    v_mfma_f32_16x16x32_bf16 v[52:55], v[136:139], v[88:91], v[52:55]
    s_add_u32 m0, s35, 43520
    s_add_u32 s52, s31, 14336
    buffer_load_dwordx4 v3, s[8:11], s52 offen lds
    v_mfma_f32_16x16x32_bf16 v[68:71], v[136:139], v[96:99], v[68:71]
    ds_read_b64_tr_b16 v[136:137], v6 offset:96
    ds_read_b64_tr_b16 v[138:139], v6 offset:352
    ds_read_b128 v[104:107], v26 offset:1024
    ds_read_b128 v[112:115], v26 offset:3072
    ds_read_b128 v[120:123], v26 offset:5120
    v_mfma_f32_16x16x32_bf16 v[40:43], v[140:143], v[80:83], v[40:43]
    v_mfma_f32_16x16x32_bf16 v[56:59], v[140:143], v[88:91], v[56:59]
    s_add_u32 s52, s32, 458752
    s_add_u32 m0, s34, 41472
    s_nop 0
    buffer_load_dwordx4 v2, s[12:15], s52 offen offset:0 lds
    v_mfma_f32_16x16x32_bf16 v[72:75], v[140:143], v[96:99], v[72:75]
    ds_read_b64_tr_b16 v[140:141], v6 offset:512
    ds_read_b64_tr_b16 v[142:143], v6 offset:768
    s_waitcnt lgkmcnt(9)
    v_mfma_f32_16x16x32_bf16 v[28:31], v[124:127], v[100:103], v[28:31]
    v_mfma_f32_16x16x32_bf16 v[44:47], v[124:127], v[108:111], v[44:47]
    s_add_u32 s52, s32, 458752
    s_add_u32 m0, s34, 41504
    s_nop 0
    buffer_load_dwordx4 v2, s[12:15], s52 offen offset:1024 lds
    v_mfma_f32_16x16x32_bf16 v[60:63], v[124:127], v[116:119], v[60:63]
    ds_read_b64_tr_b16 v[124:125], v6 offset:544
    ds_read_b64_tr_b16 v[126:127], v6 offset:800
    v_mfma_f32_16x16x32_bf16 v[32:35], v[128:131], v[100:103], v[32:35]
    v_mfma_f32_16x16x32_bf16 v[48:51], v[128:131], v[108:111], v[48:51]
    v_mfma_f32_16x16x32_bf16 v[64:67], v[128:131], v[116:119], v[64:67]
    ds_read_b64_tr_b16 v[128:129], v6 offset:576
    ds_read_b64_tr_b16 v[130:131], v6 offset:832
    s_waitcnt lgkmcnt(11)
    v_mfma_f32_16x16x32_bf16 v[36:39], v[132:135], v[100:103], v[36:39]
    v_mfma_f32_16x16x32_bf16 v[52:55], v[132:135], v[108:111], v[52:55]
    v_mfma_f32_16x16x32_bf16 v[68:71], v[132:135], v[116:119], v[68:71]
    ds_read_b64_tr_b16 v[132:133], v6 offset:608
    ds_read_b64_tr_b16 v[134:135], v6 offset:864
    s_waitcnt lgkmcnt(11)
    v_mfma_f32_16x16x32_bf16 v[40:43], v[136:139], v[100:103], v[40:43]
    v_mfma_f32_16x16x32_bf16 v[56:59], v[136:139], v[108:111], v[56:59]
    v_mfma_f32_16x16x32_bf16 v[72:75], v[136:139], v[116:119], v[72:75]
    s_waitcnt vmcnt(5) lgkmcnt(0)
    s_barrier
    ds_read_b64_tr_b16 v[136:137], v4 offset:0
    ds_read_b64_tr_b16 v[138:139], v4 offset:256
    v_mfma_f32_16x16x32_bf16 v[28:31], v[140:143], v[104:107], v[28:31]
    v_mfma_f32_16x16x32_bf16 v[44:47], v[140:143], v[112:115], v[44:47]
    s_add_u32 m0, s35, 82944
    s_add_u32 s52, s28, 16384
    buffer_load_dwordx4 v3, s[8:11], s52 offen lds
    v_mfma_f32_16x16x32_bf16 v[60:63], v[140:143], v[120:123], v[60:63]
    ds_read_b64_tr_b16 v[140:141], v4 offset:32
    ds_read_b64_tr_b16 v[142:143], v4 offset:288
    ds_read_b128 v[76:79], v24 offset:0
    ds_read_b128 v[84:87], v24 offset:2048
    ds_read_b128 v[92:95], v24 offset:4096
    v_mfma_f32_16x16x32_bf16 v[32:35], v[124:127], v[104:107], v[32:35]
    v_mfma_f32_16x16x32_bf16 v[48:51], v[124:127], v[112:115], v[48:51]
    s_add_u32 m0, s35, 83968
    s_add_u32 s52, s29, 16384
    buffer_load_dwordx4 v3, s[8:11], s52 offen lds
    v_mfma_f32_16x16x32_bf16 v[64:67], v[124:127], v[120:123], v[64:67]
    ds_read_b64_tr_b16 v[124:125], v4 offset:64
    ds_read_b64_tr_b16 v[126:127], v4 offset:320
    v_mfma_f32_16x16x32_bf16 v[36:39], v[128:131], v[104:107], v[36:39]
    v_mfma_f32_16x16x32_bf16 v[52:55], v[128:131], v[112:115], v[52:55]
    s_add_u32 m0, s35, 84992
    s_add_u32 s52, s31, 16384
    buffer_load_dwordx4 v3, s[8:11], s52 offen lds
    v_mfma_f32_16x16x32_bf16 v[68:71], v[128:131], v[120:123], v[68:71]
    ds_read_b64_tr_b16 v[128:129], v4 offset:96
    ds_read_b64_tr_b16 v[130:131], v4 offset:352
    ds_read_b128 v[80:83], v24 offset:1024
    ds_read_b128 v[88:91], v24 offset:3072
    ds_read_b128 v[96:99], v24 offset:5120
    v_mfma_f32_16x16x32_bf16 v[40:43], v[132:135], v[104:107], v[40:43]
    v_mfma_f32_16x16x32_bf16 v[56:59], v[132:135], v[112:115], v[56:59]
    s_add_u32 s52, s32, 524288
    s_add_u32 m0, s34, 82944
    s_nop 0
    buffer_load_dwordx4 v2, s[12:15], s52 offen offset:0 lds
    v_mfma_f32_16x16x32_bf16 v[72:75], v[132:135], v[120:123], v[72:75]
    ds_read_b64_tr_b16 v[132:133], v4 offset:512
    ds_read_b64_tr_b16 v[134:135], v4 offset:768
    s_waitcnt lgkmcnt(9)
    v_mfma_f32_16x16x32_bf16 v[28:31], v[136:139], v[76:79], v[28:31]
    v_mfma_f32_16x16x32_bf16 v[44:47], v[136:139], v[84:87], v[44:47]
    s_add_u32 s52, s32, 524288
    s_add_u32 m0, s34, 82976
    s_nop 0
    buffer_load_dwordx4 v2, s[12:15], s52 offen offset:1024 lds
    v_mfma_f32_16x16x32_bf16 v[60:63], v[136:139], v[92:95], v[60:63]
    ds_read_b64_tr_b16 v[136:137], v4 offset:544
    ds_read_b64_tr_b16 v[138:139], v4 offset:800
    v_mfma_f32_16x16x32_bf16 v[32:35], v[140:143], v[76:79], v[32:35]
    v_mfma_f32_16x16x32_bf16 v[48:51], v[140:143], v[84:87], v[48:51]
    v_mfma_f32_16x16x32_bf16 v[64:67], v[140:143], v[92:95], v[64:67]
    ds_read_b64_tr_b16 v[140:141], v4 offset:576
    ds_read_b64_tr_b16 v[142:143], v4 offset:832
    s_waitcnt lgkmcnt(11)
    v_mfma_f32_16x16x32_bf16 v[36:39], v[124:127], v[76:79], v[36:39]
    v_mfma_f32_16x16x32_bf16 v[52:55], v[124:127], v[84:87], v[52:55]
    v_mfma_f32_16x16x32_bf16 v[68:71], v[124:127], v[92:95], v[68:71]
    ds_read_b64_tr_b16 v[124:125], v4 offset:608
    ds_read_b64_tr_b16 v[126:127], v4 offset:864
    s_waitcnt lgkmcnt(11)
    v_mfma_f32_16x16x32_bf16 v[40:43], v[128:131], v[76:79], v[40:43]
    v_mfma_f32_16x16x32_bf16 v[56:59], v[128:131], v[84:87], v[56:59]
    v_mfma_f32_16x16x32_bf16 v[72:75], v[128:131], v[92:95], v[72:75]
    s_waitcnt vmcnt(5) lgkmcnt(0)
    s_barrier
    ds_read_b64_tr_b16 v[128:129], v5 offset:0
    ds_read_b64_tr_b16 v[130:131], v5 offset:256
    v_mfma_f32_16x16x32_bf16 v[28:31], v[132:135], v[80:83], v[28:31]
    v_mfma_f32_16x16x32_bf16 v[44:47], v[132:135], v[88:91], v[44:47]
    s_add_u32 m0, s35, 0
    s_add_u32 s52, s28, 18432
    buffer_load_dwordx4 v3, s[8:11], s52 offen lds
    v_mfma_f32_16x16x32_bf16 v[60:63], v[132:135], v[96:99], v[60:63]
    ds_read_b64_tr_b16 v[132:133], v5 offset:32
    ds_read_b64_tr_b16 v[134:135], v5 offset:288
    ds_read_b128 v[100:103], v25 offset:0
    ds_read_b128 v[108:111], v25 offset:2048
    ds_read_b128 v[116:119], v25 offset:4096
    v_mfma_f32_16x16x32_bf16 v[32:35], v[136:139], v[80:83], v[32:35]
    v_mfma_f32_16x16x32_bf16 v[48:51], v[136:139], v[88:91], v[48:51]
    s_add_u32 m0, s35, 1024
    s_add_u32 s52, s29, 18432
    buffer_load_dwordx4 v3, s[8:11], s52 offen lds
    v_mfma_f32_16x16x32_bf16 v[64:67], v[136:139], v[96:99], v[64:67]
    ds_read_b64_tr_b16 v[136:137], v5 offset:64
    ds_read_b64_tr_b16 v[138:139], v5 offset:320
    v_mfma_f32_16x16x32_bf16 v[36:39], v[140:143], v[80:83], v[36:39]
    v_mfma_f32_16x16x32_bf16 v[52:55], v[140:143], v[88:91], v[52:55]
    s_add_u32 m0, s35, 2048
    s_add_u32 s52, s31, 18432
    buffer_load_dwordx4 v3, s[8:11], s52 offen lds
    v_mfma_f32_16x16x32_bf16 v[68:71], v[140:143], v[96:99], v[68:71]
    ds_read_b64_tr_b16 v[140:141], v5 offset:96
    ds_read_b64_tr_b16 v[142:143], v5 offset:352
    ds_read_b128 v[104:107], v25 offset:1024
    ds_read_b128 v[112:115], v25 offset:3072
    ds_read_b128 v[120:123], v25 offset:5120
    v_mfma_f32_16x16x32_bf16 v[40:43], v[124:127], v[80:83], v[40:43]
    v_mfma_f32_16x16x32_bf16 v[56:59], v[124:127], v[88:91], v[56:59]
    s_add_u32 s52, s32, 589824
    s_add_u32 m0, s34, 0
    s_nop 0
    buffer_load_dwordx4 v2, s[12:15], s52 offen offset:0 lds
    v_mfma_f32_16x16x32_bf16 v[72:75], v[124:127], v[96:99], v[72:75]
    ds_read_b64_tr_b16 v[124:125], v5 offset:512
    ds_read_b64_tr_b16 v[126:127], v5 offset:768
    s_waitcnt lgkmcnt(9)
    v_mfma_f32_16x16x32_bf16 v[28:31], v[128:131], v[100:103], v[28:31]
    v_mfma_f32_16x16x32_bf16 v[44:47], v[128:131], v[108:111], v[44:47]
    s_add_u32 s52, s32, 589824
    s_add_u32 m0, s34, 32
    s_nop 0
    buffer_load_dwordx4 v2, s[12:15], s52 offen offset:1024 lds
    v_mfma_f32_16x16x32_bf16 v[60:63], v[128:131], v[116:119], v[60:63]
    ds_read_b64_tr_b16 v[128:129], v5 offset:544
    ds_read_b64_tr_b16 v[130:131], v5 offset:800
    v_mfma_f32_16x16x32_bf16 v[32:35], v[132:135], v[100:103], v[32:35]
    v_mfma_f32_16x16x32_bf16 v[48:51], v[132:135], v[108:111], v[48:51]
    v_mfma_f32_16x16x32_bf16 v[64:67], v[132:135], v[116:119], v[64:67]
    ds_read_b64_tr_b16 v[132:133], v5 offset:576
    ds_read_b64_tr_b16 v[134:135], v5 offset:832
    s_waitcnt lgkmcnt(11)
    v_mfma_f32_16x16x32_bf16 v[36:39], v[136:139], v[100:103], v[36:39]
    v_mfma_f32_16x16x32_bf16 v[52:55], v[136:139], v[108:111], v[52:55]
    v_mfma_f32_16x16x32_bf16 v[68:71], v[136:139], v[116:119], v[68:71]
    ds_read_b64_tr_b16 v[136:137], v5 offset:608
    ds_read_b64_tr_b16 v[138:139], v5 offset:864
    s_waitcnt lgkmcnt(11)
    v_mfma_f32_16x16x32_bf16 v[40:43], v[140:143], v[100:103], v[40:43]
    v_mfma_f32_16x16x32_bf16 v[56:59], v[140:143], v[108:111], v[56:59]
    v_mfma_f32_16x16x32_bf16 v[72:75], v[140:143], v[116:119], v[72:75]
    s_waitcnt vmcnt(5) lgkmcnt(0)
    s_barrier
    ds_read_b64_tr_b16 v[140:141], v6 offset:0
    ds_read_b64_tr_b16 v[142:143], v6 offset:256
    v_mfma_f32_16x16x32_bf16 v[28:31], v[124:127], v[104:107], v[28:31]
    v_mfma_f32_16x16x32_bf16 v[44:47], v[124:127], v[112:115], v[44:47]
    s_add_u32 m0, s35, 41472
    s_add_u32 s52, s28, 20480
    buffer_load_dwordx4 v3, s[8:11], s52 offen lds
    v_mfma_f32_16x16x32_bf16 v[60:63], v[124:127], v[120:123], v[60:63]
    ds_read_b64_tr_b16 v[124:125], v6 offset:32
    ds_read_b64_tr_b16 v[126:127], v6 offset:288
    ds_read_b128 v[76:79], v26 offset:0
    ds_read_b128 v[84:87], v26 offset:2048
    ds_read_b128 v[92:95], v26 offset:4096
    v_mfma_f32_16x16x32_bf16 v[32:35], v[128:131], v[104:107], v[32:35]
    v_mfma_f32_16x16x32_bf16 v[48:51], v[128:131], v[112:115], v[48:51]
    s_add_u32 m0, s35, 42496
    s_add_u32 s52, s29, 20480
    buffer_load_dwordx4 v3, s[8:11], s52 offen lds
    v_mfma_f32_16x16x32_bf16 v[64:67], v[128:131], v[120:123], v[64:67]
    ds_read_b64_tr_b16 v[128:129], v6 offset:64
    ds_read_b64_tr_b16 v[130:131], v6 offset:320
    v_mfma_f32_16x16x32_bf16 v[36:39], v[132:135], v[104:107], v[36:39]
    v_mfma_f32_16x16x32_bf16 v[52:55], v[132:135], v[112:115], v[52:55]
    s_add_u32 m0, s35, 43520
    s_add_u32 s52, s31, 20480
    buffer_load_dwordx4 v3, s[8:11], s52 offen lds
    v_mfma_f32_16x16x32_bf16 v[68:71], v[132:135], v[120:123], v[68:71]
    ds_read_b64_tr_b16 v[132:133], v6 offset:96
    ds_read_b64_tr_b16 v[134:135], v6 offset:352
    ds_read_b128 v[80:83], v26 offset:1024
    ds_read_b128 v[88:91], v26 offset:3072
    ds_read_b128 v[96:99], v26 offset:5120
    v_mfma_f32_16x16x32_bf16 v[40:43], v[136:139], v[104:107], v[40:43]
    v_mfma_f32_16x16x32_bf16 v[56:59], v[136:139], v[112:115], v[56:59]
    s_add_u32 s52, s32, 655360
    s_add_u32 m0, s34, 41472
    s_nop 0
    buffer_load_dwordx4 v2, s[12:15], s52 offen offset:0 lds
    v_mfma_f32_16x16x32_bf16 v[72:75], v[136:139], v[120:123], v[72:75]
    ds_read_b64_tr_b16 v[136:137], v6 offset:512
    ds_read_b64_tr_b16 v[138:139], v6 offset:768
    s_waitcnt lgkmcnt(9)
    v_mfma_f32_16x16x32_bf16 v[28:31], v[140:143], v[76:79], v[28:31]
    v_mfma_f32_16x16x32_bf16 v[44:47], v[140:143], v[84:87], v[44:47]
    s_add_u32 s52, s32, 655360
    s_add_u32 m0, s34, 41504
    s_nop 0
    buffer_load_dwordx4 v2, s[12:15], s52 offen offset:1024 lds
    v_mfma_f32_16x16x32_bf16 v[60:63], v[140:143], v[92:95], v[60:63]
    ds_read_b64_tr_b16 v[140:141], v6 offset:544
    ds_read_b64_tr_b16 v[142:143], v6 offset:800
    v_mfma_f32_16x16x32_bf16 v[32:35], v[124:127], v[76:79], v[32:35]
    v_mfma_f32_16x16x32_bf16 v[48:51], v[124:127], v[84:87], v[48:51]
    v_mfma_f32_16x16x32_bf16 v[64:67], v[124:127], v[92:95], v[64:67]
    ds_read_b64_tr_b16 v[124:125], v6 offset:576
    ds_read_b64_tr_b16 v[126:127], v6 offset:832
    s_waitcnt lgkmcnt(11)
    v_mfma_f32_16x16x32_bf16 v[36:39], v[128:131], v[76:79], v[36:39]
    v_mfma_f32_16x16x32_bf16 v[52:55], v[128:131], v[84:87], v[52:55]
    v_mfma_f32_16x16x32_bf16 v[68:71], v[128:131], v[92:95], v[68:71]
    ds_read_b64_tr_b16 v[128:129], v6 offset:608
    ds_read_b64_tr_b16 v[130:131], v6 offset:864
    s_waitcnt lgkmcnt(11)
    v_mfma_f32_16x16x32_bf16 v[40:43], v[132:135], v[76:79], v[40:43]
    v_mfma_f32_16x16x32_bf16 v[56:59], v[132:135], v[84:87], v[56:59]
    v_mfma_f32_16x16x32_bf16 v[72:75], v[132:135], v[92:95], v[72:75]
    s_waitcnt vmcnt(5) lgkmcnt(0)
    s_barrier
    ds_read_b64_tr_b16 v[132:133], v4 offset:0
    ds_read_b64_tr_b16 v[134:135], v4 offset:256
    v_mfma_f32_16x16x32_bf16 v[28:31], v[136:139], v[80:83], v[28:31]
    v_mfma_f32_16x16x32_bf16 v[44:47], v[136:139], v[88:91], v[44:47]
    s_add_u32 m0, s35, 82944
    s_add_u32 s52, s28, 22528
    buffer_load_dwordx4 v3, s[8:11], s52 offen lds
    v_mfma_f32_16x16x32_bf16 v[60:63], v[136:139], v[96:99], v[60:63]
    ds_read_b64_tr_b16 v[136:137], v4 offset:32
    ds_read_b64_tr_b16 v[138:139], v4 offset:288
    ds_read_b128 v[100:103], v24 offset:0
    ds_read_b128 v[108:111], v24 offset:2048
    ds_read_b128 v[116:119], v24 offset:4096
    v_mfma_f32_16x16x32_bf16 v[32:35], v[140:143], v[80:83], v[32:35]
    v_mfma_f32_16x16x32_bf16 v[48:51], v[140:143], v[88:91], v[48:51]
    s_add_u32 m0, s35, 83968
    s_add_u32 s52, s29, 22528
    buffer_load_dwordx4 v3, s[8:11], s52 offen lds
    v_mfma_f32_16x16x32_bf16 v[64:67], v[140:143], v[96:99], v[64:67]
    ds_read_b64_tr_b16 v[140:141], v4 offset:64
    ds_read_b64_tr_b16 v[142:143], v4 offset:320
    v_mfma_f32_16x16x32_bf16 v[36:39], v[124:127], v[80:83], v[36:39]
    v_mfma_f32_16x16x32_bf16 v[52:55], v[124:127], v[88:91], v[52:55]
    s_add_u32 m0, s35, 84992
    s_add_u32 s52, s31, 22528
    buffer_load_dwordx4 v3, s[8:11], s52 offen lds
    v_mfma_f32_16x16x32_bf16 v[68:71], v[124:127], v[96:99], v[68:71]
    ds_read_b64_tr_b16 v[124:125], v4 offset:96
    ds_read_b64_tr_b16 v[126:127], v4 offset:352
    ds_read_b128 v[104:107], v24 offset:1024
    ds_read_b128 v[112:115], v24 offset:3072
    ds_read_b128 v[120:123], v24 offset:5120
    v_mfma_f32_16x16x32_bf16 v[40:43], v[128:131], v[80:83], v[40:43]
    v_mfma_f32_16x16x32_bf16 v[56:59], v[128:131], v[88:91], v[56:59]
    s_add_u32 s52, s32, 720896
    s_add_u32 m0, s34, 82944
    s_nop 0
    buffer_load_dwordx4 v2, s[12:15], s52 offen offset:0 lds
    v_mfma_f32_16x16x32_bf16 v[72:75], v[128:131], v[96:99], v[72:75]
    ds_read_b64_tr_b16 v[128:129], v4 offset:512
    ds_read_b64_tr_b16 v[130:131], v4 offset:768
    s_waitcnt lgkmcnt(9)
    v_mfma_f32_16x16x32_bf16 v[28:31], v[132:135], v[100:103], v[28:31]
    v_mfma_f32_16x16x32_bf16 v[44:47], v[132:135], v[108:111], v[44:47]
    s_add_u32 s52, s32, 720896
    s_add_u32 m0, s34, 82976
    s_nop 0
    buffer_load_dwordx4 v2, s[12:15], s52 offen offset:1024 lds
    v_mfma_f32_16x16x32_bf16 v[60:63], v[132:135], v[116:119], v[60:63]
    ds_read_b64_tr_b16 v[132:133], v4 offset:544
    ds_read_b64_tr_b16 v[134:135], v4 offset:800
    v_mfma_f32_16x16x32_bf16 v[32:35], v[136:139], v[100:103], v[32:35]
    v_mfma_f32_16x16x32_bf16 v[48:51], v[136:139], v[108:111], v[48:51]
    v_mfma_f32_16x16x32_bf16 v[64:67], v[136:139], v[116:119], v[64:67]
    ds_read_b64_tr_b16 v[136:137], v4 offset:576
    ds_read_b64_tr_b16 v[138:139], v4 offset:832
    s_waitcnt lgkmcnt(11)
    v_mfma_f32_16x16x32_bf16 v[36:39], v[140:143], v[100:103], v[36:39]
    v_mfma_f32_16x16x32_bf16 v[52:55], v[140:143], v[108:111], v[52:55]
    v_mfma_f32_16x16x32_bf16 v[68:71], v[140:143], v[116:119], v[68:71]
    ds_read_b64_tr_b16 v[140:141], v4 offset:608
    ds_read_b64_tr_b16 v[142:143], v4 offset:864
    s_waitcnt lgkmcnt(11)
    v_mfma_f32_16x16x32_bf16 v[40:43], v[124:127], v[100:103], v[40:43]
    v_mfma_f32_16x16x32_bf16 v[56:59], v[124:127], v[108:111], v[56:59]
    v_mfma_f32_16x16x32_bf16 v[72:75], v[124:127], v[116:119], v[72:75]
    s_waitcnt vmcnt(5) lgkmcnt(0)
    s_barrier
    ds_read_b64_tr_b16 v[124:125], v5 offset:0
    ds_read_b64_tr_b16 v[126:127], v5 offset:256
    v_mfma_f32_16x16x32_bf16 v[28:31], v[128:131], v[104:107], v[28:31]
    v_mfma_f32_16x16x32_bf16 v[44:47], v[128:131], v[112:115], v[44:47]
    s_add_u32 m0, s35, 0
    s_add_u32 s52, s28, 24576
    buffer_load_dwordx4 v3, s[8:11], s52 offen lds
    v_mfma_f32_16x16x32_bf16 v[60:63], v[128:131], v[120:123], v[60:63]
    ds_read_b64_tr_b16 v[128:129], v5 offset:32
    ds_read_b64_tr_b16 v[130:131], v5 offset:288
    ds_read_b128 v[76:79], v25 offset:0
    ds_read_b128 v[84:87], v25 offset:2048
    ds_read_b128 v[92:95], v25 offset:4096
    v_mfma_f32_16x16x32_bf16 v[32:35], v[132:135], v[104:107], v[32:35]
    v_mfma_f32_16x16x32_bf16 v[48:51], v[132:135], v[112:115], v[48:51]
    s_add_u32 m0, s35, 1024
    s_add_u32 s52, s29, 24576
    buffer_load_dwordx4 v3, s[8:11], s52 offen lds
    v_mfma_f32_16x16x32_bf16 v[64:67], v[132:135], v[120:123], v[64:67]
    ds_read_b64_tr_b16 v[132:133], v5 offset:64
    ds_read_b64_tr_b16 v[134:135], v5 offset:320
    v_mfma_f32_16x16x32_bf16 v[36:39], v[136:139], v[104:107], v[36:39]
    v_mfma_f32_16x16x32_bf16 v[52:55], v[136:139], v[112:115], v[52:55]
    s_add_u32 m0, s35, 2048
    s_add_u32 s52, s31, 24576
    buffer_load_dwordx4 v3, s[8:11], s52 offen lds
    v_mfma_f32_16x16x32_bf16 v[68:71], v[136:139], v[120:123], v[68:71]
    ds_read_b64_tr_b16 v[136:137], v5 offset:96
    ds_read_b64_tr_b16 v[138:139], v5 offset:352
    ds_read_b128 v[80:83], v25 offset:1024
    ds_read_b128 v[88:91], v25 offset:3072
    ds_read_b128 v[96:99], v25 offset:5120
    v_mfma_f32_16x16x32_bf16 v[40:43], v[140:143], v[104:107], v[40:43]
    v_mfma_f32_16x16x32_bf16 v[56:59], v[140:143], v[112:115], v[56:59]
    s_add_u32 s52, s32, 786432
    s_add_u32 m0, s34, 0
    s_nop 0
    buffer_load_dwordx4 v2, s[12:15], s52 offen offset:0 lds
    v_mfma_f32_16x16x32_bf16 v[72:75], v[140:143], v[120:123], v[72:75]
    ds_read_b64_tr_b16 v[140:141], v5 offset:512
    ds_read_b64_tr_b16 v[142:143], v5 offset:768
    s_waitcnt lgkmcnt(9)
    v_mfma_f32_16x16x32_bf16 v[28:31], v[124:127], v[76:79], v[28:31]
    v_mfma_f32_16x16x32_bf16 v[44:47], v[124:127], v[84:87], v[44:47]
    s_add_u32 s52, s32, 786432
    s_add_u32 m0, s34, 32
    s_nop 0
    buffer_load_dwordx4 v2, s[12:15], s52 offen offset:1024 lds
    v_mfma_f32_16x16x32_bf16 v[60:63], v[124:127], v[92:95], v[60:63]
    ds_read_b64_tr_b16 v[124:125], v5 offset:544
    ds_read_b64_tr_b16 v[126:127], v5 offset:800
    v_mfma_f32_16x16x32_bf16 v[32:35], v[128:131], v[76:79], v[32:35]
    v_mfma_f32_16x16x32_bf16 v[48:51], v[128:131], v[84:87], v[48:51]
    v_mfma_f32_16x16x32_bf16 v[64:67], v[128:131], v[92:95], v[64:67]
    ds_read_b64_tr_b16 v[128:129], v5 offset:576
    ds_read_b64_tr_b16 v[130:131], v5 offset:832
    s_waitcnt lgkmcnt(11)
    v_mfma_f32_16x16x32_bf16 v[36:39], v[132:135], v[76:79], v[36:39]
    v_mfma_f32_16x16x32_bf16 v[52:55], v[132:135], v[84:87], v[52:55]
    v_mfma_f32_16x16x32_bf16 v[68:71], v[132:135], v[92:95], v[68:71]
    ds_read_b64_tr_b16 v[132:133], v5 offset:608
    ds_read_b64_tr_b16 v[134:135], v5 offset:864
    s_waitcnt lgkmcnt(11)
    v_mfma_f32_16x16x32_bf16 v[40:43], v[136:139], v[76:79], v[40:43]
    v_mfma_f32_16x16x32_bf16 v[56:59], v[136:139], v[84:87], v[56:59]
    v_mfma_f32_16x16x32_bf16 v[72:75], v[136:139], v[92:95], v[72:75]
    s_waitcnt vmcnt(5) lgkmcnt(0)
    s_barrier
    ds_read_b64_tr_b16 v[136:137], v6 offset:0
    ds_read_b64_tr_b16 v[138:139], v6 offset:256
    v_mfma_f32_16x16x32_bf16 v[28:31], v[140:143], v[80:83], v[28:31]
    v_mfma_f32_16x16x32_bf16 v[44:47], v[140:143], v[88:91], v[44:47]
    s_add_u32 m0, s35, 41472
    s_add_u32 s52, s28, 26624
    buffer_load_dwordx4 v3, s[8:11], s52 offen lds
    v_mfma_f32_16x16x32_bf16 v[60:63], v[140:143], v[96:99], v[60:63]
    ds_read_b64_tr_b16 v[140:141], v6 offset:32
    ds_read_b64_tr_b16 v[142:143], v6 offset:288
    ds_read_b128 v[100:103], v26 offset:0
    ds_read_b128 v[108:111], v26 offset:2048
    ds_read_b128 v[116:119], v26 offset:4096
    v_mfma_f32_16x16x32_bf16 v[32:35], v[124:127], v[80:83], v[32:35]
    v_mfma_f32_16x16x32_bf16 v[48:51], v[124:127], v[88:91], v[48:51]
    s_add_u32 m0, s35, 42496
    s_add_u32 s52, s29, 26624
    buffer_load_dwordx4 v3, s[8:11], s52 offen lds
    v_mfma_f32_16x16x32_bf16 v[64:67], v[124:127], v[96:99], v[64:67]
    ds_read_b64_tr_b16 v[124:125], v6 offset:64
    ds_read_b64_tr_b16 v[126:127], v6 offset:320
    v_mfma_f32_16x16x32_bf16 v[36:39], v[128:131], v[80:83], v[36:39]
    v_mfma_f32_16x16x32_bf16 v[52:55], v[128:131], v[88:91], v[52:55]
    s_add_u32 m0, s35, 43520
    s_add_u32 s52, s31, 26624
    buffer_load_dwordx4 v3, s[8:11], s52 offen lds
    v_mfma_f32_16x16x32_bf16 v[68:71], v[128:131], v[96:99], v[68:71]
    ds_read_b64_tr_b16 v[128:129], v6 offset:96
    ds_read_b64_tr_b16 v[130:131], v6 offset:352
    ds_read_b128 v[104:107], v26 offset:1024
    ds_read_b128 v[112:115], v26 offset:3072
    ds_read_b128 v[120:123], v26 offset:5120
    v_mfma_f32_16x16x32_bf16 v[40:43], v[132:135], v[80:83], v[40:43]
    v_mfma_f32_16x16x32_bf16 v[56:59], v[132:135], v[88:91], v[56:59]
    s_add_u32 s52, s32, 851968
    s_add_u32 m0, s34, 41472
    s_nop 0
    buffer_load_dwordx4 v2, s[12:15], s52 offen offset:0 lds
    v_mfma_f32_16x16x32_bf16 v[72:75], v[132:135], v[96:99], v[72:75]
    ds_read_b64_tr_b16 v[132:133], v6 offset:512
    ds_read_b64_tr_b16 v[134:135], v6 offset:768
    s_waitcnt lgkmcnt(9)
    v_mfma_f32_16x16x32_bf16 v[28:31], v[136:139], v[100:103], v[28:31]
    v_mfma_f32_16x16x32_bf16 v[44:47], v[136:139], v[108:111], v[44:47]
    s_add_u32 s52, s32, 851968
    s_add_u32 m0, s34, 41504
    s_nop 0
    buffer_load_dwordx4 v2, s[12:15], s52 offen offset:1024 lds
    v_mfma_f32_16x16x32_bf16 v[60:63], v[136:139], v[116:119], v[60:63]
    ds_read_b64_tr_b16 v[136:137], v6 offset:544
    ds_read_b64_tr_b16 v[138:139], v6 offset:800
    v_mfma_f32_16x16x32_bf16 v[32:35], v[140:143], v[100:103], v[32:35]
    v_mfma_f32_16x16x32_bf16 v[48:51], v[140:143], v[108:111], v[48:51]
    v_mfma_f32_16x16x32_bf16 v[64:67], v[140:143], v[116:119], v[64:67]
    ds_read_b64_tr_b16 v[140:141], v6 offset:576
    ds_read_b64_tr_b16 v[142:143], v6 offset:832
    s_waitcnt lgkmcnt(11)
    v_mfma_f32_16x16x32_bf16 v[36:39], v[124:127], v[100:103], v[36:39]
    v_mfma_f32_16x16x32_bf16 v[52:55], v[124:127], v[108:111], v[52:55]
    v_mfma_f32_16x16x32_bf16 v[68:71], v[124:127], v[116:119], v[68:71]
    ds_read_b64_tr_b16 v[124:125], v6 offset:608
    ds_read_b64_tr_b16 v[126:127], v6 offset:864
    s_waitcnt lgkmcnt(11)
    v_mfma_f32_16x16x32_bf16 v[40:43], v[128:131], v[100:103], v[40:43]
    v_mfma_f32_16x16x32_bf16 v[56:59], v[128:131], v[108:111], v[56:59]
    v_mfma_f32_16x16x32_bf16 v[72:75], v[128:131], v[116:119], v[72:75]
    s_waitcnt vmcnt(5) lgkmcnt(0)
    s_barrier
    ds_read_b64_tr_b16 v[128:129], v4 offset:0
    ds_read_b64_tr_b16 v[130:131], v4 offset:256
    v_mfma_f32_16x16x32_bf16 v[28:31], v[132:135], v[104:107], v[28:31]
    v_mfma_f32_16x16x32_bf16 v[44:47], v[132:135], v[112:115], v[44:47]
    s_add_u32 m0, s35, 82944
    s_add_u32 s52, s28, 28672
    buffer_load_dwordx4 v3, s[8:11], s52 offen lds
    v_mfma_f32_16x16x32_bf16 v[60:63], v[132:135], v[120:123], v[60:63]
    ds_read_b64_tr_b16 v[132:133], v4 offset:32
    ds_read_b64_tr_b16 v[134:135], v4 offset:288
    ds_read_b128 v[76:79], v24 offset:0
    ds_read_b128 v[84:87], v24 offset:2048
    ds_read_b128 v[92:95], v24 offset:4096
    v_mfma_f32_16x16x32_bf16 v[32:35], v[136:139], v[104:107], v[32:35]
    v_mfma_f32_16x16x32_bf16 v[48:51], v[136:139], v[112:115], v[48:51]
    s_add_u32 m0, s35, 83968
    s_add_u32 s52, s29, 28672
    buffer_load_dwordx4 v3, s[8:11], s52 offen lds
    v_mfma_f32_16x16x32_bf16 v[64:67], v[136:139], v[120:123], v[64:67]
    ds_read_b64_tr_b16 v[136:137], v4 offset:64
    ds_read_b64_tr_b16 v[138:139], v4 offset:320
    v_mfma_f32_16x16x32_bf16 v[36:39], v[140:143], v[104:107], v[36:39]
    v_mfma_f32_16x16x32_bf16 v[52:55], v[140:143], v[112:115], v[52:55]
    s_add_u32 m0, s35, 84992
    s_add_u32 s52, s31, 28672
    buffer_load_dwordx4 v3, s[8:11], s52 offen lds
    v_mfma_f32_16x16x32_bf16 v[68:71], v[140:143], v[120:123], v[68:71]
    ds_read_b64_tr_b16 v[140:141], v4 offset:96
    ds_read_b64_tr_b16 v[142:143], v4 offset:352
    ds_read_b128 v[80:83], v24 offset:1024
    ds_read_b128 v[88:91], v24 offset:3072
    ds_read_b128 v[96:99], v24 offset:5120
    v_mfma_f32_16x16x32_bf16 v[40:43], v[124:127], v[104:107], v[40:43]
    v_mfma_f32_16x16x32_bf16 v[56:59], v[124:127], v[112:115], v[56:59]
    s_add_u32 s52, s32, 917504
    s_add_u32 m0, s34, 82944
    s_nop 0
    buffer_load_dwordx4 v2, s[12:15], s52 offen offset:0 lds
    v_mfma_f32_16x16x32_bf16 v[72:75], v[124:127], v[120:123], v[72:75]
    ds_read_b64_tr_b16 v[124:125], v4 offset:512
    ds_read_b64_tr_b16 v[126:127], v4 offset:768
    s_waitcnt lgkmcnt(9)
    v_mfma_f32_16x16x32_bf16 v[28:31], v[128:131], v[76:79], v[28:31]
    v_mfma_f32_16x16x32_bf16 v[44:47], v[128:131], v[84:87], v[44:47]
    s_add_u32 s52, s32, 917504
    s_add_u32 m0, s34, 82976
    s_nop 0
    buffer_load_dwordx4 v2, s[12:15], s52 offen offset:1024 lds
    v_mfma_f32_16x16x32_bf16 v[60:63], v[128:131], v[92:95], v[60:63]
    ds_read_b64_tr_b16 v[128:129], v4 offset:544
    ds_read_b64_tr_b16 v[130:131], v4 offset:800
    v_mfma_f32_16x16x32_bf16 v[32:35], v[132:135], v[76:79], v[32:35]
    v_mfma_f32_16x16x32_bf16 v[48:51], v[132:135], v[84:87], v[48:51]
    v_mfma_f32_16x16x32_bf16 v[64:67], v[132:135], v[92:95], v[64:67]
    ds_read_b64_tr_b16 v[132:133], v4 offset:576
    ds_read_b64_tr_b16 v[134:135], v4 offset:832
    s_waitcnt lgkmcnt(11)
    v_mfma_f32_16x16x32_bf16 v[36:39], v[136:139], v[76:79], v[36:39]
    v_mfma_f32_16x16x32_bf16 v[52:55], v[136:139], v[84:87], v[52:55]
    v_mfma_f32_16x16x32_bf16 v[68:71], v[136:139], v[92:95], v[68:71]
    ds_read_b64_tr_b16 v[136:137], v4 offset:608
    ds_read_b64_tr_b16 v[138:139], v4 offset:864
    s_waitcnt lgkmcnt(11)
    v_mfma_f32_16x16x32_bf16 v[40:43], v[140:143], v[76:79], v[40:43]
    v_mfma_f32_16x16x32_bf16 v[56:59], v[140:143], v[84:87], v[56:59]
    v_mfma_f32_16x16x32_bf16 v[72:75], v[140:143], v[92:95], v[72:75]
    s_waitcnt vmcnt(5) lgkmcnt(0)
    s_barrier
    ds_read_b64_tr_b16 v[140:141], v5 offset:0
    ds_read_b64_tr_b16 v[142:143], v5 offset:256
    v_mfma_f32_16x16x32_bf16 v[28:31], v[124:127], v[80:83], v[28:31]
    v_mfma_f32_16x16x32_bf16 v[44:47], v[124:127], v[88:91], v[44:47]
    s_add_u32 m0, s35, 0
    s_add_u32 s52, s28, 30720
    buffer_load_dwordx4 v3, s[8:11], s52 offen lds
    v_mfma_f32_16x16x32_bf16 v[60:63], v[124:127], v[96:99], v[60:63]
    ds_read_b64_tr_b16 v[124:125], v5 offset:32
    ds_read_b64_tr_b16 v[126:127], v5 offset:288
    ds_read_b128 v[100:103], v25 offset:0
    ds_read_b128 v[108:111], v25 offset:2048
    ds_read_b128 v[116:119], v25 offset:4096
    v_mfma_f32_16x16x32_bf16 v[32:35], v[128:131], v[80:83], v[32:35]
    v_mfma_f32_16x16x32_bf16 v[48:51], v[128:131], v[88:91], v[48:51]
    s_add_u32 m0, s35, 1024
    s_add_u32 s52, s29, 30720
    buffer_load_dwordx4 v3, s[8:11], s52 offen lds
    v_mfma_f32_16x16x32_bf16 v[64:67], v[128:131], v[96:99], v[64:67]
    ds_read_b64_tr_b16 v[128:129], v5 offset:64
    ds_read_b64_tr_b16 v[130:131], v5 offset:320
    v_mfma_f32_16x16x32_bf16 v[36:39], v[132:135], v[80:83], v[36:39]
    v_mfma_f32_16x16x32_bf16 v[52:55], v[132:135], v[88:91], v[52:55]
    s_add_u32 m0, s35, 2048
    s_add_u32 s52, s31, 30720
    buffer_load_dwordx4 v3, s[8:11], s52 offen lds
    v_mfma_f32_16x16x32_bf16 v[68:71], v[132:135], v[96:99], v[68:71]
    ds_read_b64_tr_b16 v[132:133], v5 offset:96
    ds_read_b64_tr_b16 v[134:135], v5 offset:352
    ds_read_b128 v[104:107], v25 offset:1024
    ds_read_b128 v[112:115], v25 offset:3072
    ds_read_b128 v[120:123], v25 offset:5120
    v_mfma_f32_16x16x32_bf16 v[40:43], v[136:139], v[80:83], v[40:43]
    v_mfma_f32_16x16x32_bf16 v[56:59], v[136:139], v[88:91], v[56:59]
    s_add_u32 s52, s32, 983040
    s_add_u32 m0, s34, 0
    s_nop 0
    buffer_load_dwordx4 v2, s[12:15], s52 offen offset:0 lds
    v_mfma_f32_16x16x32_bf16 v[72:75], v[136:139], v[96:99], v[72:75]
    ds_read_b64_tr_b16 v[136:137], v5 offset:512
    ds_read_b64_tr_b16 v[138:139], v5 offset:768
    s_waitcnt lgkmcnt(9)
    v_mfma_f32_16x16x32_bf16 v[28:31], v[140:143], v[100:103], v[28:31]
    v_mfma_f32_16x16x32_bf16 v[44:47], v[140:143], v[108:111], v[44:47]
    s_add_u32 s52, s32, 983040
    s_add_u32 m0, s34, 32
    s_nop 0
    buffer_load_dwordx4 v2, s[12:15], s52 offen offset:1024 lds
    v_mfma_f32_16x16x32_bf16 v[60:63], v[140:143], v[116:119], v[60:63]
    ds_read_b64_tr_b16 v[140:141], v5 offset:544
    ds_read_b64_tr_b16 v[142:143], v5 offset:800
    v_mfma_f32_16x16x32_bf16 v[32:35], v[124:127], v[100:103], v[32:35]
    v_mfma_f32_16x16x32_bf16 v[48:51], v[124:127], v[108:111], v[48:51]
    v_mfma_f32_16x16x32_bf16 v[64:67], v[124:127], v[116:119], v[64:67]
    ds_read_b64_tr_b16 v[124:125], v5 offset:576
    ds_read_b64_tr_b16 v[126:127], v5 offset:832
    s_waitcnt lgkmcnt(11)
    v_mfma_f32_16x16x32_bf16 v[36:39], v[128:131], v[100:103], v[36:39]
    v_mfma_f32_16x16x32_bf16 v[52:55], v[128:131], v[108:111], v[52:55]
    v_mfma_f32_16x16x32_bf16 v[68:71], v[128:131], v[116:119], v[68:71]
    ds_read_b64_tr_b16 v[128:129], v5 offset:608
    ds_read_b64_tr_b16 v[130:131], v5 offset:864
    s_waitcnt lgkmcnt(11)
    v_mfma_f32_16x16x32_bf16 v[40:43], v[132:135], v[100:103], v[40:43]
    v_mfma_f32_16x16x32_bf16 v[56:59], v[132:135], v[108:111], v[56:59]
    v_mfma_f32_16x16x32_bf16 v[72:75], v[132:135], v[116:119], v[72:75]
    s_waitcnt vmcnt(5) lgkmcnt(0)
    s_barrier
    ds_read_b64_tr_b16 v[132:133], v6 offset:0
    ds_read_b64_tr_b16 v[134:135], v6 offset:256
    v_mfma_f32_16x16x32_bf16 v[28:31], v[136:139], v[104:107], v[28:31]
    v_mfma_f32_16x16x32_bf16 v[44:47], v[136:139], v[112:115], v[44:47]
    v_mfma_f32_16x16x32_bf16 v[60:63], v[136:139], v[120:123], v[60:63]
    ds_read_b64_tr_b16 v[136:137], v6 offset:32
    ds_read_b64_tr_b16 v[138:139], v6 offset:288
    ds_read_b128 v[76:79], v26 offset:0
    ds_read_b128 v[84:87], v26 offset:2048
    ds_read_b128 v[92:95], v26 offset:4096
    v_mfma_f32_16x16x32_bf16 v[32:35], v[140:143], v[104:107], v[32:35]
    v_mfma_f32_16x16x32_bf16 v[48:51], v[140:143], v[112:115], v[48:51]
    v_mfma_f32_16x16x32_bf16 v[64:67], v[140:143], v[120:123], v[64:67]
    ds_read_b64_tr_b16 v[140:141], v6 offset:64
    ds_read_b64_tr_b16 v[142:143], v6 offset:320
    v_mfma_f32_16x16x32_bf16 v[36:39], v[124:127], v[104:107], v[36:39]
    v_mfma_f32_16x16x32_bf16 v[52:55], v[124:127], v[112:115], v[52:55]
    v_mfma_f32_16x16x32_bf16 v[68:71], v[124:127], v[120:123], v[68:71]
    ds_read_b64_tr_b16 v[124:125], v6 offset:96
    ds_read_b64_tr_b16 v[126:127], v6 offset:352
    ds_read_b128 v[80:83], v26 offset:1024
    ds_read_b128 v[88:91], v26 offset:3072
    ds_read_b128 v[96:99], v26 offset:5120
    v_mfma_f32_16x16x32_bf16 v[40:43], v[128:131], v[104:107], v[40:43]
    v_mfma_f32_16x16x32_bf16 v[56:59], v[128:131], v[112:115], v[56:59]
    v_mfma_f32_16x16x32_bf16 v[72:75], v[128:131], v[120:123], v[72:75]
    ds_read_b64_tr_b16 v[128:129], v6 offset:512
    ds_read_b64_tr_b16 v[130:131], v6 offset:768
    s_waitcnt lgkmcnt(9)
    v_mfma_f32_16x16x32_bf16 v[28:31], v[132:135], v[76:79], v[28:31]
    v_mfma_f32_16x16x32_bf16 v[44:47], v[132:135], v[84:87], v[44:47]
    v_mfma_f32_16x16x32_bf16 v[60:63], v[132:135], v[92:95], v[60:63]
    ds_read_b64_tr_b16 v[132:133], v6 offset:544
    ds_read_b64_tr_b16 v[134:135], v6 offset:800
    v_mfma_f32_16x16x32_bf16 v[32:35], v[136:139], v[76:79], v[32:35]
    v_mfma_f32_16x16x32_bf16 v[48:51], v[136:139], v[84:87], v[48:51]
    v_mfma_f32_16x16x32_bf16 v[64:67], v[136:139], v[92:95], v[64:67]
    ds_read_b64_tr_b16 v[136:137], v6 offset:576
    ds_read_b64_tr_b16 v[138:139], v6 offset:832
    s_waitcnt lgkmcnt(11)
    v_mfma_f32_16x16x32_bf16 v[36:39], v[140:143], v[76:79], v[36:39]
    v_mfma_f32_16x16x32_bf16 v[52:55], v[140:143], v[84:87], v[52:55]
    v_mfma_f32_16x16x32_bf16 v[68:71], v[140:143], v[92:95], v[68:71]
    ds_read_b64_tr_b16 v[140:141], v6 offset:608
    ds_read_b64_tr_b16 v[142:143], v6 offset:864
    s_waitcnt lgkmcnt(11)
    v_mfma_f32_16x16x32_bf16 v[40:43], v[124:127], v[76:79], v[40:43]
    v_mfma_f32_16x16x32_bf16 v[56:59], v[124:127], v[84:87], v[56:59]
    v_mfma_f32_16x16x32_bf16 v[72:75], v[124:127], v[92:95], v[72:75]
    s_waitcnt vmcnt(0) lgkmcnt(0)
    s_barrier
    ds_read_b64_tr_b16 v[124:125], v4 offset:0
    ds_read_b64_tr_b16 v[126:127], v4 offset:256
    v_mfma_f32_16x16x32_bf16 v[28:31], v[128:131], v[80:83], v[28:31]
    v_mfma_f32_16x16x32_bf16 v[44:47], v[128:131], v[88:91], v[44:47]
    v_mfma_f32_16x16x32_bf16 v[60:63], v[128:131], v[96:99], v[60:63]
    ds_read_b64_tr_b16 v[128:129], v4 offset:32
    ds_read_b64_tr_b16 v[130:131], v4 offset:288
    ds_read_b128 v[100:103], v24 offset:0
    ds_read_b128 v[108:111], v24 offset:2048
    ds_read_b128 v[116:119], v24 offset:4096
    v_mfma_f32_16x16x32_bf16 v[32:35], v[132:135], v[80:83], v[32:35]
    v_mfma_f32_16x16x32_bf16 v[48:51], v[132:135], v[88:91], v[48:51]
    v_mfma_f32_16x16x32_bf16 v[64:67], v[132:135], v[96:99], v[64:67]
    ds_read_b64_tr_b16 v[132:133], v4 offset:64
    ds_read_b64_tr_b16 v[134:135], v4 offset:320
    v_mfma_f32_16x16x32_bf16 v[36:39], v[136:139], v[80:83], v[36:39]
    v_mfma_f32_16x16x32_bf16 v[52:55], v[136:139], v[88:91], v[52:55]
    v_mfma_f32_16x16x32_bf16 v[68:71], v[136:139], v[96:99], v[68:71]
    ds_read_b64_tr_b16 v[136:137], v4 offset:96
    ds_read_b64_tr_b16 v[138:139], v4 offset:352
    ds_read_b128 v[104:107], v24 offset:1024
    ds_read_b128 v[112:115], v24 offset:3072
    ds_read_b128 v[120:123], v24 offset:5120
    v_mfma_f32_16x16x32_bf16 v[40:43], v[140:143], v[80:83], v[40:43]
    v_mfma_f32_16x16x32_bf16 v[56:59], v[140:143], v[88:91], v[56:59]
    v_mfma_f32_16x16x32_bf16 v[72:75], v[140:143], v[96:99], v[72:75]
    ds_read_b64_tr_b16 v[140:141], v4 offset:512
    ds_read_b64_tr_b16 v[142:143], v4 offset:768
    s_waitcnt lgkmcnt(9)
    v_mfma_f32_16x16x32_bf16 v[28:31], v[124:127], v[100:103], v[28:31]
    v_mfma_f32_16x16x32_bf16 v[44:47], v[124:127], v[108:111], v[44:47]
    v_mfma_f32_16x16x32_bf16 v[60:63], v[124:127], v[116:119], v[60:63]
    ds_read_b64_tr_b16 v[124:125], v4 offset:544
    ds_read_b64_tr_b16 v[126:127], v4 offset:800
    v_mfma_f32_16x16x32_bf16 v[32:35], v[128:131], v[100:103], v[32:35]
    v_mfma_f32_16x16x32_bf16 v[48:51], v[128:131], v[108:111], v[48:51]
    v_mfma_f32_16x16x32_bf16 v[64:67], v[128:131], v[116:119], v[64:67]
    ds_read_b64_tr_b16 v[128:129], v4 offset:576
    ds_read_b64_tr_b16 v[130:131], v4 offset:832
    s_waitcnt lgkmcnt(11)
    v_mfma_f32_16x16x32_bf16 v[36:39], v[132:135], v[100:103], v[36:39]
    v_mfma_f32_16x16x32_bf16 v[52:55], v[132:135], v[108:111], v[52:55]
    v_mfma_f32_16x16x32_bf16 v[68:71], v[132:135], v[116:119], v[68:71]
    ds_read_b64_tr_b16 v[132:133], v4 offset:608
    ds_read_b64_tr_b16 v[134:135], v4 offset:864
    s_waitcnt lgkmcnt(11)
    v_mfma_f32_16x16x32_bf16 v[40:43], v[136:139], v[100:103], v[40:43]
    v_mfma_f32_16x16x32_bf16 v[56:59], v[136:139], v[108:111], v[56:59]
    v_mfma_f32_16x16x32_bf16 v[72:75], v[136:139], v[116:119], v[72:75]
    s_waitcnt lgkmcnt(8)
    s_waitcnt lgkmcnt(6)
    v_mfma_f32_16x16x32_bf16 v[28:31], v[140:143], v[104:107], v[28:31]
    v_mfma_f32_16x16x32_bf16 v[44:47], v[140:143], v[112:115], v[44:47]
    v_mfma_f32_16x16x32_bf16 v[60:63], v[140:143], v[120:123], v[60:63]
    s_waitcnt lgkmcnt(4)
    v_mfma_f32_16x16x32_bf16 v[32:35], v[124:127], v[104:107], v[32:35]
    v_mfma_f32_16x16x32_bf16 v[48:51], v[124:127], v[112:115], v[48:51]
    v_mfma_f32_16x16x32_bf16 v[64:67], v[124:127], v[120:123], v[64:67]
    s_waitcnt lgkmcnt(2)
    v_mfma_f32_16x16x32_bf16 v[36:39], v[128:131], v[104:107], v[36:39]
    v_mfma_f32_16x16x32_bf16 v[52:55], v[128:131], v[112:115], v[52:55]
    v_mfma_f32_16x16x32_bf16 v[68:71], v[128:131], v[120:123], v[68:71]
    s_waitcnt lgkmcnt(0)
    v_mfma_f32_16x16x32_bf16 v[40:43], v[132:135], v[104:107], v[40:43]
    v_mfma_f32_16x16x32_bf16 v[56:59], v[132:135], v[112:115], v[56:59]
    v_mfma_f32_16x16x32_bf16 v[72:75], v[132:135], v[120:123], v[72:75]
    v_cvt_pk_bf16_f32 v76, v28, v29
    v_cvt_pk_bf16_f32 v77, v30, v31
    v_cvt_pk_bf16_f32 v78, v32, v33
    v_cvt_pk_bf16_f32 v79, v34, v35
    s_add_u32 s52, s33, 0
    buffer_store_dwordx4 v[76:79], v3, s[16:19], s52 offen sc0 sc1
    v_cvt_pk_bf16_f32 v80, v36, v37
    v_cvt_pk_bf16_f32 v81, v38, v39
    v_cvt_pk_bf16_f32 v82, v40, v41
    v_cvt_pk_bf16_f32 v83, v42, v43
    s_add_u32 s52, s33, 1024
    buffer_store_dwordx4 v[80:83], v3, s[16:19], s52 offen sc0 sc1
    v_cvt_pk_bf16_f32 v84, v44, v45
    v_cvt_pk_bf16_f32 v85, v46, v47
    v_cvt_pk_bf16_f32 v86, v48, v49
    v_cvt_pk_bf16_f32 v87, v50, v51
    s_add_u32 s52, s33, 2048
    buffer_store_dwordx4 v[84:87], v3, s[16:19], s52 offen sc0 sc1
    v_cvt_pk_bf16_f32 v88, v52, v53
    v_cvt_pk_bf16_f32 v89, v54, v55
    v_cvt_pk_bf16_f32 v90, v56, v57
    v_cvt_pk_bf16_f32 v91, v58, v59
    s_add_u32 s52, s33, 3072
    buffer_store_dwordx4 v[88:91], v3, s[16:19], s52 offen sc0 sc1
    v_cvt_pk_bf16_f32 v92, v60, v61
    v_cvt_pk_bf16_f32 v93, v62, v63
    v_cvt_pk_bf16_f32 v94, v64, v65
    v_cvt_pk_bf16_f32 v95, v66, v67
    s_add_u32 s52, s33, 4096
    buffer_store_dwordx4 v[92:95], v3, s[16:19], s52 offen sc0 sc1
    v_cvt_pk_bf16_f32 v96, v68, v69
    v_cvt_pk_bf16_f32 v97, v70, v71
    v_cvt_pk_bf16_f32 v98, v72, v73
    v_cvt_pk_bf16_f32 v99, v74, v75
    s_add_u32 s52, s33, 5120
    buffer_store_dwordx4 v[96:99], v3, s[16:19], s52 offen sc0 sc1
K2_done:
    s_endpgm
.globl oreduce_kernel
.p2align 8
.type oreduce_kernel,@function
oreduce_kernel:
    s_cmp_ge_u32 s2, 512
    s_cbranch_scc1 K3_done
    s_load_dwordx2 s[46:47], s[0:1], 80
    s_load_dwordx2 s[48:49], s[0:1], 96
    v_lshrrev_b32 v8, 6, v0
    v_and_b32 v9, 63, v0
    s_nop 0
    v_readfirstlane_b32 s3, v8
    v_lshlrev_b32 v3, 4, v9
    v_and_b32 v10, 15, v9
    v_lshrrev_b32 v11, 4, v9
    v_lshlrev_b32 v5, 11, v10
    v_lshl_add_u32 v5, v11, 3, v5
    s_lshr_b32 s4, s2, 3
    s_and_b32 s5, s2, 7
    s_mul_i32 s20, s4, 196608
    s_mul_i32 s21, s5, 6144
    s_add_u32 s20, s20, s21
    s_lshl_b32 s21, s3, 11
    s_add_u32 s20, s20, s21
    s_lshr_b32 s6, s4, 5
    s_bfe_u32 s7, s4, 0x30002
    s_and_b32 s22, s4, 3
    s_mul_i32 s23, s7, 192
    s_and_b32 s24, s5, 3
    s_mul_i32 s24, s24, 48
    s_add_u32 s23, s23, s24
    s_lshl_b32 s24, s3, 4
    s_add_u32 s23, s23, s24
    s_lshl_b32 s23, s23, 11
    s_lshl_b32 s24, s6, 10
    s_add_u32 s23, s23, s24
    s_lshl_b32 s24, s22, 8
    s_add_u32 s23, s23, s24
    s_lshr_b32 s24, s5, 2
    s_lshl_b32 s24, s24, 7
    s_add_u32 s23, s23, s24
    s_waitcnt lgkmcnt(0)
    s_add_u32 s48, s48, 33554432
    s_addc_u32 s49, s49, 0
    s_mov_b32 s8, s48
    s_and_b32 s9, s49, 0xffff
    s_mov_b32 s10, 25165824
    s_mov_b32 s11, 0x00020000
    s_mov_b32 s12, s46
    s_and_b32 s13, s47, 0xffff
    s_mov_b32 s14, 3145728
    s_mov_b32 s15, 0x00020000
    s_mov_b32 s25, 0xffff0000
    s_add_u32 s21, s20, 0
    buffer_load_dwordx4 v[12:15], v3, s[8:11], s21 offen offset:0
    s_add_u32 s21, s20, 49152
    buffer_load_dwordx4 v[16:19], v3, s[8:11], s21 offen offset:0
    s_add_u32 s21, s20, 98304
    buffer_load_dwordx4 v[20:23], v3, s[8:11], s21 offen offset:0
    s_add_u32 s21, s20, 147456
    buffer_load_dwordx4 v[24:27], v3, s[8:11], s21 offen offset:0
    s_add_u32 s21, s20, 0
    buffer_load_dwordx4 v[28:31], v3, s[8:11], s21 offen offset:1024
    s_add_u32 s21, s20, 49152
    buffer_load_dwordx4 v[32:35], v3, s[8:11], s21 offen offset:1024
    s_add_u32 s21, s20, 98304
    buffer_load_dwordx4 v[36:39], v3, s[8:11], s21 offen offset:1024
    s_add_u32 s21, s20, 147456
    buffer_load_dwordx4 v[40:43], v3, s[8:11], s21 offen offset:1024
    s_waitcnt vmcnt(4)
    v_lshlrev_b32 v48, 16, v12
    v_and_b32 v49, s25, v12
    v_lshlrev_b32 v50, 16, v13
    v_and_b32 v51, s25, v13
    v_lshlrev_b32 v52, 16, v14
    v_and_b32 v53, s25, v14
    v_lshlrev_b32 v54, 16, v15
    v_and_b32 v55, s25, v15
    v_lshlrev_b32 v60, 16, v16
    v_and_b32 v61, s25, v16
    v_add_f32 v48, v48, v60
    v_add_f32 v49, v49, v61
    v_lshlrev_b32 v60, 16, v17
    v_and_b32 v61, s25, v17
    v_add_f32 v50, v50, v60
    v_add_f32 v51, v51, v61
    v_lshlrev_b32 v60, 16, v18
    v_and_b32 v61, s25, v18
    v_add_f32 v52, v52, v60
    v_add_f32 v53, v53, v61
    v_lshlrev_b32 v60, 16, v19
    v_and_b32 v61, s25, v19
    v_add_f32 v54, v54, v60
    v_add_f32 v55, v55, v61
    v_lshlrev_b32 v60, 16, v20
    v_and_b32 v61, s25, v20
    v_add_f32 v48, v48, v60
    v_add_f32 v49, v49, v61
    v_lshlrev_b32 v60, 16, v21
    v_and_b32 v61, s25, v21
    v_add_f32 v50, v50, v60
    v_add_f32 v51, v51, v61
    v_lshlrev_b32 v60, 16, v22
    v_and_b32 v61, s25, v22
    v_add_f32 v52, v52, v60
    v_add_f32 v53, v53, v61
    v_lshlrev_b32 v60, 16, v23
    v_and_b32 v61, s25, v23
    v_add_f32 v54, v54, v60
    v_add_f32 v55, v55, v61
    v_lshlrev_b32 v60, 16, v24
    v_and_b32 v61, s25, v24
    v_add_f32 v48, v48, v60
    v_add_f32 v49, v49, v61
    v_lshlrev_b32 v60, 16, v25
    v_and_b32 v61, s25, v25
    v_add_f32 v50, v50, v60
    v_add_f32 v51, v51, v61
    v_lshlrev_b32 v60, 16, v26
    v_and_b32 v61, s25, v26
    v_add_f32 v52, v52, v60
    v_add_f32 v53, v53, v61
    v_lshlrev_b32 v60, 16, v27
    v_and_b32 v61, s25, v27
    v_add_f32 v54, v54, v60
    v_add_f32 v55, v55, v61
    v_cvt_pk_bf16_f32 v64, v48, v49
    v_cvt_pk_bf16_f32 v65, v50, v51
    buffer_store_dwordx2 v[64:65], v5, s[12:15], s23 offen offset:0
    v_cvt_pk_bf16_f32 v66, v52, v53
    v_cvt_pk_bf16_f32 v67, v54, v55
    buffer_store_dwordx2 v[66:67], v5, s[12:15], s23 offen offset:32
    s_waitcnt vmcnt(2)
    v_lshlrev_b32 v48, 16, v28
    v_and_b32 v49, s25, v28
    v_lshlrev_b32 v50, 16, v29
    v_and_b32 v51, s25, v29
    v_lshlrev_b32 v52, 16, v30
    v_and_b32 v53, s25, v30
    v_lshlrev_b32 v54, 16, v31
    v_and_b32 v55, s25, v31
    v_lshlrev_b32 v60, 16, v32
    v_and_b32 v61, s25, v32
    v_add_f32 v48, v48, v60
    v_add_f32 v49, v49, v61
    v_lshlrev_b32 v60, 16, v33
    v_and_b32 v61, s25, v33
    v_add_f32 v50, v50, v60
    v_add_f32 v51, v51, v61
    v_lshlrev_b32 v60, 16, v34
    v_and_b32 v61, s25, v34
    v_add_f32 v52, v52, v60
    v_add_f32 v53, v53, v61
    v_lshlrev_b32 v60, 16, v35
    v_and_b32 v61, s25, v35
    v_add_f32 v54, v54, v60
    v_add_f32 v55, v55, v61
    v_lshlrev_b32 v60, 16, v36
    v_and_b32 v61, s25, v36
    v_add_f32 v48, v48, v60
    v_add_f32 v49, v49, v61
    v_lshlrev_b32 v60, 16, v37
    v_and_b32 v61, s25, v37
    v_add_f32 v50, v50, v60
    v_add_f32 v51, v51, v61
    v_lshlrev_b32 v60, 16, v38
    v_and_b32 v61, s25, v38
    v_add_f32 v52, v52, v60
    v_add_f32 v53, v53, v61
    v_lshlrev_b32 v60, 16, v39
    v_and_b32 v61, s25, v39
    v_add_f32 v54, v54, v60
    v_add_f32 v55, v55, v61
    v_lshlrev_b32 v60, 16, v40
    v_and_b32 v61, s25, v40
    v_add_f32 v48, v48, v60
    v_add_f32 v49, v49, v61
    v_lshlrev_b32 v60, 16, v41
    v_and_b32 v61, s25, v41
    v_add_f32 v50, v50, v60
    v_add_f32 v51, v51, v61
    v_lshlrev_b32 v60, 16, v42
    v_and_b32 v61, s25, v42
    v_add_f32 v52, v52, v60
    v_add_f32 v53, v53, v61
    v_lshlrev_b32 v60, 16, v43
    v_and_b32 v61, s25, v43
    v_add_f32 v54, v54, v60
    v_add_f32 v55, v55, v61
    v_cvt_pk_bf16_f32 v68, v48, v49
    v_cvt_pk_bf16_f32 v69, v50, v51
    buffer_store_dwordx2 v[68:69], v5, s[12:15], s23 offen offset:64
    v_cvt_pk_bf16_f32 v70, v52, v53
    v_cvt_pk_bf16_f32 v71, v54, v55
    buffer_store_dwordx2 v[70:71], v5, s[12:15], s23 offen offset:96
K3_done:
    s_endpgm
.section .rodata,"a"
.p2align 6
.amdhsa_kernel attn_fused_kernel
  .amdhsa_next_free_vgpr 256
  .amdhsa_next_free_sgpr 102
  .amdhsa_accum_offset 256
  .amdhsa_group_segment_fixed_size 0
  .amdhsa_kernarg_size 104
  .amdhsa_user_sgpr_count 2
  .amdhsa_user_sgpr_kernarg_segment_ptr 1
  .amdhsa_system_sgpr_workgroup_id_x 1
.end_amdhsa_kernel

.p2align 6
.amdhsa_kernel oproj_kernel
  .amdhsa_next_free_vgpr 168
  .amdhsa_next_free_sgpr 102
  .amdhsa_accum_offset 168
  .amdhsa_group_segment_fixed_size 0
  .amdhsa_kernarg_size 104
  .amdhsa_user_sgpr_count 2
  .amdhsa_user_sgpr_kernarg_segment_ptr 1
  .amdhsa_system_sgpr_workgroup_id_x 1
.end_amdhsa_kernel

.p2align 6
.amdhsa_kernel oreduce_kernel
  .amdhsa_next_free_vgpr 80
  .amdhsa_next_free_sgpr 64
  .amdhsa_accum_offset 80
  .amdhsa_group_segment_fixed_size 0
  .amdhsa_kernarg_size 104
  .amdhsa_user_sgpr_count 2
  .amdhsa_user_sgpr_kernarg_segment_ptr 1
  .amdhsa_system_sgpr_workgroup_id_x 1
.end_amdhsa_kernel
```
